```python
import torch

def _softmax(x, axis=-1):
    return torch.softmax(x, dim=axis)
def _gelu(x):
    return torch.nn.functional.gelu(x, approximate="tanh")
def _silu(x):
    return torch.nn.functional.silu(x)
def _sigmoid(x):
    return torch.sigmoid(x)
def _layernorm(x, axis=-1, eps=1e-5):
    m = x.mean(dim=axis, keepdim=True)
    v = x.var(dim=axis, keepdim=True, unbiased=False)
    return (x - m) / torch.sqrt(v + eps)
def _scatter_add(tgt, idx, src, axis=0):
    return tgt.clone().index_add_(axis, idx, src)
def _segment_sum(src, seg, n):
    out = torch.zeros((n,) + src.shape[1:], dtype=src.dtype)
    return out.index_add_(0, seg, src)
def _pad(x, pw):
    flat = tuple(v for pair in reversed(pw) for v in pair)
    return torch.nn.functional.pad(x, flat)

kernel_name = 'parallel_sum__grouped_kv_mqa__glu_gated_reglu__prompt'

def setup_inputs():

    _w = (lambda a: (lambda t: t.to(torch.bfloat16) if t.is_floating_point() else t)(torch.as_tensor(a)))
    def _A_setup():
        B, S, D, H = 1, 2048, 576, 32
        Dh = D // H
        return {
            "x": _w((lambda *s: torch.randn(*s, dtype=torch.bfloat16) * 0.05)(B, S, D)),
            "wq": _w((lambda *s: torch.randn(*s, dtype=torch.bfloat16) * 0.05)(D, H * Dh)),
            "wk": _w((lambda *s: torch.randn(*s, dtype=torch.bfloat16) * 0.05)(D, Dh)),
            "wv": _w((lambda *s: torch.randn(*s, dtype=torch.bfloat16) * 0.05)(D, Dh)),
            "wo": _w((lambda *s: torch.randn(*s, dtype=torch.bfloat16) * 0.05)(H * Dh, D)),
        }
    _A_in = _A_setup()

    def _B_setup():
        B, S, D, F = 1, 2048, 576, 4608
        return {
            "x": _w((lambda *s: torch.randn(*s, dtype=torch.bfloat16) * 0.05)(B, S, D)),
            "W_gate": _w((lambda *s: torch.randn(*s, dtype=torch.bfloat16) * 0.4)(D, F) * (2.0 / D) ** 0.5),
            "W_up": _w((lambda *s: torch.randn(*s, dtype=torch.bfloat16) * 0.4)(D, F) * (2.0 / D) ** 0.5),
            "W_down": _w((lambda *s: torch.randn(*s, dtype=torch.bfloat16) * 0.4)(F, D) * (1.0 / F) ** 0.5),
        }
    _B_in = _B_setup()

    return {
        "A_x": _A_in["x"],
        "A_wq": _A_in["wq"],
        "A_wk": _A_in["wk"],
        "A_wv": _A_in["wv"],
        "A_wo": _A_in["wo"],
        "B_x": _B_in["x"],
        "B_W_gate": _B_in["W_gate"],
        "B_W_up": _B_in["W_up"],
        "B_W_down": _B_in["W_down"],
    }

def reference(A_x, A_wq, A_wk, A_wv, A_wo, B_x, B_W_gate, B_W_up, B_W_down):
    def _A_ref(x, wq, wk, wv, wo):
        B, S, D = x.shape
        H = 32
        Dh = D // H
        q = (lambda x, *d: x.permute(*d))((x @ wq).reshape(B, S, H, Dh), 0, 2, 1, 3)
        k = x @ wk
        v = x @ wv
        scores = torch.einsum("bhqd,bkd->bhqk", q, k) * (Dh ** -0.5)
        p = _softmax(scores, axis=-1)
        o = torch.einsum("bhqk,bkd->bhqd", p, v)
        return (lambda x, *d: x.permute(*d))(o, 0, 2, 1, 3).reshape(B, S, H * Dh) @ wo

    def _B_ref(x, W_gate, W_up, W_down):
        gate = torch.einsum("bsd,df->bsf", x, W_gate)
        up = torch.einsum("bsd,df->bsf", x, W_up)
        gate = gate * (lambda x, dt: x.to(dt))(gate > 0, gate.dtype)
        h = gate * up
        return torch.einsum("bsf,fd->bsd", h, W_down)

    x = A_x
    xn = _layernorm(x, axis=-1)
    return x + _A_ref(xn, A_wq, A_wk, A_wv, A_wo) + _B_ref(xn, B_W_gate, B_W_up, B_W_down)
```

```asm
; @launch grid=(256,1,1) block=(512,1,1) lds=163840
.amdgcn_target "amdgcn-amd-amdhsa--gfx950"
.text
.globl parallel_sum__grouped_kv_mqa__glu_gated_reglu__prompt_kernel
.p2align 8
.type parallel_sum__grouped_kv_mqa__glu_gated_reglu__prompt_kernel,@function
parallel_sum__grouped_kv_mqa__glu_gated_reglu__prompt_kernel:
KSTART:
    s_cmp_ge_u32 s2, 256
    s_cbranch_scc1 L_end
    s_load_dwordx16 s[64:79], s[0:1], 0
    s_load_dwordx8 s[80:87], s[0:1], 64
    v_lshrrev_b32 v2, 6, v0
    v_and_b32 v1, 63, v0
    v_readfirstlane_b32 s55, v2
    s_and_b32 s40, s2, 7
    s_lshr_b32 s41, s2, 3
    s_and_b32 s37, s40, 1
    s_lshl_b32 s37, s37, 3
    s_and_b32 s42, s41, 7
    s_add_u32 s37, s37, s42
    s_lshr_b32 s38, s40, 1
    s_lshl_b32 s38, s38, 2
    s_lshr_b32 s42, s41, 3
    s_add_u32 s38, s38, s42
    s_and_b32 s36, s55, 3
    s_mov_b32 s3, 0
    s_lshl_b32 s39, s37, 2
    s_add_u32 s39, s39, s36
    v_lshlrev_b32 v11, 4, v1
    s_bfe_u32 s62, s2, 0x30003
    s_lshr_b32 s40, s2, 6
    s_lshl_b32 s40, s40, 1
    s_add_u32 s62, s62, s40
    s_cmp_ge_u32 s62, 9
    s_cselect_b32 s40, 9, 0
    s_sub_u32 s62, s62, s40
    s_lshl_b32 s45, s36, 12
    s_add_u32 s45, s45, 1024
    s_mul_i32 s44, s39, 36864
    v_lshrrev_b32 v2, 3, v1
    v_and_b32 v3, 7, v1
    v_lshrrev_b32 v4, 1, v2
    v_xor_b32 v3, v3, v4
    v_mul_u32_u24 v5, 1152, v2
    v_lshl_add_u32 v12, v3, 4, v5
    v_xor_b32 v13, 64, v12
    s_waitcnt lgkmcnt(0)
    v_mov_b32 v0, 4
    s_cmp_ge_u32 s55, 4
    s_cbranch_scc1 L_at
    s_mov_b32 s4, s64
    s_mov_b32 s5, s65
    s_mov_b32 s6, 2359296
    s_mov_b32 s7, 0x20000
    s_add_u32 s43, s62, 0
    s_cmp_ge_u32 s43, 9
    s_cselect_b32 s40, 9, 0
    s_sub_u32 s43, s43, s40
    s_lshl_b32 s43, s43, 7
    s_add_u32 s43, s43, s44
    s_add_u32 m0, s45, 0
    s_add_u32 s42, s43, 0
    buffer_load_dwordx4 v12, s[4:7], s42 offen lds
    s_add_u32 m0, s45, 1024
    s_add_u32 s42, s43, 9216
    buffer_load_dwordx4 v13, s[4:7], s42 offen lds
    s_add_u32 m0, s45, 2048
    s_add_u32 s42, s43, 18432
    buffer_load_dwordx4 v12, s[4:7], s42 offen lds
    s_add_u32 m0, s45, 3072
    s_add_u32 s42, s43, 27648
    buffer_load_dwordx4 v13, s[4:7], s42 offen lds
    s_add_u32 s43, s62, 1
    s_cmp_ge_u32 s43, 9
    s_cselect_b32 s40, 9, 0
    s_sub_u32 s43, s43, s40
    s_lshl_b32 s43, s43, 7
    s_add_u32 s43, s43, s44
    s_add_u32 m0, s45, 16384
    s_add_u32 s42, s43, 0
    buffer_load_dwordx4 v12, s[4:7], s42 offen lds
    s_add_u32 m0, s45, 17408
    s_add_u32 s42, s43, 9216
    buffer_load_dwordx4 v13, s[4:7], s42 offen lds
    s_add_u32 m0, s45, 18432
    s_add_u32 s42, s43, 18432
    buffer_load_dwordx4 v12, s[4:7], s42 offen lds
    s_add_u32 m0, s45, 19456
    s_add_u32 s42, s43, 27648
    buffer_load_dwordx4 v13, s[4:7], s42 offen lds
    s_sub_u32 s8, s80, 4096
    s_subb_u32 s9, s81, 0
    s_mov_b32 s10, 5312512
    s_mov_b32 s11, 0x20000
    s_sub_u32 s20, s72, 4096
    s_subb_u32 s21, s73, 0
    s_mov_b32 s22, 667648
    s_mov_b32 s23, 0x20000
    s_sub_u32 s12, s76, 4096
    s_subb_u32 s13, s77, 0
    s_mov_b32 s14, 5312512
    s_mov_b32 s15, 0x20000
    s_sub_u32 s16, s78, 4096
    s_subb_u32 s17, s79, 0
    s_mov_b32 s18, 5312512
    s_mov_b32 s19, 0x20000
    s_add_u32 s64, s62, 0
    s_cmp_ge_u32 s64, 9
    s_cselect_b32 s40, 9, 0
    s_sub_u32 s64, s64, s40
    s_add_u32 s65, s62, 1
    s_cmp_ge_u32 s65, 9
    s_cselect_b32 s40, 9, 0
    s_sub_u32 s65, s65, s40
    s_add_u32 s66, s62, 2
    s_cmp_ge_u32 s66, 9
    s_cselect_b32 s40, 9, 0
    s_sub_u32 s66, s66, s40
    s_add_u32 s67, s62, 3
    s_cmp_ge_u32 s67, 9
    s_cselect_b32 s40, 9, 0
    s_sub_u32 s67, s67, s40
    s_add_u32 s68, s62, 4
    s_cmp_ge_u32 s68, 9
    s_cselect_b32 s40, 9, 0
    s_sub_u32 s68, s68, s40
    s_add_u32 s69, s62, 5
    s_cmp_ge_u32 s69, 9
    s_cselect_b32 s40, 9, 0
    s_sub_u32 s69, s69, s40
    s_add_u32 s70, s62, 6
    s_cmp_ge_u32 s70, 9
    s_cselect_b32 s40, 9, 0
    s_sub_u32 s70, s70, s40
    s_add_u32 s71, s62, 7
    s_cmp_ge_u32 s71, 9
    s_cselect_b32 s40, 9, 0
    s_sub_u32 s71, s71, s40
    s_add_u32 s72, s62, 8
    s_cmp_ge_u32 s72, 9
    s_cselect_b32 s40, 9, 0
    s_sub_u32 s72, s72, s40
    s_lshl_b32 s43, s66, 7
    s_add_u32 s43, s43, s44
    s_add_u32 m0, s45, 32768
    s_add_u32 s42, s43, 0
    buffer_load_dwordx4 v12, s[4:7], s42 offen lds
    s_add_u32 m0, s45, 33792
    s_add_u32 s42, s43, 9216
    buffer_load_dwordx4 v13, s[4:7], s42 offen lds
    s_add_u32 m0, s45, 34816
    s_add_u32 s42, s43, 18432
    buffer_load_dwordx4 v12, s[4:7], s42 offen lds
    s_add_u32 m0, s45, 35840
    s_add_u32 s42, s43, 27648
    buffer_load_dwordx4 v13, s[4:7], s42 offen lds
    s_lshl_b32 s43, s67, 7
    s_add_u32 s43, s43, s44
    s_add_u32 m0, s45, 49152
    s_add_u32 s42, s43, 0
    buffer_load_dwordx4 v12, s[4:7], s42 offen lds
    s_add_u32 m0, s45, 50176
    s_add_u32 s42, s43, 9216
    buffer_load_dwordx4 v13, s[4:7], s42 offen lds
    s_add_u32 m0, s45, 51200
    s_add_u32 s42, s43, 18432
    buffer_load_dwordx4 v12, s[4:7], s42 offen lds
    s_add_u32 m0, s45, 52224
    s_add_u32 s42, s43, 27648
    buffer_load_dwordx4 v13, s[4:7], s42 offen lds
    s_lshl_b32 s43, s68, 7
    s_add_u32 s43, s43, s44
    s_add_u32 m0, s45, 65536
    s_add_u32 s42, s43, 0
    buffer_load_dwordx4 v12, s[4:7], s42 offen lds
    s_add_u32 m0, s45, 66560
    s_add_u32 s42, s43, 9216
    buffer_load_dwordx4 v13, s[4:7], s42 offen lds
    s_add_u32 m0, s45, 67584
    s_add_u32 s42, s43, 18432
    buffer_load_dwordx4 v12, s[4:7], s42 offen lds
    s_add_u32 m0, s45, 68608
    s_add_u32 s42, s43, 27648
    buffer_load_dwordx4 v13, s[4:7], s42 offen lds
    s_lshl_b32 s43, s69, 7
    s_add_u32 s43, s43, s44
    s_add_u32 m0, s45, 81920
    s_add_u32 s42, s43, 0
    buffer_load_dwordx4 v12, s[4:7], s42 offen lds
    s_add_u32 m0, s45, 82944
    s_add_u32 s42, s43, 9216
    buffer_load_dwordx4 v13, s[4:7], s42 offen lds
    s_add_u32 m0, s45, 83968
    s_add_u32 s42, s43, 18432
    buffer_load_dwordx4 v12, s[4:7], s42 offen lds
    s_add_u32 m0, s45, 84992
    s_add_u32 s42, s43, 27648
    buffer_load_dwordx4 v13, s[4:7], s42 offen lds
    s_lshl_b32 s43, s70, 7
    s_add_u32 s43, s43, s44
    s_add_u32 m0, s45, 98304
    s_add_u32 s42, s43, 0
    buffer_load_dwordx4 v12, s[4:7], s42 offen lds
    s_add_u32 m0, s45, 99328
    s_add_u32 s42, s43, 9216
    buffer_load_dwordx4 v13, s[4:7], s42 offen lds
    s_add_u32 m0, s45, 100352
    s_add_u32 s42, s43, 18432
    buffer_load_dwordx4 v12, s[4:7], s42 offen lds
    s_add_u32 m0, s45, 101376
    s_add_u32 s42, s43, 27648
    buffer_load_dwordx4 v13, s[4:7], s42 offen lds
    s_mov_b32 s24, s86
    s_mov_b32 s25, s87
    s_mov_b32 s26, 21233664
    s_mov_b32 s27, 0x20000
    s_add_u32 s28, s86, 21495808
    s_addc_u32 s29, s87, 0
    s_mov_b32 s30, 201728
    s_mov_b32 s31, 0x20000
    s_mov_b32 s32, s84
    s_mov_b32 s33, s85
    s_mov_b32 s34, 256
    s_mov_b32 s35, 0x20000
    s_mul_i32 s46, s36, 147456
    s_mul_i32 s40, s38, 576
    s_add_u32 s46, s46, s40
    s_and_b32 s40, s38, 1
    s_lshl_b32 s41, s40, 6
    s_add_u32 s47, s46, s41
    s_xor_b32 s41, s40, 1
    s_lshl_b32 s41, s41, 9
    s_add_u32 s48, s46, s41
    s_add_u32 s48, s48, 4096
    s_mul_i32 s49, s36, 18432
    s_mul_i32 s41, s38, 72
    s_add_u32 s49, s49, s41
    s_mul_i32 s51, s39, 331776
    s_mul_i32 s41, s38, 18432
    s_add_u32 s50, s51, s41
    s_mov_b32 s53, 0x3f803f80
    s_mov_b32 s54, 0xffff0000
    v_and_b32 v2, 31, v1
    v_lshrrev_b32 v3, 5, v1
    v_bfe_u32 v4, v1, 1, 3
    v_xor_b32 v3, v3, v4
    v_lshlrev_b32 v2, 7, v2
    v_lshl_add_u32 v2, v3, 4, v2
    v_add_u32 v2, s45, v2
    v_xor_b32 v3, 32, v2
    v_xor_b32 v4, 64, v2
    v_xor_b32 v5, 96, v2
    v_add_u32 v6, 65536, v2
    v_add_u32 v7, 65536, v3
    v_add_u32 v8, 65536, v4
    v_add_u32 v9, 65536, v5
    v_mov_b32 v48, 0
    v_mov_b32 v49, 0
    v_mov_b32 v50, 0
    v_mov_b32 v51, 0
    s_waitcnt vmcnt(24)
    ds_read_b128 v[112:115], v2 offset:0
    ds_read_b128 v[116:119], v3 offset:0
    ds_read_b128 v[120:123], v4 offset:0
    ds_read_b128 v[124:127], v5 offset:0
    s_waitcnt lgkmcnt(0)
    s_lshl_b32 s43, s71, 7
    s_add_u32 s43, s43, s44
    s_add_u32 m0, s45, 0
    s_add_u32 s42, s43, 0
    buffer_load_dwordx4 v12, s[4:7], s42 offen lds
    s_add_u32 m0, s45, 1024
    s_add_u32 s42, s43, 9216
    buffer_load_dwordx4 v13, s[4:7], s42 offen lds
    s_add_u32 m0, s45, 2048
    s_add_u32 s42, s43, 18432
    buffer_load_dwordx4 v12, s[4:7], s42 offen lds
    s_add_u32 m0, s45, 3072
    s_add_u32 s42, s43, 27648
    buffer_load_dwordx4 v13, s[4:7], s42 offen lds
    s_waitcnt vmcnt(24)
    ds_read_b128 v[128:131], v2 offset:16384
    ds_read_b128 v[132:135], v3 offset:16384
    ds_read_b128 v[136:139], v4 offset:16384
    ds_read_b128 v[140:143], v5 offset:16384
    s_waitcnt lgkmcnt(0)
    s_lshl_b32 s43, s72, 7
    s_add_u32 s43, s43, s44
    s_add_u32 m0, s45, 16384
    s_add_u32 s42, s43, 0
    buffer_load_dwordx4 v12, s[4:7], s42 offen lds
    s_add_u32 m0, s45, 17408
    s_add_u32 s42, s43, 9216
    buffer_load_dwordx4 v13, s[4:7], s42 offen lds
    s_add_u32 m0, s45, 18432
    s_add_u32 s42, s43, 18432
    buffer_load_dwordx4 v12, s[4:7], s42 offen lds
    s_add_u32 m0, s45, 19456
    s_add_u32 s42, s43, 27648
    buffer_load_dwordx4 v13, s[4:7], s42 offen lds
    v_dot2c_f32_bf16 v48, s53, v112
    v_dot2c_f32_bf16 v50, v112, v112
    v_dot2c_f32_bf16 v49, s53, v113
    v_dot2c_f32_bf16 v51, v113, v113
    v_dot2c_f32_bf16 v48, s53, v114
    v_dot2c_f32_bf16 v50, v114, v114
    v_dot2c_f32_bf16 v49, s53, v115
    v_dot2c_f32_bf16 v51, v115, v115
    v_dot2c_f32_bf16 v48, s53, v116
    v_dot2c_f32_bf16 v50, v116, v116
    v_dot2c_f32_bf16 v49, s53, v117
    v_dot2c_f32_bf16 v51, v117, v117
    v_dot2c_f32_bf16 v48, s53, v118
    v_dot2c_f32_bf16 v50, v118, v118
    v_dot2c_f32_bf16 v49, s53, v119
    v_dot2c_f32_bf16 v51, v119, v119
    v_dot2c_f32_bf16 v48, s53, v120
    v_dot2c_f32_bf16 v50, v120, v120
    v_dot2c_f32_bf16 v49, s53, v121
    v_dot2c_f32_bf16 v51, v121, v121
    v_dot2c_f32_bf16 v48, s53, v122
    v_dot2c_f32_bf16 v50, v122, v122
    v_dot2c_f32_bf16 v49, s53, v123
    v_dot2c_f32_bf16 v51, v123, v123
    v_dot2c_f32_bf16 v48, s53, v124
    v_dot2c_f32_bf16 v50, v124, v124
    v_dot2c_f32_bf16 v49, s53, v125
    v_dot2c_f32_bf16 v51, v125, v125
    v_dot2c_f32_bf16 v48, s53, v126
    v_dot2c_f32_bf16 v50, v126, v126
    v_dot2c_f32_bf16 v49, s53, v127
    v_dot2c_f32_bf16 v51, v127, v127
    s_waitcnt vmcnt(24)
    ds_read_b128 v[144:147], v2 offset:32768
    ds_read_b128 v[148:151], v3 offset:32768
    ds_read_b128 v[152:155], v4 offset:32768
    ds_read_b128 v[156:159], v5 offset:32768
    v_dot2c_f32_bf16 v48, s53, v128
    v_dot2c_f32_bf16 v50, v128, v128
    v_dot2c_f32_bf16 v49, s53, v129
    v_dot2c_f32_bf16 v51, v129, v129
    v_dot2c_f32_bf16 v48, s53, v130
    v_dot2c_f32_bf16 v50, v130, v130
    v_dot2c_f32_bf16 v49, s53, v131
    v_dot2c_f32_bf16 v51, v131, v131
    v_dot2c_f32_bf16 v48, s53, v132
    v_dot2c_f32_bf16 v50, v132, v132
    v_dot2c_f32_bf16 v49, s53, v133
    v_dot2c_f32_bf16 v51, v133, v133
    v_dot2c_f32_bf16 v48, s53, v134
    v_dot2c_f32_bf16 v50, v134, v134
    v_dot2c_f32_bf16 v49, s53, v135
    v_dot2c_f32_bf16 v51, v135, v135
    v_dot2c_f32_bf16 v48, s53, v136
    v_dot2c_f32_bf16 v50, v136, v136
    v_dot2c_f32_bf16 v49, s53, v137
    v_dot2c_f32_bf16 v51, v137, v137
    v_dot2c_f32_bf16 v48, s53, v138
    v_dot2c_f32_bf16 v50, v138, v138
    v_dot2c_f32_bf16 v49, s53, v139
    v_dot2c_f32_bf16 v51, v139, v139
    v_dot2c_f32_bf16 v48, s53, v140
    v_dot2c_f32_bf16 v50, v140, v140
    v_dot2c_f32_bf16 v49, s53, v141
    v_dot2c_f32_bf16 v51, v141, v141
    v_dot2c_f32_bf16 v48, s53, v142
    v_dot2c_f32_bf16 v50, v142, v142
    v_dot2c_f32_bf16 v49, s53, v143
    v_dot2c_f32_bf16 v51, v143, v143
    s_waitcnt vmcnt(20)
    ds_read_b128 v[160:163], v2 offset:49152
    ds_read_b128 v[164:167], v3 offset:49152
    ds_read_b128 v[168:171], v4 offset:49152
    ds_read_b128 v[172:175], v5 offset:49152
    s_waitcnt lgkmcnt(4)
    v_dot2c_f32_bf16 v48, s53, v144
    v_dot2c_f32_bf16 v50, v144, v144
    v_dot2c_f32_bf16 v49, s53, v145
    v_dot2c_f32_bf16 v51, v145, v145
    v_dot2c_f32_bf16 v48, s53, v146
    v_dot2c_f32_bf16 v50, v146, v146
    v_dot2c_f32_bf16 v49, s53, v147
    v_dot2c_f32_bf16 v51, v147, v147
    v_dot2c_f32_bf16 v48, s53, v148
    v_dot2c_f32_bf16 v50, v148, v148
    v_dot2c_f32_bf16 v49, s53, v149
    v_dot2c_f32_bf16 v51, v149, v149
    v_dot2c_f32_bf16 v48, s53, v150
    v_dot2c_f32_bf16 v50, v150, v150
    v_dot2c_f32_bf16 v49, s53, v151
    v_dot2c_f32_bf16 v51, v151, v151
    v_dot2c_f32_bf16 v48, s53, v152
    v_dot2c_f32_bf16 v50, v152, v152
    v_dot2c_f32_bf16 v49, s53, v153
    v_dot2c_f32_bf16 v51, v153, v153
    v_dot2c_f32_bf16 v48, s53, v154
    v_dot2c_f32_bf16 v50, v154, v154
    v_dot2c_f32_bf16 v49, s53, v155
    v_dot2c_f32_bf16 v51, v155, v155
    v_dot2c_f32_bf16 v48, s53, v156
    v_dot2c_f32_bf16 v50, v156, v156
    v_dot2c_f32_bf16 v49, s53, v157
    v_dot2c_f32_bf16 v51, v157, v157
    v_dot2c_f32_bf16 v48, s53, v158
    v_dot2c_f32_bf16 v50, v158, v158
    v_dot2c_f32_bf16 v49, s53, v159
    v_dot2c_f32_bf16 v51, v159, v159
    s_waitcnt vmcnt(16)
    ds_read_b128 v[176:179], v6 offset:0
    ds_read_b128 v[180:183], v7 offset:0
    ds_read_b128 v[184:187], v8 offset:0
    ds_read_b128 v[188:191], v9 offset:0
    s_waitcnt lgkmcnt(4)
    v_dot2c_f32_bf16 v48, s53, v160
    v_dot2c_f32_bf16 v50, v160, v160
    v_dot2c_f32_bf16 v49, s53, v161
    v_dot2c_f32_bf16 v51, v161, v161
    v_dot2c_f32_bf16 v48, s53, v162
    v_dot2c_f32_bf16 v50, v162, v162
    v_dot2c_f32_bf16 v49, s53, v163
    v_dot2c_f32_bf16 v51, v163, v163
    v_dot2c_f32_bf16 v48, s53, v164
    v_dot2c_f32_bf16 v50, v164, v164
    v_dot2c_f32_bf16 v49, s53, v165
    v_dot2c_f32_bf16 v51, v165, v165
    v_dot2c_f32_bf16 v48, s53, v166
    v_dot2c_f32_bf16 v50, v166, v166
    v_dot2c_f32_bf16 v49, s53, v167
    v_dot2c_f32_bf16 v51, v167, v167
    v_dot2c_f32_bf16 v48, s53, v168
    v_dot2c_f32_bf16 v50, v168, v168
    v_dot2c_f32_bf16 v49, s53, v169
    v_dot2c_f32_bf16 v51, v169, v169
    v_dot2c_f32_bf16 v48, s53, v170
    v_dot2c_f32_bf16 v50, v170, v170
    v_dot2c_f32_bf16 v49, s53, v171
    v_dot2c_f32_bf16 v51, v171, v171
    v_dot2c_f32_bf16 v48, s53, v172
    v_dot2c_f32_bf16 v50, v172, v172
    v_dot2c_f32_bf16 v49, s53, v173
    v_dot2c_f32_bf16 v51, v173, v173
    v_dot2c_f32_bf16 v48, s53, v174
    v_dot2c_f32_bf16 v50, v174, v174
    v_dot2c_f32_bf16 v49, s53, v175
    v_dot2c_f32_bf16 v51, v175, v175
    s_waitcnt vmcnt(12)
    ds_read_b128 v[192:195], v6 offset:16384
    ds_read_b128 v[196:199], v7 offset:16384
    ds_read_b128 v[200:203], v8 offset:16384
    ds_read_b128 v[204:207], v9 offset:16384
    s_waitcnt lgkmcnt(4)
    v_dot2c_f32_bf16 v48, s53, v176
    v_dot2c_f32_bf16 v50, v176, v176
    v_dot2c_f32_bf16 v49, s53, v177
    v_dot2c_f32_bf16 v51, v177, v177
    v_dot2c_f32_bf16 v48, s53, v178
    v_dot2c_f32_bf16 v50, v178, v178
    v_dot2c_f32_bf16 v49, s53, v179
    v_dot2c_f32_bf16 v51, v179, v179
    v_dot2c_f32_bf16 v48, s53, v180
    v_dot2c_f32_bf16 v50, v180, v180
    v_dot2c_f32_bf16 v49, s53, v181
    v_dot2c_f32_bf16 v51, v181, v181
    v_dot2c_f32_bf16 v48, s53, v182
    v_dot2c_f32_bf16 v50, v182, v182
    v_dot2c_f32_bf16 v49, s53, v183
    v_dot2c_f32_bf16 v51, v183, v183
    v_dot2c_f32_bf16 v48, s53, v184
    v_dot2c_f32_bf16 v50, v184, v184
    v_dot2c_f32_bf16 v49, s53, v185
    v_dot2c_f32_bf16 v51, v185, v185
    v_dot2c_f32_bf16 v48, s53, v186
    v_dot2c_f32_bf16 v50, v186, v186
    v_dot2c_f32_bf16 v49, s53, v187
    v_dot2c_f32_bf16 v51, v187, v187
    v_dot2c_f32_bf16 v48, s53, v188
    v_dot2c_f32_bf16 v50, v188, v188
    v_dot2c_f32_bf16 v49, s53, v189
    v_dot2c_f32_bf16 v51, v189, v189
    v_dot2c_f32_bf16 v48, s53, v190
    v_dot2c_f32_bf16 v50, v190, v190
    v_dot2c_f32_bf16 v49, s53, v191
    v_dot2c_f32_bf16 v51, v191, v191
    s_waitcnt vmcnt(8)
    ds_read_b128 v[208:211], v6 offset:32768
    ds_read_b128 v[212:215], v7 offset:32768
    ds_read_b128 v[216:219], v8 offset:32768
    ds_read_b128 v[220:223], v9 offset:32768
    s_waitcnt lgkmcnt(4)
    v_dot2c_f32_bf16 v48, s53, v192
    v_dot2c_f32_bf16 v50, v192, v192
    v_dot2c_f32_bf16 v49, s53, v193
    v_dot2c_f32_bf16 v51, v193, v193
    v_dot2c_f32_bf16 v48, s53, v194
    v_dot2c_f32_bf16 v50, v194, v194
    v_dot2c_f32_bf16 v49, s53, v195
    v_dot2c_f32_bf16 v51, v195, v195
    v_dot2c_f32_bf16 v48, s53, v196
    v_dot2c_f32_bf16 v50, v196, v196
    v_dot2c_f32_bf16 v49, s53, v197
    v_dot2c_f32_bf16 v51, v197, v197
    v_dot2c_f32_bf16 v48, s53, v198
    v_dot2c_f32_bf16 v50, v198, v198
    v_dot2c_f32_bf16 v49, s53, v199
    v_dot2c_f32_bf16 v51, v199, v199
    v_dot2c_f32_bf16 v48, s53, v200
    v_dot2c_f32_bf16 v50, v200, v200
    v_dot2c_f32_bf16 v49, s53, v201
    v_dot2c_f32_bf16 v51, v201, v201
    v_dot2c_f32_bf16 v48, s53, v202
    v_dot2c_f32_bf16 v50, v202, v202
    v_dot2c_f32_bf16 v49, s53, v203
    v_dot2c_f32_bf16 v51, v203, v203
    v_dot2c_f32_bf16 v48, s53, v204
    v_dot2c_f32_bf16 v50, v204, v204
    v_dot2c_f32_bf16 v49, s53, v205
    v_dot2c_f32_bf16 v51, v205, v205
    v_dot2c_f32_bf16 v48, s53, v206
    v_dot2c_f32_bf16 v50, v206, v206
    v_dot2c_f32_bf16 v49, s53, v207
    v_dot2c_f32_bf16 v51, v207, v207
    s_waitcnt vmcnt(4)
    ds_read_b128 v[224:227], v2 offset:0
    ds_read_b128 v[228:231], v3 offset:0
    ds_read_b128 v[232:235], v4 offset:0
    ds_read_b128 v[236:239], v5 offset:0
    s_waitcnt lgkmcnt(4)
    v_dot2c_f32_bf16 v48, s53, v208
    v_dot2c_f32_bf16 v50, v208, v208
    v_dot2c_f32_bf16 v49, s53, v209
    v_dot2c_f32_bf16 v51, v209, v209
    v_dot2c_f32_bf16 v48, s53, v210
    v_dot2c_f32_bf16 v50, v210, v210
    v_dot2c_f32_bf16 v49, s53, v211
    v_dot2c_f32_bf16 v51, v211, v211
    v_dot2c_f32_bf16 v48, s53, v212
    v_dot2c_f32_bf16 v50, v212, v212
    v_dot2c_f32_bf16 v49, s53, v213
    v_dot2c_f32_bf16 v51, v213, v213
    v_dot2c_f32_bf16 v48, s53, v214
    v_dot2c_f32_bf16 v50, v214, v214
    v_dot2c_f32_bf16 v49, s53, v215
    v_dot2c_f32_bf16 v51, v215, v215
    v_dot2c_f32_bf16 v48, s53, v216
    v_dot2c_f32_bf16 v50, v216, v216
    v_dot2c_f32_bf16 v49, s53, v217
    v_dot2c_f32_bf16 v51, v217, v217
    v_dot2c_f32_bf16 v48, s53, v218
    v_dot2c_f32_bf16 v50, v218, v218
    v_dot2c_f32_bf16 v49, s53, v219
    v_dot2c_f32_bf16 v51, v219, v219
    v_dot2c_f32_bf16 v48, s53, v220
    v_dot2c_f32_bf16 v50, v220, v220
    v_dot2c_f32_bf16 v49, s53, v221
    v_dot2c_f32_bf16 v51, v221, v221
    v_dot2c_f32_bf16 v48, s53, v222
    v_dot2c_f32_bf16 v50, v222, v222
    v_dot2c_f32_bf16 v49, s53, v223
    v_dot2c_f32_bf16 v51, v223, v223
    s_waitcnt vmcnt(0)
    ds_read_b128 v[240:243], v2 offset:16384
    ds_read_b128 v[244:247], v3 offset:16384
    ds_read_b128 v[248:251], v4 offset:16384
    ds_read_b128 v[252:255], v5 offset:16384
    s_waitcnt lgkmcnt(4)
    v_dot2c_f32_bf16 v48, s53, v224
    v_dot2c_f32_bf16 v50, v224, v224
    v_dot2c_f32_bf16 v49, s53, v225
    v_dot2c_f32_bf16 v51, v225, v225
    v_dot2c_f32_bf16 v48, s53, v226
    v_dot2c_f32_bf16 v50, v226, v226
    v_dot2c_f32_bf16 v49, s53, v227
    v_dot2c_f32_bf16 v51, v227, v227
    v_dot2c_f32_bf16 v48, s53, v228
    v_dot2c_f32_bf16 v50, v228, v228
    v_dot2c_f32_bf16 v49, s53, v229
    v_dot2c_f32_bf16 v51, v229, v229
    v_dot2c_f32_bf16 v48, s53, v230
    v_dot2c_f32_bf16 v50, v230, v230
    v_dot2c_f32_bf16 v49, s53, v231
    v_dot2c_f32_bf16 v51, v231, v231
    v_dot2c_f32_bf16 v48, s53, v232
    v_dot2c_f32_bf16 v50, v232, v232
    v_dot2c_f32_bf16 v49, s53, v233
    v_dot2c_f32_bf16 v51, v233, v233
    v_dot2c_f32_bf16 v48, s53, v234
    v_dot2c_f32_bf16 v50, v234, v234
    v_dot2c_f32_bf16 v49, s53, v235
    v_dot2c_f32_bf16 v51, v235, v235
    v_dot2c_f32_bf16 v48, s53, v236
    v_dot2c_f32_bf16 v50, v236, v236
    v_dot2c_f32_bf16 v49, s53, v237
    v_dot2c_f32_bf16 v51, v237, v237
    v_dot2c_f32_bf16 v48, s53, v238
    v_dot2c_f32_bf16 v50, v238, v238
    v_dot2c_f32_bf16 v49, s53, v239
    v_dot2c_f32_bf16 v51, v239, v239
    s_waitcnt lgkmcnt(0)
    s_barrier
    v_dot2c_f32_bf16 v48, s53, v240
    v_dot2c_f32_bf16 v50, v240, v240
    v_dot2c_f32_bf16 v49, s53, v241
    v_dot2c_f32_bf16 v51, v241, v241
    v_dot2c_f32_bf16 v48, s53, v242
    v_dot2c_f32_bf16 v50, v242, v242
    v_dot2c_f32_bf16 v49, s53, v243
    v_dot2c_f32_bf16 v51, v243, v243
    v_dot2c_f32_bf16 v48, s53, v244
    v_dot2c_f32_bf16 v50, v244, v244
    v_dot2c_f32_bf16 v49, s53, v245
    v_dot2c_f32_bf16 v51, v245, v245
    v_dot2c_f32_bf16 v48, s53, v246
    v_dot2c_f32_bf16 v50, v246, v246
    v_dot2c_f32_bf16 v49, s53, v247
    v_dot2c_f32_bf16 v51, v247, v247
    v_dot2c_f32_bf16 v48, s53, v248
    v_dot2c_f32_bf16 v50, v248, v248
    v_dot2c_f32_bf16 v49, s53, v249
    v_dot2c_f32_bf16 v51, v249, v249
    v_dot2c_f32_bf16 v48, s53, v250
    v_dot2c_f32_bf16 v50, v250, v250
    v_dot2c_f32_bf16 v49, s53, v251
    v_dot2c_f32_bf16 v51, v251, v251
    v_dot2c_f32_bf16 v48, s53, v252
    v_dot2c_f32_bf16 v50, v252, v252
    v_dot2c_f32_bf16 v49, s53, v253
    v_dot2c_f32_bf16 v51, v253, v253
    v_dot2c_f32_bf16 v48, s53, v254
    v_dot2c_f32_bf16 v50, v254, v254
    v_dot2c_f32_bf16 v49, s53, v255
    v_dot2c_f32_bf16 v51, v255, v255
    s_nop 2
    v_add_f32 v48, v48, v49
    v_add_f32 v50, v50, v51
    v_mov_b32 v49, v48
    v_mov_b32 v51, v50
    s_nop 0
    v_permlane32_swap_b32 v48, v49
    v_permlane32_swap_b32 v50, v51
    v_add_f32 v48, v48, v49
    v_add_f32 v50, v50, v51
    v_mul_f32 v48, 0x3ae38e39, v48
    v_mul_f32 v50, 0x3ae38e39, v50
    v_fma_f32 v50, -v48, v48, v50
    v_max_f32 v50, 0, v50
    v_add_f32 v50, 0x3727c5ac, v50
    v_rsq_f32 v50, v50
    s_nop 0
    v_mul_f32 v52, v48, v50
    v_sub_f32 v52, 0, v52
    v_mov_b32 v51, v50
    v_mov_b32 v53, v52
    v_lshlrev_b32 v56, 16, v112
    v_and_b32 v57, s54, v112
    v_lshlrev_b32 v58, 16, v113
    v_and_b32 v59, s54, v113
    v_lshlrev_b32 v60, 16, v114
    v_and_b32 v61, s54, v114
    v_lshlrev_b32 v62, 16, v115
    v_and_b32 v63, s54, v115
    v_pk_fma_f32 v[56:57], v[56:57], v[50:51], v[52:53]
    v_pk_fma_f32 v[58:59], v[58:59], v[50:51], v[52:53]
    v_pk_fma_f32 v[60:61], v[60:61], v[50:51], v[52:53]
    v_pk_fma_f32 v[62:63], v[62:63], v[50:51], v[52:53]
    v_cvt_pk_bf16_f32 v112, v56, v57
    v_cvt_pk_bf16_f32 v113, v58, v59
    v_cvt_pk_bf16_f32 v114, v60, v61
    v_cvt_pk_bf16_f32 v115, v62, v63
    v_lshlrev_b32 v56, 16, v116
    v_and_b32 v57, s54, v116
    v_lshlrev_b32 v58, 16, v117
    v_and_b32 v59, s54, v117
    v_lshlrev_b32 v60, 16, v118
    v_and_b32 v61, s54, v118
    v_lshlrev_b32 v62, 16, v119
    v_and_b32 v63, s54, v119
    v_pk_fma_f32 v[56:57], v[56:57], v[50:51], v[52:53]
    v_pk_fma_f32 v[58:59], v[58:59], v[50:51], v[52:53]
    v_pk_fma_f32 v[60:61], v[60:61], v[50:51], v[52:53]
    v_pk_fma_f32 v[62:63], v[62:63], v[50:51], v[52:53]
    v_cvt_pk_bf16_f32 v116, v56, v57
    v_cvt_pk_bf16_f32 v117, v58, v59
    v_cvt_pk_bf16_f32 v118, v60, v61
    v_cvt_pk_bf16_f32 v119, v62, v63
    v_lshlrev_b32 v56, 16, v120
    v_and_b32 v57, s54, v120
    v_lshlrev_b32 v58, 16, v121
    v_and_b32 v59, s54, v121
    v_lshlrev_b32 v60, 16, v122
    v_and_b32 v61, s54, v122
    v_lshlrev_b32 v62, 16, v123
    v_and_b32 v63, s54, v123
    v_pk_fma_f32 v[56:57], v[56:57], v[50:51], v[52:53]
    v_pk_fma_f32 v[58:59], v[58:59], v[50:51], v[52:53]
    v_pk_fma_f32 v[60:61], v[60:61], v[50:51], v[52:53]
    v_pk_fma_f32 v[62:63], v[62:63], v[50:51], v[52:53]
    v_cvt_pk_bf16_f32 v120, v56, v57
    v_cvt_pk_bf16_f32 v121, v58, v59
    v_cvt_pk_bf16_f32 v122, v60, v61
    v_cvt_pk_bf16_f32 v123, v62, v63
    v_lshlrev_b32 v56, 16, v124
    v_and_b32 v57, s54, v124
    v_lshlrev_b32 v58, 16, v125
    v_and_b32 v59, s54, v125
    v_lshlrev_b32 v60, 16, v126
    v_and_b32 v61, s54, v126
    v_lshlrev_b32 v62, 16, v127
    v_and_b32 v63, s54, v127
    v_pk_fma_f32 v[56:57], v[56:57], v[50:51], v[52:53]
    v_pk_fma_f32 v[58:59], v[58:59], v[50:51], v[52:53]
    v_pk_fma_f32 v[60:61], v[60:61], v[50:51], v[52:53]
    v_pk_fma_f32 v[62:63], v[62:63], v[50:51], v[52:53]
    v_cvt_pk_bf16_f32 v124, v56, v57
    v_cvt_pk_bf16_f32 v125, v58, v59
    v_cvt_pk_bf16_f32 v126, v60, v61
    v_cvt_pk_bf16_f32 v127, v62, v63
    v_lshlrev_b32 v56, 16, v128
    v_and_b32 v57, s54, v128
    v_lshlrev_b32 v58, 16, v129
    v_and_b32 v59, s54, v129
    v_lshlrev_b32 v60, 16, v130
    v_and_b32 v61, s54, v130
    v_lshlrev_b32 v62, 16, v131
    v_and_b32 v63, s54, v131
    v_pk_fma_f32 v[56:57], v[56:57], v[50:51], v[52:53]
    v_pk_fma_f32 v[58:59], v[58:59], v[50:51], v[52:53]
    v_pk_fma_f32 v[60:61], v[60:61], v[50:51], v[52:53]
    v_pk_fma_f32 v[62:63], v[62:63], v[50:51], v[52:53]
    v_cvt_pk_bf16_f32 v128, v56, v57
    v_cvt_pk_bf16_f32 v129, v58, v59
    v_cvt_pk_bf16_f32 v130, v60, v61
    v_cvt_pk_bf16_f32 v131, v62, v63
    v_lshlrev_b32 v56, 16, v132
    v_and_b32 v57, s54, v132
    v_lshlrev_b32 v58, 16, v133
    v_and_b32 v59, s54, v133
    v_lshlrev_b32 v60, 16, v134
    v_and_b32 v61, s54, v134
    v_lshlrev_b32 v62, 16, v135
    v_and_b32 v63, s54, v135
    v_pk_fma_f32 v[56:57], v[56:57], v[50:51], v[52:53]
    v_pk_fma_f32 v[58:59], v[58:59], v[50:51], v[52:53]
    v_pk_fma_f32 v[60:61], v[60:61], v[50:51], v[52:53]
    v_pk_fma_f32 v[62:63], v[62:63], v[50:51], v[52:53]
    v_cvt_pk_bf16_f32 v132, v56, v57
    v_cvt_pk_bf16_f32 v133, v58, v59
    v_cvt_pk_bf16_f32 v134, v60, v61
    v_cvt_pk_bf16_f32 v135, v62, v63
    v_lshlrev_b32 v56, 16, v136
    v_and_b32 v57, s54, v136
    v_lshlrev_b32 v58, 16, v137
    v_and_b32 v59, s54, v137
    v_lshlrev_b32 v60, 16, v138
    v_and_b32 v61, s54, v138
    v_lshlrev_b32 v62, 16, v139
    v_and_b32 v63, s54, v139
    v_pk_fma_f32 v[56:57], v[56:57], v[50:51], v[52:53]
    v_pk_fma_f32 v[58:59], v[58:59], v[50:51], v[52:53]
    v_pk_fma_f32 v[60:61], v[60:61], v[50:51], v[52:53]
    v_pk_fma_f32 v[62:63], v[62:63], v[50:51], v[52:53]
    v_cvt_pk_bf16_f32 v136, v56, v57
    v_cvt_pk_bf16_f32 v137, v58, v59
    v_cvt_pk_bf16_f32 v138, v60, v61
    v_cvt_pk_bf16_f32 v139, v62, v63
    v_lshlrev_b32 v56, 16, v140
    v_and_b32 v57, s54, v140
    v_lshlrev_b32 v58, 16, v141
    v_and_b32 v59, s54, v141
    v_lshlrev_b32 v60, 16, v142
    v_and_b32 v61, s54, v142
    v_lshlrev_b32 v62, 16, v143
    v_and_b32 v63, s54, v143
    v_pk_fma_f32 v[56:57], v[56:57], v[50:51], v[52:53]
    v_pk_fma_f32 v[58:59], v[58:59], v[50:51], v[52:53]
    v_pk_fma_f32 v[60:61], v[60:61], v[50:51], v[52:53]
    v_pk_fma_f32 v[62:63], v[62:63], v[50:51], v[52:53]
    v_cvt_pk_bf16_f32 v140, v56, v57
    v_cvt_pk_bf16_f32 v141, v58, v59
    v_cvt_pk_bf16_f32 v142, v60, v61
    v_cvt_pk_bf16_f32 v143, v62, v63
    v_lshlrev_b32 v56, 16, v144
    v_and_b32 v57, s54, v144
    v_lshlrev_b32 v58, 16, v145
    v_and_b32 v59, s54, v145
    v_lshlrev_b32 v60, 16, v146
    v_and_b32 v61, s54, v146
    v_lshlrev_b32 v62, 16, v147
    v_and_b32 v63, s54, v147
    v_pk_fma_f32 v[56:57], v[56:57], v[50:51], v[52:53]
    v_pk_fma_f32 v[58:59], v[58:59], v[50:51], v[52:53]
    v_pk_fma_f32 v[60:61], v[60:61], v[50:51], v[52:53]
    v_pk_fma_f32 v[62:63], v[62:63], v[50:51], v[52:53]
    v_cvt_pk_bf16_f32 v144, v56, v57
    v_cvt_pk_bf16_f32 v145, v58, v59
    v_cvt_pk_bf16_f32 v146, v60, v61
    v_cvt_pk_bf16_f32 v147, v62, v63
    v_lshlrev_b32 v56, 16, v148
    v_and_b32 v57, s54, v148
    v_lshlrev_b32 v58, 16, v149
    v_and_b32 v59, s54, v149
    v_lshlrev_b32 v60, 16, v150
    v_and_b32 v61, s54, v150
    v_lshlrev_b32 v62, 16, v151
    v_and_b32 v63, s54, v151
    v_pk_fma_f32 v[56:57], v[56:57], v[50:51], v[52:53]
    v_pk_fma_f32 v[58:59], v[58:59], v[50:51], v[52:53]
    v_pk_fma_f32 v[60:61], v[60:61], v[50:51], v[52:53]
    v_pk_fma_f32 v[62:63], v[62:63], v[50:51], v[52:53]
    v_cvt_pk_bf16_f32 v148, v56, v57
    v_cvt_pk_bf16_f32 v149, v58, v59
    v_cvt_pk_bf16_f32 v150, v60, v61
    v_cvt_pk_bf16_f32 v151, v62, v63
    v_lshlrev_b32 v56, 16, v152
    v_and_b32 v57, s54, v152
    v_lshlrev_b32 v58, 16, v153
    v_and_b32 v59, s54, v153
    v_lshlrev_b32 v60, 16, v154
    v_and_b32 v61, s54, v154
    v_lshlrev_b32 v62, 16, v155
    v_and_b32 v63, s54, v155
    v_pk_fma_f32 v[56:57], v[56:57], v[50:51], v[52:53]
    v_pk_fma_f32 v[58:59], v[58:59], v[50:51], v[52:53]
    v_pk_fma_f32 v[60:61], v[60:61], v[50:51], v[52:53]
    v_pk_fma_f32 v[62:63], v[62:63], v[50:51], v[52:53]
    v_cvt_pk_bf16_f32 v152, v56, v57
    v_cvt_pk_bf16_f32 v153, v58, v59
    v_cvt_pk_bf16_f32 v154, v60, v61
    v_cvt_pk_bf16_f32 v155, v62, v63
    v_lshlrev_b32 v56, 16, v156
    v_and_b32 v57, s54, v156
    v_lshlrev_b32 v58, 16, v157
    v_and_b32 v59, s54, v157
    v_lshlrev_b32 v60, 16, v158
    v_and_b32 v61, s54, v158
    v_lshlrev_b32 v62, 16, v159
    v_and_b32 v63, s54, v159
    v_pk_fma_f32 v[56:57], v[56:57], v[50:51], v[52:53]
    v_pk_fma_f32 v[58:59], v[58:59], v[50:51], v[52:53]
    v_pk_fma_f32 v[60:61], v[60:61], v[50:51], v[52:53]
    v_pk_fma_f32 v[62:63], v[62:63], v[50:51], v[52:53]
    v_cvt_pk_bf16_f32 v156, v56, v57
    v_cvt_pk_bf16_f32 v157, v58, v59
    v_cvt_pk_bf16_f32 v158, v60, v61
    v_cvt_pk_bf16_f32 v159, v62, v63
    v_lshlrev_b32 v56, 16, v160
    v_and_b32 v57, s54, v160
    v_lshlrev_b32 v58, 16, v161
    v_and_b32 v59, s54, v161
    v_lshlrev_b32 v60, 16, v162
    v_and_b32 v61, s54, v162
    v_lshlrev_b32 v62, 16, v163
    v_and_b32 v63, s54, v163
    v_pk_fma_f32 v[56:57], v[56:57], v[50:51], v[52:53]
    v_pk_fma_f32 v[58:59], v[58:59], v[50:51], v[52:53]
    v_pk_fma_f32 v[60:61], v[60:61], v[50:51], v[52:53]
    v_pk_fma_f32 v[62:63], v[62:63], v[50:51], v[52:53]
    v_cvt_pk_bf16_f32 v160, v56, v57
    v_cvt_pk_bf16_f32 v161, v58, v59
    v_cvt_pk_bf16_f32 v162, v60, v61
    v_cvt_pk_bf16_f32 v163, v62, v63
    v_lshlrev_b32 v56, 16, v164
    v_and_b32 v57, s54, v164
    v_lshlrev_b32 v58, 16, v165
    v_and_b32 v59, s54, v165
    v_lshlrev_b32 v60, 16, v166
    v_and_b32 v61, s54, v166
    v_lshlrev_b32 v62, 16, v167
    v_and_b32 v63, s54, v167
    v_pk_fma_f32 v[56:57], v[56:57], v[50:51], v[52:53]
    v_pk_fma_f32 v[58:59], v[58:59], v[50:51], v[52:53]
    v_pk_fma_f32 v[60:61], v[60:61], v[50:51], v[52:53]
    v_pk_fma_f32 v[62:63], v[62:63], v[50:51], v[52:53]
    v_cvt_pk_bf16_f32 v164, v56, v57
    v_cvt_pk_bf16_f32 v165, v58, v59
    v_cvt_pk_bf16_f32 v166, v60, v61
    v_cvt_pk_bf16_f32 v167, v62, v63
    v_lshlrev_b32 v56, 16, v168
    v_and_b32 v57, s54, v168
    v_lshlrev_b32 v58, 16, v169
    v_and_b32 v59, s54, v169
    v_lshlrev_b32 v60, 16, v170
    v_and_b32 v61, s54, v170
    v_lshlrev_b32 v62, 16, v171
    v_and_b32 v63, s54, v171
    v_pk_fma_f32 v[56:57], v[56:57], v[50:51], v[52:53]
    v_pk_fma_f32 v[58:59], v[58:59], v[50:51], v[52:53]
    v_pk_fma_f32 v[60:61], v[60:61], v[50:51], v[52:53]
    v_pk_fma_f32 v[62:63], v[62:63], v[50:51], v[52:53]
    v_cvt_pk_bf16_f32 v168, v56, v57
    v_cvt_pk_bf16_f32 v169, v58, v59
    v_cvt_pk_bf16_f32 v170, v60, v61
    v_cvt_pk_bf16_f32 v171, v62, v63
    v_lshlrev_b32 v56, 16, v172
    v_and_b32 v57, s54, v172
    v_lshlrev_b32 v58, 16, v173
    v_and_b32 v59, s54, v173
    v_lshlrev_b32 v60, 16, v174
    v_and_b32 v61, s54, v174
    v_lshlrev_b32 v62, 16, v175
    v_and_b32 v63, s54, v175
    v_pk_fma_f32 v[56:57], v[56:57], v[50:51], v[52:53]
    v_pk_fma_f32 v[58:59], v[58:59], v[50:51], v[52:53]
    v_pk_fma_f32 v[60:61], v[60:61], v[50:51], v[52:53]
    v_pk_fma_f32 v[62:63], v[62:63], v[50:51], v[52:53]
    v_cvt_pk_bf16_f32 v172, v56, v57
    v_cvt_pk_bf16_f32 v173, v58, v59
    v_cvt_pk_bf16_f32 v174, v60, v61
    v_cvt_pk_bf16_f32 v175, v62, v63
    v_lshlrev_b32 v56, 16, v176
    v_and_b32 v57, s54, v176
    v_lshlrev_b32 v58, 16, v177
    v_and_b32 v59, s54, v177
    v_lshlrev_b32 v60, 16, v178
    v_and_b32 v61, s54, v178
    v_lshlrev_b32 v62, 16, v179
    v_and_b32 v63, s54, v179
    v_pk_fma_f32 v[56:57], v[56:57], v[50:51], v[52:53]
    v_pk_fma_f32 v[58:59], v[58:59], v[50:51], v[52:53]
    v_pk_fma_f32 v[60:61], v[60:61], v[50:51], v[52:53]
    v_pk_fma_f32 v[62:63], v[62:63], v[50:51], v[52:53]
    v_cvt_pk_bf16_f32 v176, v56, v57
    v_cvt_pk_bf16_f32 v177, v58, v59
    v_cvt_pk_bf16_f32 v178, v60, v61
    v_cvt_pk_bf16_f32 v179, v62, v63
    v_lshlrev_b32 v56, 16, v180
    v_and_b32 v57, s54, v180
    v_lshlrev_b32 v58, 16, v181
    v_and_b32 v59, s54, v181
    v_lshlrev_b32 v60, 16, v182
    v_and_b32 v61, s54, v182
    v_lshlrev_b32 v62, 16, v183
    v_and_b32 v63, s54, v183
    v_pk_fma_f32 v[56:57], v[56:57], v[50:51], v[52:53]
    v_pk_fma_f32 v[58:59], v[58:59], v[50:51], v[52:53]
    v_pk_fma_f32 v[60:61], v[60:61], v[50:51], v[52:53]
    v_pk_fma_f32 v[62:63], v[62:63], v[50:51], v[52:53]
    v_cvt_pk_bf16_f32 v180, v56, v57
    v_cvt_pk_bf16_f32 v181, v58, v59
    v_cvt_pk_bf16_f32 v182, v60, v61
    v_cvt_pk_bf16_f32 v183, v62, v63
    v_lshlrev_b32 v56, 16, v184
    v_and_b32 v57, s54, v184
    v_lshlrev_b32 v58, 16, v185
    v_and_b32 v59, s54, v185
    v_lshlrev_b32 v60, 16, v186
    v_and_b32 v61, s54, v186
    v_lshlrev_b32 v62, 16, v187
    v_and_b32 v63, s54, v187
    v_pk_fma_f32 v[56:57], v[56:57], v[50:51], v[52:53]
    v_pk_fma_f32 v[58:59], v[58:59], v[50:51], v[52:53]
    v_pk_fma_f32 v[60:61], v[60:61], v[50:51], v[52:53]
    v_pk_fma_f32 v[62:63], v[62:63], v[50:51], v[52:53]
    v_cvt_pk_bf16_f32 v184, v56, v57
    v_cvt_pk_bf16_f32 v185, v58, v59
    v_cvt_pk_bf16_f32 v186, v60, v61
    v_cvt_pk_bf16_f32 v187, v62, v63
    v_lshlrev_b32 v56, 16, v188
    v_and_b32 v57, s54, v188
    v_lshlrev_b32 v58, 16, v189
    v_and_b32 v59, s54, v189
    v_lshlrev_b32 v60, 16, v190
    v_and_b32 v61, s54, v190
    v_lshlrev_b32 v62, 16, v191
    v_and_b32 v63, s54, v191
    v_pk_fma_f32 v[56:57], v[56:57], v[50:51], v[52:53]
    v_pk_fma_f32 v[58:59], v[58:59], v[50:51], v[52:53]
    v_pk_fma_f32 v[60:61], v[60:61], v[50:51], v[52:53]
    v_pk_fma_f32 v[62:63], v[62:63], v[50:51], v[52:53]
    v_cvt_pk_bf16_f32 v188, v56, v57
    v_cvt_pk_bf16_f32 v189, v58, v59
    v_cvt_pk_bf16_f32 v190, v60, v61
    v_cvt_pk_bf16_f32 v191, v62, v63
    v_lshlrev_b32 v56, 16, v192
    v_and_b32 v57, s54, v192
    v_lshlrev_b32 v58, 16, v193
    v_and_b32 v59, s54, v193
    v_lshlrev_b32 v60, 16, v194
    v_and_b32 v61, s54, v194
    v_lshlrev_b32 v62, 16, v195
    v_and_b32 v63, s54, v195
    v_pk_fma_f32 v[56:57], v[56:57], v[50:51], v[52:53]
    v_pk_fma_f32 v[58:59], v[58:59], v[50:51], v[52:53]
    v_pk_fma_f32 v[60:61], v[60:61], v[50:51], v[52:53]
    v_pk_fma_f32 v[62:63], v[62:63], v[50:51], v[52:53]
    v_cvt_pk_bf16_f32 v192, v56, v57
    v_cvt_pk_bf16_f32 v193, v58, v59
    v_cvt_pk_bf16_f32 v194, v60, v61
    v_cvt_pk_bf16_f32 v195, v62, v63
    v_lshlrev_b32 v56, 16, v196
    v_and_b32 v57, s54, v196
    v_lshlrev_b32 v58, 16, v197
    v_and_b32 v59, s54, v197
    v_lshlrev_b32 v60, 16, v198
    v_and_b32 v61, s54, v198
    v_lshlrev_b32 v62, 16, v199
    v_and_b32 v63, s54, v199
    v_pk_fma_f32 v[56:57], v[56:57], v[50:51], v[52:53]
    v_pk_fma_f32 v[58:59], v[58:59], v[50:51], v[52:53]
    v_pk_fma_f32 v[60:61], v[60:61], v[50:51], v[52:53]
    v_pk_fma_f32 v[62:63], v[62:63], v[50:51], v[52:53]
    v_cvt_pk_bf16_f32 v196, v56, v57
    v_cvt_pk_bf16_f32 v197, v58, v59
    v_cvt_pk_bf16_f32 v198, v60, v61
    v_cvt_pk_bf16_f32 v199, v62, v63
    v_lshlrev_b32 v56, 16, v200
    v_and_b32 v57, s54, v200
    v_lshlrev_b32 v58, 16, v201
    v_and_b32 v59, s54, v201
    v_lshlrev_b32 v60, 16, v202
    v_and_b32 v61, s54, v202
    v_lshlrev_b32 v62, 16, v203
    v_and_b32 v63, s54, v203
    v_pk_fma_f32 v[56:57], v[56:57], v[50:51], v[52:53]
    v_pk_fma_f32 v[58:59], v[58:59], v[50:51], v[52:53]
    v_pk_fma_f32 v[60:61], v[60:61], v[50:51], v[52:53]
    v_pk_fma_f32 v[62:63], v[62:63], v[50:51], v[52:53]
    v_cvt_pk_bf16_f32 v200, v56, v57
    v_cvt_pk_bf16_f32 v201, v58, v59
    v_cvt_pk_bf16_f32 v202, v60, v61
    v_cvt_pk_bf16_f32 v203, v62, v63
    v_lshlrev_b32 v56, 16, v204
    v_and_b32 v57, s54, v204
    v_lshlrev_b32 v58, 16, v205
    v_and_b32 v59, s54, v205
    v_lshlrev_b32 v60, 16, v206
    v_and_b32 v61, s54, v206
    v_lshlrev_b32 v62, 16, v207
    v_and_b32 v63, s54, v207
    v_pk_fma_f32 v[56:57], v[56:57], v[50:51], v[52:53]
    v_pk_fma_f32 v[58:59], v[58:59], v[50:51], v[52:53]
    v_pk_fma_f32 v[60:61], v[60:61], v[50:51], v[52:53]
    v_pk_fma_f32 v[62:63], v[62:63], v[50:51], v[52:53]
    v_cvt_pk_bf16_f32 v204, v56, v57
    v_cvt_pk_bf16_f32 v205, v58, v59
    v_cvt_pk_bf16_f32 v206, v60, v61
    v_cvt_pk_bf16_f32 v207, v62, v63
    v_lshlrev_b32 v56, 16, v208
    v_and_b32 v57, s54, v208
    v_lshlrev_b32 v58, 16, v209
    v_and_b32 v59, s54, v209
    v_lshlrev_b32 v60, 16, v210
    v_and_b32 v61, s54, v210
    v_lshlrev_b32 v62, 16, v211
    v_and_b32 v63, s54, v211
    v_pk_fma_f32 v[56:57], v[56:57], v[50:51], v[52:53]
    v_pk_fma_f32 v[58:59], v[58:59], v[50:51], v[52:53]
    v_pk_fma_f32 v[60:61], v[60:61], v[50:51], v[52:53]
    v_pk_fma_f32 v[62:63], v[62:63], v[50:51], v[52:53]
    v_cvt_pk_bf16_f32 v208, v56, v57
    v_cvt_pk_bf16_f32 v209, v58, v59
    v_cvt_pk_bf16_f32 v210, v60, v61
    v_cvt_pk_bf16_f32 v211, v62, v63
    v_lshlrev_b32 v56, 16, v212
    v_and_b32 v57, s54, v212
    v_lshlrev_b32 v58, 16, v213
    v_and_b32 v59, s54, v213
    v_lshlrev_b32 v60, 16, v214
    v_and_b32 v61, s54, v214
    v_lshlrev_b32 v62, 16, v215
    v_and_b32 v63, s54, v215
    v_pk_fma_f32 v[56:57], v[56:57], v[50:51], v[52:53]
    v_pk_fma_f32 v[58:59], v[58:59], v[50:51], v[52:53]
    v_pk_fma_f32 v[60:61], v[60:61], v[50:51], v[52:53]
    v_pk_fma_f32 v[62:63], v[62:63], v[50:51], v[52:53]
    v_cvt_pk_bf16_f32 v212, v56, v57
    v_cvt_pk_bf16_f32 v213, v58, v59
    v_cvt_pk_bf16_f32 v214, v60, v61
    v_cvt_pk_bf16_f32 v215, v62, v63
    v_lshlrev_b32 v56, 16, v216
    v_and_b32 v57, s54, v216
    v_lshlrev_b32 v58, 16, v217
    v_and_b32 v59, s54, v217
    v_lshlrev_b32 v60, 16, v218
    v_and_b32 v61, s54, v218
    v_lshlrev_b32 v62, 16, v219
    v_and_b32 v63, s54, v219
    v_pk_fma_f32 v[56:57], v[56:57], v[50:51], v[52:53]
    v_pk_fma_f32 v[58:59], v[58:59], v[50:51], v[52:53]
    v_pk_fma_f32 v[60:61], v[60:61], v[50:51], v[52:53]
    v_pk_fma_f32 v[62:63], v[62:63], v[50:51], v[52:53]
    v_cvt_pk_bf16_f32 v216, v56, v57
    v_cvt_pk_bf16_f32 v217, v58, v59
    v_cvt_pk_bf16_f32 v218, v60, v61
    v_cvt_pk_bf16_f32 v219, v62, v63
    v_lshlrev_b32 v56, 16, v220
    v_and_b32 v57, s54, v220
    v_lshlrev_b32 v58, 16, v221
    v_and_b32 v59, s54, v221
    v_lshlrev_b32 v60, 16, v222
    v_and_b32 v61, s54, v222
    v_lshlrev_b32 v62, 16, v223
    v_and_b32 v63, s54, v223
    v_pk_fma_f32 v[56:57], v[56:57], v[50:51], v[52:53]
    v_pk_fma_f32 v[58:59], v[58:59], v[50:51], v[52:53]
    v_pk_fma_f32 v[60:61], v[60:61], v[50:51], v[52:53]
    v_pk_fma_f32 v[62:63], v[62:63], v[50:51], v[52:53]
    v_cvt_pk_bf16_f32 v220, v56, v57
    v_cvt_pk_bf16_f32 v221, v58, v59
    v_cvt_pk_bf16_f32 v222, v60, v61
    v_cvt_pk_bf16_f32 v223, v62, v63
    v_lshlrev_b32 v56, 16, v224
    v_and_b32 v57, s54, v224
    v_lshlrev_b32 v58, 16, v225
    v_and_b32 v59, s54, v225
    v_lshlrev_b32 v60, 16, v226
    v_and_b32 v61, s54, v226
    v_lshlrev_b32 v62, 16, v227
    v_and_b32 v63, s54, v227
    v_pk_fma_f32 v[56:57], v[56:57], v[50:51], v[52:53]
    v_pk_fma_f32 v[58:59], v[58:59], v[50:51], v[52:53]
    v_pk_fma_f32 v[60:61], v[60:61], v[50:51], v[52:53]
    v_pk_fma_f32 v[62:63], v[62:63], v[50:51], v[52:53]
    v_cvt_pk_bf16_f32 v224, v56, v57
    v_cvt_pk_bf16_f32 v225, v58, v59
    v_cvt_pk_bf16_f32 v226, v60, v61
    v_cvt_pk_bf16_f32 v227, v62, v63
    v_lshlrev_b32 v56, 16, v228
    v_and_b32 v57, s54, v228
    v_lshlrev_b32 v58, 16, v229
    v_and_b32 v59, s54, v229
    v_lshlrev_b32 v60, 16, v230
    v_and_b32 v61, s54, v230
    v_lshlrev_b32 v62, 16, v231
    v_and_b32 v63, s54, v231
    v_pk_fma_f32 v[56:57], v[56:57], v[50:51], v[52:53]
    v_pk_fma_f32 v[58:59], v[58:59], v[50:51], v[52:53]
    v_pk_fma_f32 v[60:61], v[60:61], v[50:51], v[52:53]
    v_pk_fma_f32 v[62:63], v[62:63], v[50:51], v[52:53]
    v_cvt_pk_bf16_f32 v228, v56, v57
    v_cvt_pk_bf16_f32 v229, v58, v59
    v_cvt_pk_bf16_f32 v230, v60, v61
    v_cvt_pk_bf16_f32 v231, v62, v63
    v_lshlrev_b32 v56, 16, v232
    v_and_b32 v57, s54, v232
    v_lshlrev_b32 v58, 16, v233
    v_and_b32 v59, s54, v233
    v_lshlrev_b32 v60, 16, v234
    v_and_b32 v61, s54, v234
    v_lshlrev_b32 v62, 16, v235
    v_and_b32 v63, s54, v235
    v_pk_fma_f32 v[56:57], v[56:57], v[50:51], v[52:53]
    v_pk_fma_f32 v[58:59], v[58:59], v[50:51], v[52:53]
    v_pk_fma_f32 v[60:61], v[60:61], v[50:51], v[52:53]
    v_pk_fma_f32 v[62:63], v[62:63], v[50:51], v[52:53]
    v_cvt_pk_bf16_f32 v232, v56, v57
    v_cvt_pk_bf16_f32 v233, v58, v59
    v_cvt_pk_bf16_f32 v234, v60, v61
    v_cvt_pk_bf16_f32 v235, v62, v63
    v_lshlrev_b32 v56, 16, v236
    v_and_b32 v57, s54, v236
    v_lshlrev_b32 v58, 16, v237
    v_and_b32 v59, s54, v237
    v_lshlrev_b32 v60, 16, v238
    v_and_b32 v61, s54, v238
    v_lshlrev_b32 v62, 16, v239
    v_and_b32 v63, s54, v239
    v_pk_fma_f32 v[56:57], v[56:57], v[50:51], v[52:53]
    v_pk_fma_f32 v[58:59], v[58:59], v[50:51], v[52:53]
    v_pk_fma_f32 v[60:61], v[60:61], v[50:51], v[52:53]
    v_pk_fma_f32 v[62:63], v[62:63], v[50:51], v[52:53]
    v_cvt_pk_bf16_f32 v236, v56, v57
    v_cvt_pk_bf16_f32 v237, v58, v59
    v_cvt_pk_bf16_f32 v238, v60, v61
    v_cvt_pk_bf16_f32 v239, v62, v63
    v_lshlrev_b32 v56, 16, v240
    v_and_b32 v57, s54, v240
    v_lshlrev_b32 v58, 16, v241
    v_and_b32 v59, s54, v241
    v_lshlrev_b32 v60, 16, v242
    v_and_b32 v61, s54, v242
    v_lshlrev_b32 v62, 16, v243
    v_and_b32 v63, s54, v243
    v_pk_fma_f32 v[56:57], v[56:57], v[50:51], v[52:53]
    v_pk_fma_f32 v[58:59], v[58:59], v[50:51], v[52:53]
    v_pk_fma_f32 v[60:61], v[60:61], v[50:51], v[52:53]
    v_pk_fma_f32 v[62:63], v[62:63], v[50:51], v[52:53]
    v_cvt_pk_bf16_f32 v240, v56, v57
    v_cvt_pk_bf16_f32 v241, v58, v59
    v_cvt_pk_bf16_f32 v242, v60, v61
    v_cvt_pk_bf16_f32 v243, v62, v63
    v_lshlrev_b32 v56, 16, v244
    v_and_b32 v57, s54, v244
    v_lshlrev_b32 v58, 16, v245
    v_and_b32 v59, s54, v245
    v_lshlrev_b32 v60, 16, v246
    v_and_b32 v61, s54, v246
    v_lshlrev_b32 v62, 16, v247
    v_and_b32 v63, s54, v247
    v_pk_fma_f32 v[56:57], v[56:57], v[50:51], v[52:53]
    v_pk_fma_f32 v[58:59], v[58:59], v[50:51], v[52:53]
    v_pk_fma_f32 v[60:61], v[60:61], v[50:51], v[52:53]
    v_pk_fma_f32 v[62:63], v[62:63], v[50:51], v[52:53]
    v_cvt_pk_bf16_f32 v244, v56, v57
    v_cvt_pk_bf16_f32 v245, v58, v59
    v_cvt_pk_bf16_f32 v246, v60, v61
    v_cvt_pk_bf16_f32 v247, v62, v63
    v_lshlrev_b32 v56, 16, v248
    v_and_b32 v57, s54, v248
    v_lshlrev_b32 v58, 16, v249
    v_and_b32 v59, s54, v249
    v_lshlrev_b32 v60, 16, v250
    v_and_b32 v61, s54, v250
    v_lshlrev_b32 v62, 16, v251
    v_and_b32 v63, s54, v251
    v_pk_fma_f32 v[56:57], v[56:57], v[50:51], v[52:53]
    v_pk_fma_f32 v[58:59], v[58:59], v[50:51], v[52:53]
    v_pk_fma_f32 v[60:61], v[60:61], v[50:51], v[52:53]
    v_pk_fma_f32 v[62:63], v[62:63], v[50:51], v[52:53]
    v_cvt_pk_bf16_f32 v248, v56, v57
    v_cvt_pk_bf16_f32 v249, v58, v59
    v_cvt_pk_bf16_f32 v250, v60, v61
    v_cvt_pk_bf16_f32 v251, v62, v63
    v_lshlrev_b32 v56, 16, v252
    v_and_b32 v57, s54, v252
    v_lshlrev_b32 v58, 16, v253
    v_and_b32 v59, s54, v253
    v_lshlrev_b32 v60, 16, v254
    v_and_b32 v61, s54, v254
    v_lshlrev_b32 v62, 16, v255
    v_and_b32 v63, s54, v255
    v_pk_fma_f32 v[56:57], v[56:57], v[50:51], v[52:53]
    v_pk_fma_f32 v[58:59], v[58:59], v[50:51], v[52:53]
    v_pk_fma_f32 v[60:61], v[60:61], v[50:51], v[52:53]
    v_pk_fma_f32 v[62:63], v[62:63], v[50:51], v[52:53]
    v_cvt_pk_bf16_f32 v252, v56, v57
    v_cvt_pk_bf16_f32 v253, v58, v59
    v_cvt_pk_bf16_f32 v254, v60, v61
    v_cvt_pk_bf16_f32 v255, v62, v63
    v_lshrrev_b32 v14, 3, v1
    v_bfe_u32 v15, v1, 1, 2
    v_and_b32 v13, 1, v1
    v_lshlrev_b32 v13, 4, v13
    v_and_b32 v5, 2, v14
    v_xor_b32 v5, v15, v5
    v_lshrrev_b32 v4, 1, v5
    v_mul_u32_u24 v4, 36, v4
    v_and_b32 v5, 1, v5
    v_lshl_add_u32 v4, v5, 5, v4
    v_and_b32 v5, v5, v1
    v_lshl_add_u32 v4, v5, 30, v4
    v_mul_u32_u24 v5, 1152, v14
    v_add3_u32 v6, v5, v4, v13
    v_lshrrev_b32 v2, 2, v1
    v_mul_u32_u24 v2, 9216, v2
    v_and_b32 v3, 3, v1
    v_lshl_add_u32 v7, v3, 4, v2
    v_xor_b32 v8, 32, v7
    v_bfe_u32 v5, v14, 1, 1
    v_xor_b32 v5, v15, v5
    v_lshl_add_u32 v5, v5, 5, v13
    v_mul_u32_u24 v4, 9216, v14
    v_add_u32 v9, v4, v5
    v_add_u32 v9, 4096, v9
    v_add_u32 v10, 72704, v9
    s_mul_i32 s64, s64, 589824
    s_mul_i32 s65, s65, 589824
    s_mul_i32 s66, s66, 589824
    s_mul_i32 s67, s67, 589824
    s_mul_i32 s68, s68, 589824
    s_mul_i32 s69, s69, 589824
    s_mul_i32 s70, s70, 589824
    s_mul_i32 s71, s71, 589824
    s_mul_i32 s72, s72, 589824
    s_mov_b32 s60, -1
    s_mov_b32 s61, 0
    s_cmp_ge_u32 s38, 2
    s_cbranch_scc1 L_g_nokv
    v_lshrrev_b32 v2, 5, v1
    v_lshlrev_b32 v2, 3, v2
    v_bfe_u32 v3, v1, 2, 2
    v_add_u32 v2, v2, v3
    v_lshlrev_b32 v2, 6, v2
    v_bfe_u32 v3, v1, 4, 1
    v_lshl_add_u32 v2, v3, 5, v2
    v_and_b32 v3, 3, v1
    v_lshl_add_u32 v2, v3, 3, v2
    v_add_u32 v2, 115712, v2
    s_lshl_b32 s43, s36, 11
    s_add_u32 s43, s43, 152576
    v_add_u32 v3, s43, v11
    v_mov_b32 v5, v3
    s_cmp_eq_u32 s38, 1
    s_cbranch_scc1 L_g_v
    ds_read_b64_tr_b16 v[16:17], v2 offset:0
    ds_read_b64_tr_b16 v[18:19], v2 offset:256
    ds_read_b64_tr_b16 v[20:21], v2 offset:1024
    ds_read_b64_tr_b16 v[22:23], v2 offset:1280
    ds_read_b64_tr_b16 v[24:25], v2 offset:2048
    ds_read_b64_tr_b16 v[26:27], v2 offset:2304
    ds_read_b64_tr_b16 v[28:29], v2 offset:3072
    ds_read_b64_tr_b16 v[30:31], v2 offset:3328
    ds_read_b64_tr_b16 v[32:33], v2 offset:4096
    ds_read_b64_tr_b16 v[34:35], v2 offset:4352
    ds_read_b64_tr_b16 v[36:37], v2 offset:5120
    ds_read_b64_tr_b16 v[38:39], v2 offset:5376
    s_waitcnt lgkmcnt(10)
    v_mfma_f32_32x32x16_bf16 v[48:63], v[16:19], v[112:115], 0
    ds_read_b64_tr_b16 v[40:41], v2 offset:6144
    ds_read_b64_tr_b16 v[42:43], v2 offset:6400
    s_waitcnt lgkmcnt(10)
    v_mfma_f32_32x32x16_bf16 v[48:63], v[20:23], v[116:119], v[48:63]
    ds_read_b64_tr_b16 v[44:45], v2 offset:7168
    ds_read_b64_tr_b16 v[46:47], v2 offset:7424
    s_waitcnt lgkmcnt(10)
    v_mfma_f32_32x32x16_bf16 v[48:63], v[24:27], v[120:123], v[48:63]
    ds_read_b64_tr_b16 v[16:17], v2 offset:8192
    ds_read_b64_tr_b16 v[18:19], v2 offset:8448
    s_waitcnt lgkmcnt(10)
    v_mfma_f32_32x32x16_bf16 v[48:63], v[28:31], v[124:127], v[48:63]
    ds_read_b64_tr_b16 v[20:21], v2 offset:9216
    ds_read_b64_tr_b16 v[22:23], v2 offset:9472
    s_waitcnt lgkmcnt(10)
    v_mfma_f32_32x32x16_bf16 v[48:63], v[32:35], v[128:131], v[48:63]
    ds_read_b64_tr_b16 v[24:25], v2 offset:10240
    ds_read_b64_tr_b16 v[26:27], v2 offset:10496
    s_waitcnt lgkmcnt(10)
    v_mfma_f32_32x32x16_bf16 v[48:63], v[36:39], v[132:135], v[48:63]
    ds_read_b64_tr_b16 v[28:29], v2 offset:11264
    ds_read_b64_tr_b16 v[30:31], v2 offset:11520
    s_waitcnt lgkmcnt(10)
    v_mfma_f32_32x32x16_bf16 v[48:63], v[40:43], v[136:139], v[48:63]
    ds_read_b64_tr_b16 v[32:33], v2 offset:12288
    ds_read_b64_tr_b16 v[34:35], v2 offset:12544
    s_waitcnt lgkmcnt(10)
    v_mfma_f32_32x32x16_bf16 v[48:63], v[44:47], v[140:143], v[48:63]
    ds_read_b64_tr_b16 v[36:37], v2 offset:13312
    ds_read_b64_tr_b16 v[38:39], v2 offset:13568
    s_waitcnt lgkmcnt(10)
    v_mfma_f32_32x32x16_bf16 v[48:63], v[16:19], v[144:147], v[48:63]
    ds_read_b64_tr_b16 v[40:41], v2 offset:14336
    ds_read_b64_tr_b16 v[42:43], v2 offset:14592
    s_waitcnt lgkmcnt(10)
    v_mfma_f32_32x32x16_bf16 v[48:63], v[20:23], v[148:151], v[48:63]
    ds_read_b64_tr_b16 v[44:45], v2 offset:15360
    ds_read_b64_tr_b16 v[46:47], v2 offset:15616
    s_waitcnt lgkmcnt(10)
    v_mfma_f32_32x32x16_bf16 v[48:63], v[24:27], v[152:155], v[48:63]
    ds_read_b64_tr_b16 v[16:17], v2 offset:16384
    ds_read_b64_tr_b16 v[18:19], v2 offset:16640
    s_waitcnt lgkmcnt(10)
    v_mfma_f32_32x32x16_bf16 v[48:63], v[28:31], v[156:159], v[48:63]
    ds_read_b64_tr_b16 v[20:21], v2 offset:17408
    ds_read_b64_tr_b16 v[22:23], v2 offset:17664
    s_waitcnt lgkmcnt(10)
    v_mfma_f32_32x32x16_bf16 v[48:63], v[32:35], v[160:163], v[48:63]
    ds_read_b64_tr_b16 v[24:25], v2 offset:18432
    ds_read_b64_tr_b16 v[26:27], v2 offset:18688
    s_waitcnt lgkmcnt(10)
    v_mfma_f32_32x32x16_bf16 v[48:63], v[36:39], v[164:167], v[48:63]
    ds_read_b64_tr_b16 v[28:29], v2 offset:19456
    ds_read_b64_tr_b16 v[30:31], v2 offset:19712
    s_waitcnt lgkmcnt(10)
    v_mfma_f32_32x32x16_bf16 v[48:63], v[40:43], v[168:171], v[48:63]
    ds_read_b64_tr_b16 v[32:33], v2 offset:20480
    ds_read_b64_tr_b16 v[34:35], v2 offset:20736
    s_waitcnt lgkmcnt(10)
    v_mfma_f32_32x32x16_bf16 v[48:63], v[44:47], v[172:175], v[48:63]
    ds_read_b64_tr_b16 v[36:37], v2 offset:21504
    ds_read_b64_tr_b16 v[38:39], v2 offset:21760
    s_waitcnt lgkmcnt(10)
    v_mfma_f32_32x32x16_bf16 v[48:63], v[16:19], v[176:179], v[48:63]
    ds_read_b64_tr_b16 v[40:41], v2 offset:22528
    ds_read_b64_tr_b16 v[42:43], v2 offset:22784
    s_waitcnt lgkmcnt(10)
    v_mfma_f32_32x32x16_bf16 v[48:63], v[20:23], v[180:183], v[48:63]
    ds_read_b64_tr_b16 v[44:45], v2 offset:23552
    ds_read_b64_tr_b16 v[46:47], v2 offset:23808
    s_waitcnt lgkmcnt(10)
    v_mfma_f32_32x32x16_bf16 v[48:63], v[24:27], v[184:187], v[48:63]
    ds_read_b64_tr_b16 v[16:17], v2 offset:24576
    ds_read_b64_tr_b16 v[18:19], v2 offset:24832
    s_waitcnt lgkmcnt(10)
    v_mfma_f32_32x32x16_bf16 v[48:63], v[28:31], v[188:191], v[48:63]
    ds_read_b64_tr_b16 v[20:21], v2 offset:25600
    ds_read_b64_tr_b16 v[22:23], v2 offset:25856
    s_waitcnt lgkmcnt(10)
    v_mfma_f32_32x32x16_bf16 v[48:63], v[32:35], v[192:195], v[48:63]
    ds_read_b64_tr_b16 v[24:25], v2 offset:26624
    ds_read_b64_tr_b16 v[26:27], v2 offset:26880
    s_waitcnt lgkmcnt(10)
    v_mfma_f32_32x32x16_bf16 v[48:63], v[36:39], v[196:199], v[48:63]
    ds_read_b64_tr_b16 v[28:29], v2 offset:27648
    ds_read_b64_tr_b16 v[30:31], v2 offset:27904
    s_waitcnt lgkmcnt(10)
    v_mfma_f32_32x32x16_bf16 v[48:63], v[40:43], v[200:203], v[48:63]
    ds_read_b64_tr_b16 v[32:33], v2 offset:28672
    ds_read_b64_tr_b16 v[34:35], v2 offset:28928
    s_waitcnt lgkmcnt(10)
    v_mfma_f32_32x32x16_bf16 v[48:63], v[44:47], v[204:207], v[48:63]
    ds_read_b64_tr_b16 v[36:37], v2 offset:29696
    ds_read_b64_tr_b16 v[38:39], v2 offset:29952
    s_waitcnt lgkmcnt(10)
    v_mfma_f32_32x32x16_bf16 v[48:63], v[16:19], v[208:211], v[48:63]
    ds_read_b64_tr_b16 v[40:41], v2 offset:30720
    ds_read_b64_tr_b16 v[42:43], v2 offset:30976
    s_waitcnt lgkmcnt(10)
    v_mfma_f32_32x32x16_bf16 v[48:63], v[20:23], v[212:215], v[48:63]
    ds_read_b64_tr_b16 v[44:45], v2 offset:31744
    ds_read_b64_tr_b16 v[46:47], v2 offset:32000
    s_waitcnt lgkmcnt(10)
    v_mfma_f32_32x32x16_bf16 v[48:63], v[24:27], v[216:219], v[48:63]
    ds_read_b64_tr_b16 v[16:17], v2 offset:32768
    ds_read_b64_tr_b16 v[18:19], v2 offset:33024
    s_waitcnt lgkmcnt(10)
    v_mfma_f32_32x32x16_bf16 v[48:63], v[28:31], v[220:223], v[48:63]
    ds_read_b64_tr_b16 v[20:21], v2 offset:33792
    ds_read_b64_tr_b16 v[22:23], v2 offset:34048
    s_waitcnt lgkmcnt(10)
    v_mfma_f32_32x32x16_bf16 v[48:63], v[32:35], v[224:227], v[48:63]
    ds_read_b64_tr_b16 v[24:25], v2 offset:34816
    ds_read_b64_tr_b16 v[26:27], v2 offset:35072
    s_waitcnt lgkmcnt(10)
    v_mfma_f32_32x32x16_bf16 v[48:63], v[36:39], v[228:231], v[48:63]
    ds_read_b64_tr_b16 v[28:29], v2 offset:35840
    ds_read_b64_tr_b16 v[30:31], v2 offset:36096
    s_waitcnt lgkmcnt(10)
    v_mfma_f32_32x32x16_bf16 v[48:63], v[40:43], v[232:235], v[48:63]
    s_waitcnt lgkmcnt(8)
    v_mfma_f32_32x32x16_bf16 v[48:63], v[44:47], v[236:239], v[48:63]
    s_waitcnt lgkmcnt(6)
    v_mfma_f32_32x32x16_bf16 v[48:63], v[16:19], v[240:243], v[48:63]
    s_waitcnt lgkmcnt(4)
    v_mfma_f32_32x32x16_bf16 v[48:63], v[20:23], v[244:247], v[48:63]
    s_waitcnt lgkmcnt(2)
    v_mfma_f32_32x32x16_bf16 v[48:63], v[24:27], v[248:251], v[48:63]
    s_waitcnt lgkmcnt(0)
    v_mfma_f32_32x32x16_bf16 v[48:63], v[28:31], v[252:255], v[48:63]
    s_nop 11
    v_cvt_pk_bf16_f32 v64, v48, v49
    v_cvt_pk_bf16_f32 v65, v50, v51
    v_cvt_pk_bf16_f32 v66, v52, v53
    v_cvt_pk_bf16_f32 v67, v54, v55
    v_cvt_pk_bf16_f32 v68, v56, v57
    ds_write_b128 v3, v[64:67]
    v_mul_f32 v72, v56, v56
    v_fmac_f32 v72, v57, v57
    v_cndmask_b32 v72, 0, v72, s[60:61]
    v_fmac_f32 v72, v48, v48
    v_fmac_f32 v72, v49, v49
    v_fmac_f32 v72, v50, v50
    v_fmac_f32 v72, v51, v51
    v_fmac_f32 v72, v52, v52
    v_fmac_f32 v72, v53, v53
    v_fmac_f32 v72, v54, v54
    v_fmac_f32 v72, v55, v55
    v_mov_b32 v73, v72
    s_nop 1
    v_permlane32_swap_b32 v72, v73
    v_add_f32 v72, v72, v73
    v_mov_b32 v69, v72
    ds_write_b64 v3, v[68:69] offset:1024
    s_branch L_g_kvdone
L_g_v:
    ds_read_b64_tr_b16 v[16:17], v2 offset:0
    ds_read_b64_tr_b16 v[18:19], v2 offset:256
    ds_read_b64_tr_b16 v[20:21], v2 offset:1024
    ds_read_b64_tr_b16 v[22:23], v2 offset:1280
    ds_read_b64_tr_b16 v[24:25], v2 offset:2048
    ds_read_b64_tr_b16 v[26:27], v2 offset:2304
    ds_read_b64_tr_b16 v[28:29], v2 offset:3072
    ds_read_b64_tr_b16 v[30:31], v2 offset:3328
    ds_read_b64_tr_b16 v[32:33], v2 offset:4096
    ds_read_b64_tr_b16 v[34:35], v2 offset:4352
    ds_read_b64_tr_b16 v[36:37], v2 offset:5120
    ds_read_b64_tr_b16 v[38:39], v2 offset:5376
    s_waitcnt lgkmcnt(10)
    v_mfma_f32_32x32x16_bf16 v[48:63], v[112:115], v[16:19], 0
    ds_read_b64_tr_b16 v[40:41], v2 offset:6144
    ds_read_b64_tr_b16 v[42:43], v2 offset:6400
    s_waitcnt lgkmcnt(10)
    v_mfma_f32_32x32x16_bf16 v[48:63], v[116:119], v[20:23], v[48:63]
    ds_read_b64_tr_b16 v[44:45], v2 offset:7168
    ds_read_b64_tr_b16 v[46:47], v2 offset:7424
    s_waitcnt lgkmcnt(10)
    v_mfma_f32_32x32x16_bf16 v[48:63], v[120:123], v[24:27], v[48:63]
    ds_read_b64_tr_b16 v[16:17], v2 offset:8192
    ds_read_b64_tr_b16 v[18:19], v2 offset:8448
    s_waitcnt lgkmcnt(10)
    v_mfma_f32_32x32x16_bf16 v[48:63], v[124:127], v[28:31], v[48:63]
    ds_read_b64_tr_b16 v[20:21], v2 offset:9216
    ds_read_b64_tr_b16 v[22:23], v2 offset:9472
    s_waitcnt lgkmcnt(10)
    v_mfma_f32_32x32x16_bf16 v[48:63], v[128:131], v[32:35], v[48:63]
    ds_read_b64_tr_b16 v[24:25], v2 offset:10240
    ds_read_b64_tr_b16 v[26:27], v2 offset:10496
    s_waitcnt lgkmcnt(10)
    v_mfma_f32_32x32x16_bf16 v[48:63], v[132:135], v[36:39], v[48:63]
    ds_read_b64_tr_b16 v[28:29], v2 offset:11264
    ds_read_b64_tr_b16 v[30:31], v2 offset:11520
    s_waitcnt lgkmcnt(10)
    v_mfma_f32_32x32x16_bf16 v[48:63], v[136:139], v[40:43], v[48:63]
    ds_read_b64_tr_b16 v[32:33], v2 offset:12288
    ds_read_b64_tr_b16 v[34:35], v2 offset:12544
    s_waitcnt lgkmcnt(10)
    v_mfma_f32_32x32x16_bf16 v[48:63], v[140:143], v[44:47], v[48:63]
    ds_read_b64_tr_b16 v[36:37], v2 offset:13312
    ds_read_b64_tr_b16 v[38:39], v2 offset:13568
    s_waitcnt lgkmcnt(10)
    v_mfma_f32_32x32x16_bf16 v[48:63], v[144:147], v[16:19], v[48:63]
    ds_read_b64_tr_b16 v[40:41], v2 offset:14336
    ds_read_b64_tr_b16 v[42:43], v2 offset:14592
    s_waitcnt lgkmcnt(10)
    v_mfma_f32_32x32x16_bf16 v[48:63], v[148:151], v[20:23], v[48:63]
    ds_read_b64_tr_b16 v[44:45], v2 offset:15360
    ds_read_b64_tr_b16 v[46:47], v2 offset:15616
    s_waitcnt lgkmcnt(10)
    v_mfma_f32_32x32x16_bf16 v[48:63], v[152:155], v[24:27], v[48:63]
    ds_read_b64_tr_b16 v[16:17], v2 offset:16384
    ds_read_b64_tr_b16 v[18:19], v2 offset:16640
    s_waitcnt lgkmcnt(10)
    v_mfma_f32_32x32x16_bf16 v[48:63], v[156:159], v[28:31], v[48:63]
    ds_read_b64_tr_b16 v[20:21], v2 offset:17408
    ds_read_b64_tr_b16 v[22:23], v2 offset:17664
    s_waitcnt lgkmcnt(10)
    v_mfma_f32_32x32x16_bf16 v[48:63], v[160:163], v[32:35], v[48:63]
    ds_read_b64_tr_b16 v[24:25], v2 offset:18432
    ds_read_b64_tr_b16 v[26:27], v2 offset:18688
    s_waitcnt lgkmcnt(10)
    v_mfma_f32_32x32x16_bf16 v[48:63], v[164:167], v[36:39], v[48:63]
    ds_read_b64_tr_b16 v[28:29], v2 offset:19456
    ds_read_b64_tr_b16 v[30:31], v2 offset:19712
    s_waitcnt lgkmcnt(10)
    v_mfma_f32_32x32x16_bf16 v[48:63], v[168:171], v[40:43], v[48:63]
    ds_read_b64_tr_b16 v[32:33], v2 offset:20480
    ds_read_b64_tr_b16 v[34:35], v2 offset:20736
    s_waitcnt lgkmcnt(10)
    v_mfma_f32_32x32x16_bf16 v[48:63], v[172:175], v[44:47], v[48:63]
    ds_read_b64_tr_b16 v[36:37], v2 offset:21504
    ds_read_b64_tr_b16 v[38:39], v2 offset:21760
    s_waitcnt lgkmcnt(10)
    v_mfma_f32_32x32x16_bf16 v[48:63], v[176:179], v[16:19], v[48:63]
    ds_read_b64_tr_b16 v[40:41], v2 offset:22528
    ds_read_b64_tr_b16 v[42:43], v2 offset:22784
    s_waitcnt lgkmcnt(10)
    v_mfma_f32_32x32x16_bf16 v[48:63], v[180:183], v[20:23], v[48:63]
    ds_read_b64_tr_b16 v[44:45], v2 offset:23552
    ds_read_b64_tr_b16 v[46:47], v2 offset:23808
    s_waitcnt lgkmcnt(10)
    v_mfma_f32_32x32x16_bf16 v[48:63], v[184:187], v[24:27], v[48:63]
    ds_read_b64_tr_b16 v[16:17], v2 offset:24576
    ds_read_b64_tr_b16 v[18:19], v2 offset:24832
    s_waitcnt lgkmcnt(10)
    v_mfma_f32_32x32x16_bf16 v[48:63], v[188:191], v[28:31], v[48:63]
    ds_read_b64_tr_b16 v[20:21], v2 offset:25600
    ds_read_b64_tr_b16 v[22:23], v2 offset:25856
    s_waitcnt lgkmcnt(10)
    v_mfma_f32_32x32x16_bf16 v[48:63], v[192:195], v[32:35], v[48:63]
    ds_read_b64_tr_b16 v[24:25], v2 offset:26624
    ds_read_b64_tr_b16 v[26:27], v2 offset:26880
    s_waitcnt lgkmcnt(10)
    v_mfma_f32_32x32x16_bf16 v[48:63], v[196:199], v[36:39], v[48:63]
    ds_read_b64_tr_b16 v[28:29], v2 offset:27648
    ds_read_b64_tr_b16 v[30:31], v2 offset:27904
    s_waitcnt lgkmcnt(10)
    v_mfma_f32_32x32x16_bf16 v[48:63], v[200:203], v[40:43], v[48:63]
    ds_read_b64_tr_b16 v[32:33], v2 offset:28672
    ds_read_b64_tr_b16 v[34:35], v2 offset:28928
    s_waitcnt lgkmcnt(10)
    v_mfma_f32_32x32x16_bf16 v[48:63], v[204:207], v[44:47], v[48:63]
    ds_read_b64_tr_b16 v[36:37], v2 offset:29696
    ds_read_b64_tr_b16 v[38:39], v2 offset:29952
    s_waitcnt lgkmcnt(10)
    v_mfma_f32_32x32x16_bf16 v[48:63], v[208:211], v[16:19], v[48:63]
    ds_read_b64_tr_b16 v[40:41], v2 offset:30720
    ds_read_b64_tr_b16 v[42:43], v2 offset:30976
    s_waitcnt lgkmcnt(10)
    v_mfma_f32_32x32x16_bf16 v[48:63], v[212:215], v[20:23], v[48:63]
    ds_read_b64_tr_b16 v[44:45], v2 offset:31744
    ds_read_b64_tr_b16 v[46:47], v2 offset:32000
    s_waitcnt lgkmcnt(10)
    v_mfma_f32_32x32x16_bf16 v[48:63], v[216:219], v[24:27], v[48:63]
    ds_read_b64_tr_b16 v[16:17], v2 offset:32768
    ds_read_b64_tr_b16 v[18:19], v2 offset:33024
    s_waitcnt lgkmcnt(10)
    v_mfma_f32_32x32x16_bf16 v[48:63], v[220:223], v[28:31], v[48:63]
    ds_read_b64_tr_b16 v[20:21], v2 offset:33792
    ds_read_b64_tr_b16 v[22:23], v2 offset:34048
    s_waitcnt lgkmcnt(10)
    v_mfma_f32_32x32x16_bf16 v[48:63], v[224:227], v[32:35], v[48:63]
    ds_read_b64_tr_b16 v[24:25], v2 offset:34816
    ds_read_b64_tr_b16 v[26:27], v2 offset:35072
    s_waitcnt lgkmcnt(10)
    v_mfma_f32_32x32x16_bf16 v[48:63], v[228:231], v[36:39], v[48:63]
    ds_read_b64_tr_b16 v[28:29], v2 offset:35840
    ds_read_b64_tr_b16 v[30:31], v2 offset:36096
    s_waitcnt lgkmcnt(10)
    v_mfma_f32_32x32x16_bf16 v[48:63], v[232:235], v[40:43], v[48:63]
    s_waitcnt lgkmcnt(8)
    v_mfma_f32_32x32x16_bf16 v[48:63], v[236:239], v[44:47], v[48:63]
    s_waitcnt lgkmcnt(6)
    v_mfma_f32_32x32x16_bf16 v[48:63], v[240:243], v[16:19], v[48:63]
    s_waitcnt lgkmcnt(4)
    v_mfma_f32_32x32x16_bf16 v[48:63], v[244:247], v[20:23], v[48:63]
    s_waitcnt lgkmcnt(2)
    v_mfma_f32_32x32x16_bf16 v[48:63], v[248:251], v[24:27], v[48:63]
    s_waitcnt lgkmcnt(0)
    v_mfma_f32_32x32x16_bf16 v[48:63], v[252:255], v[28:31], v[48:63]
    s_nop 11
    v_cvt_pk_bf16_f32 v64, v48, v49
    v_cvt_pk_bf16_f32 v65, v50, v51
    v_cvt_pk_bf16_f32 v66, v52, v53
    v_cvt_pk_bf16_f32 v67, v54, v55
    v_cvt_pk_bf16_f32 v68, v56, v57
    v_cvt_pk_bf16_f32 v69, v58, v59
    v_cvt_pk_bf16_f32 v70, v60, v61
    v_cvt_pk_bf16_f32 v71, v62, v63
    v_and_b32 v3, 31, v1
    v_cmp_eq_u32 vcc, 18, v3
    v_mov_b32 v4, s53
    s_nop 0
    v_cndmask_b32 v64, v64, v4, vcc
    v_cndmask_b32 v65, v65, v4, vcc
    v_cndmask_b32 v66, v66, v4, vcc
    v_cndmask_b32 v67, v67, v4, vcc
    v_cndmask_b32 v68, v68, v4, vcc
    v_cndmask_b32 v69, v69, v4, vcc
    v_cndmask_b32 v70, v70, v4, vcc
    v_cndmask_b32 v71, v71, v4, vcc
    v_cmp_gt_u32 vcc, 19, v3
    s_nop 1
    v_cndmask_b32 v64, 0, v64, vcc
    v_cndmask_b32 v65, 0, v65, vcc
    v_cndmask_b32 v66, 0, v66, vcc
    v_cndmask_b32 v67, 0, v67, vcc
    v_cndmask_b32 v68, 0, v68, vcc
    v_cndmask_b32 v69, 0, v69, vcc
    v_cndmask_b32 v70, 0, v70, vcc
    v_cndmask_b32 v71, 0, v71, vcc
    ds_write_b128 v5, v[64:67]
    ds_write_b128 v5, v[68:71] offset:1024
L_g_kvdone:
    s_waitcnt lgkmcnt(0)
    s_mov_b64 exec, 1
    ds_add_u32 v0, v0 offset:20
    s_mov_b64 exec, -1
L_g_nokv:
    s_nop 7
    s_nop 7
    v_lshrrev_b32 v13, 5, v1
    v_lshlrev_b32 v2, 10, v13
    v_bfe_u32 v14, v1, 2, 2
    v_lshl_add_u32 v2, v14, 7, v2
    v_and_b32 v15, 2, v14
    v_bfe_u32 v3, v1, 4, 1
    v_xor_b32 v15, v15, v3
    v_lshl_add_u32 v2, v15, 5, v2
    v_and_b32 v15, 3, v1
    v_lshl_add_u32 v2, v15, 3, v2
    v_add_u32 v2, 1024, v2
    v_xor_b32 v3, 64, v2
    v_lshl_add_u32 v4, v13, 3, v14
    v_lshlrev_b32 v4, 6, v4
    v_bfe_u32 v13, v1, 4, 1
    v_mul_u32_u24 v13, 1056, v13
    v_add_u32 v4, v4, v13
    v_add_u32 v4, 1024, v4
    v_lshl_add_u32 v4, v15, 3, v4
    v_xor_b32 v5, 32, v4
    ds_read_b32 v15, v0 offset:8
    s_waitcnt lgkmcnt(0)
L_cl0:
    v_cmp_gt_u32 vcc, 16, v15
    s_cbranch_vccz L_cl0_ok
    s_add_u32 s3, s3, 1
    s_cmp_ge_u32 s3, 0x400000
    s_cbranch_scc1 L_cl0_ok
    s_sleep 1
    ds_read_b32 v15, v0 offset:8
    s_waitcnt lgkmcnt(0)
    s_branch L_cl0
L_cl0_ok:
    ds_read_b64_tr_b16 v[16:17], v2 offset:0
    ds_read_b64_tr_b16 v[18:19], v2 offset:512
    ds_read_b64_tr_b16 v[20:21], v2 offset:4096
    ds_read_b64_tr_b16 v[22:23], v2 offset:4608
    ds_read_b64_tr_b16 v[24:25], v2 offset:8192
    ds_read_b64_tr_b16 v[26:27], v2 offset:8704
    ds_read_b64_tr_b16 v[28:29], v2 offset:12288
    ds_read_b64_tr_b16 v[30:31], v2 offset:12800
    ds_read_b64_tr_b16 v[32:33], v3 offset:0
    ds_read_b64_tr_b16 v[34:35], v3 offset:512
    ds_read_b64_tr_b16 v[36:37], v3 offset:4096
    ds_read_b64_tr_b16 v[38:39], v3 offset:4608
    s_waitcnt lgkmcnt(8)
    v_mfma_f32_32x32x16_bf16 v[48:63], v[16:19], v[112:115], 0
    ds_read_b64_tr_b16 v[40:41], v3 offset:8192
    ds_read_b64_tr_b16 v[42:43], v3 offset:8704
    v_mfma_f32_32x32x16_bf16 v[48:63], v[20:23], v[116:119], v[48:63]
    ds_read_b64_tr_b16 v[44:45], v3 offset:12288
    ds_read_b64_tr_b16 v[46:47], v3 offset:12800
    s_waitcnt lgkmcnt(8)
    v_mfma_f32_32x32x16_bf16 v[48:63], v[24:27], v[120:123], v[48:63]
    ds_read_b64_tr_b16 v[16:17], v2 offset:2048
    ds_read_b64_tr_b16 v[18:19], v2 offset:2560
    v_mfma_f32_32x32x16_bf16 v[48:63], v[28:31], v[124:127], v[48:63]
    ds_read_b64_tr_b16 v[20:21], v2 offset:6144
    ds_read_b64_tr_b16 v[22:23], v2 offset:6656
    s_waitcnt lgkmcnt(8)
    v_mfma_f32_32x32x16_bf16 v[64:79], v[32:35], v[112:115], 0
    ds_read_b64_tr_b16 v[24:25], v2 offset:10240
    ds_read_b64_tr_b16 v[26:27], v2 offset:10752
    v_mfma_f32_32x32x16_bf16 v[64:79], v[36:39], v[116:119], v[64:79]
    ds_read_b64_tr_b16 v[28:29], v2 offset:14336
    ds_read_b64_tr_b16 v[30:31], v2 offset:14848
    s_waitcnt lgkmcnt(8)
    v_mfma_f32_32x32x16_bf16 v[64:79], v[40:43], v[120:123], v[64:79]
    ds_read_b64_tr_b16 v[32:33], v3 offset:2048
    ds_read_b64_tr_b16 v[34:35], v3 offset:2560
    v_mfma_f32_32x32x16_bf16 v[64:79], v[44:47], v[124:127], v[64:79]
    ds_read_b64_tr_b16 v[36:37], v3 offset:6144
    ds_read_b64_tr_b16 v[38:39], v3 offset:6656
    s_waitcnt lgkmcnt(8)
    v_mfma_f32_32x32x16_bf16 v[48:63], v[16:19], v[128:131], v[48:63]
    ds_read_b64_tr_b16 v[40:41], v3 offset:10240
    ds_read_b64_tr_b16 v[42:43], v3 offset:10752
    v_mfma_f32_32x32x16_bf16 v[48:63], v[20:23], v[132:135], v[48:63]
    ds_read_b64_tr_b16 v[44:45], v3 offset:14336
    ds_read_b64_tr_b16 v[46:47], v3 offset:14848
    s_waitcnt lgkmcnt(8)
    v_mfma_f32_32x32x16_bf16 v[48:63], v[24:27], v[136:139], v[48:63]
    ds_read_b64_tr_b16 v[16:17], v2 offset:16384
    ds_read_b64_tr_b16 v[18:19], v2 offset:16896
    v_mfma_f32_32x32x16_bf16 v[48:63], v[28:31], v[140:143], v[48:63]
    ds_read_b64_tr_b16 v[20:21], v2 offset:20480
    ds_read_b64_tr_b16 v[22:23], v2 offset:20992
    s_waitcnt lgkmcnt(8)
    v_mfma_f32_32x32x16_bf16 v[64:79], v[32:35], v[128:131], v[64:79]
    ds_read_b64_tr_b16 v[24:25], v2 offset:24576
    ds_read_b64_tr_b16 v[26:27], v2 offset:25088
    v_mfma_f32_32x32x16_bf16 v[64:79], v[36:39], v[132:135], v[64:79]
    ds_read_b64_tr_b16 v[28:29], v2 offset:28672
    ds_read_b64_tr_b16 v[30:31], v2 offset:29184
    s_waitcnt lgkmcnt(8)
    v_mfma_f32_32x32x16_bf16 v[64:79], v[40:43], v[136:139], v[64:79]
    ds_read_b64_tr_b16 v[32:33], v3 offset:16384
    ds_read_b64_tr_b16 v[34:35], v3 offset:16896
    v_mfma_f32_32x32x16_bf16 v[64:79], v[44:47], v[140:143], v[64:79]
    ds_read_b64_tr_b16 v[36:37], v3 offset:20480
    ds_read_b64_tr_b16 v[38:39], v3 offset:20992
    s_mov_b64 exec, 1
    ds_add_u32 v0, v0 offset:0
    s_mov_b64 exec, -1
    s_waitcnt lgkmcnt(9)
    v_mfma_f32_32x32x16_bf16 v[48:63], v[16:19], v[144:147], v[48:63]
    ds_read_b64_tr_b16 v[40:41], v3 offset:24576
    ds_read_b64_tr_b16 v[42:43], v3 offset:25088
    v_mfma_f32_32x32x16_bf16 v[48:63], v[20:23], v[148:151], v[48:63]
    ds_read_b64_tr_b16 v[44:45], v3 offset:28672
    ds_read_b64_tr_b16 v[46:47], v3 offset:29184
    s_waitcnt lgkmcnt(9)
    v_mfma_f32_32x32x16_bf16 v[48:63], v[24:27], v[152:155], v[48:63]
    ds_read_b64_tr_b16 v[16:17], v2 offset:18432
    ds_read_b64_tr_b16 v[18:19], v2 offset:18944
    v_mfma_f32_32x32x16_bf16 v[48:63], v[28:31], v[156:159], v[48:63]
    ds_read_b64_tr_b16 v[20:21], v2 offset:22528
    ds_read_b64_tr_b16 v[22:23], v2 offset:23040
    s_waitcnt lgkmcnt(9)
    v_mfma_f32_32x32x16_bf16 v[64:79], v[32:35], v[144:147], v[64:79]
    ds_read_b64_tr_b16 v[24:25], v2 offset:26624
    ds_read_b64_tr_b16 v[26:27], v2 offset:27136
    v_mfma_f32_32x32x16_bf16 v[64:79], v[36:39], v[148:151], v[64:79]
    ds_read_b64_tr_b16 v[28:29], v2 offset:30720
    ds_read_b64_tr_b16 v[30:31], v2 offset:31232
    s_waitcnt lgkmcnt(8)
    v_mfma_f32_32x32x16_bf16 v[64:79], v[40:43], v[152:155], v[64:79]
    ds_read_b32 v15, v0 offset:0
    ds_read_b64_tr_b16 v[32:33], v3 offset:18432
    ds_read_b64_tr_b16 v[34:35], v3 offset:18944
    v_mfma_f32_32x32x16_bf16 v[64:79], v[44:47], v[156:159], v[64:79]
    ds_read_b64_tr_b16 v[36:37], v3 offset:22528
    ds_read_b64_tr_b16 v[38:39], v3 offset:23040
    s_waitcnt lgkmcnt(9)
    v_mfma_f32_32x32x16_bf16 v[48:63], v[16:19], v[160:163], v[48:63]
    ds_read_b64_tr_b16 v[40:41], v3 offset:26624
    ds_read_b64_tr_b16 v[42:43], v3 offset:27136
    v_mfma_f32_32x32x16_bf16 v[48:63], v[20:23], v[164:167], v[48:63]
    s_waitcnt lgkmcnt(6)
L_cg1:
    v_cmp_gt_u32 vcc, 16, v15
    s_cbranch_vccz L_cg1_ok
    s_add_u32 s3, s3, 1
    s_cmp_ge_u32 s3, 0x400000
    s_cbranch_scc1 L_cg1_ok
    ds_read_b32 v15, v0 offset:0
    s_waitcnt lgkmcnt(0)
    s_branch L_cg1
L_cg1_ok:
    ds_read_b32 v15, v0 offset:12
    s_waitcnt lgkmcnt(0)
L_cl1:
    v_cmp_gt_u32 vcc, 16, v15
    s_cbranch_vccz L_cl1_ok
    s_add_u32 s3, s3, 1
    s_cmp_ge_u32 s3, 0x400000
    s_cbranch_scc1 L_cl1_ok
    ds_read_b32 v15, v0 offset:12
    s_waitcnt lgkmcnt(0)
    s_branch L_cl1
L_cl1_ok:
    ds_read_b64_tr_b16 v[44:45], v3 offset:30720
    ds_read_b64_tr_b16 v[46:47], v3 offset:31232
    s_add_u32 s43, s69, s48
    s_add_u32 m0, s45, 0
    s_nop 0
    buffer_load_dwordx4 v7, s[12:15], s43 offen lds
    v_mfma_f32_32x32x16_bf16 v[48:63], v[24:27], v[168:171], v[48:63]
    ds_read_b64_tr_b16 v[16:17], v2 offset:32768
    ds_read_b64_tr_b16 v[18:19], v2 offset:33280
    s_add_u32 m0, s45, 1024
    s_nop 0
    buffer_load_dwordx4 v8, s[16:19], s43 offen lds
    v_mfma_f32_32x32x16_bf16 v[48:63], v[28:31], v[172:175], v[48:63]
    ds_read_b64_tr_b16 v[20:21], v2 offset:36864
    ds_read_b64_tr_b16 v[22:23], v2 offset:37376
    s_add_u32 s43, s70, s48
    s_add_u32 m0, s45, 2048
    s_nop 0
    buffer_load_dwordx4 v7, s[12:15], s43 offen lds
    v_mfma_f32_32x32x16_bf16 v[64:79], v[32:35], v[160:163], v[64:79]
    ds_read_b64_tr_b16 v[24:25], v2 offset:40960
    ds_read_b64_tr_b16 v[26:27], v2 offset:41472
    s_add_u32 m0, s45, 3072
    s_nop 0
    buffer_load_dwordx4 v8, s[16:19], s43 offen lds
    v_mfma_f32_32x32x16_bf16 v[64:79], v[36:39], v[164:167], v[64:79]
    ds_read_b64_tr_b16 v[28:29], v2 offset:45056
    ds_read_b64_tr_b16 v[30:31], v2 offset:45568
    v_mfma_f32_32x32x16_bf16 v[64:79], v[40:43], v[168:171], v[64:79]
    ds_read_b64_tr_b16 v[32:33], v3 offset:32768
    ds_read_b64_tr_b16 v[34:35], v3 offset:33280
    s_waitcnt lgkmcnt(8)
    v_mfma_f32_32x32x16_bf16 v[64:79], v[44:47], v[172:175], v[64:79]
    ds_read_b64_tr_b16 v[36:37], v3 offset:36864
    ds_read_b64_tr_b16 v[38:39], v3 offset:37376
    s_mov_b64 exec, 1
    ds_add_u32 v0, v0 offset:0
    s_mov_b64 exec, -1
    v_mfma_f32_32x32x16_bf16 v[48:63], v[16:19], v[176:179], v[48:63]
    ds_read_b64_tr_b16 v[40:41], v3 offset:40960
    ds_read_b64_tr_b16 v[42:43], v3 offset:41472
    s_waitcnt lgkmcnt(9)
    v_mfma_f32_32x32x16_bf16 v[48:63], v[20:23], v[180:183], v[48:63]
    ds_read_b64_tr_b16 v[44:45], v3 offset:45056
    ds_read_b64_tr_b16 v[46:47], v3 offset:45568
    v_mfma_f32_32x32x16_bf16 v[48:63], v[24:27], v[184:187], v[48:63]
    ds_read_b64_tr_b16 v[16:17], v2 offset:34816
    ds_read_b64_tr_b16 v[18:19], v2 offset:35328
    s_waitcnt lgkmcnt(9)
    v_mfma_f32_32x32x16_bf16 v[48:63], v[28:31], v[188:191], v[48:63]
    ds_read_b64_tr_b16 v[20:21], v2 offset:38912
    ds_read_b64_tr_b16 v[22:23], v2 offset:39424
    v_mfma_f32_32x32x16_bf16 v[64:79], v[32:35], v[176:179], v[64:79]
    ds_read_b64_tr_b16 v[24:25], v2 offset:43008
    ds_read_b64_tr_b16 v[26:27], v2 offset:43520
    s_waitcnt lgkmcnt(8)
    v_mfma_f32_32x32x16_bf16 v[64:79], v[36:39], v[180:183], v[64:79]
    ds_read_b64_tr_b16 v[28:29], v2 offset:47104
    ds_read_b64_tr_b16 v[30:31], v2 offset:47616
    v_mfma_f32_32x32x16_bf16 v[64:79], v[40:43], v[184:187], v[64:79]
    ds_read_b32 v15, v0 offset:0
    ds_read_b64_tr_b16 v[32:33], v3 offset:34816
    ds_read_b64_tr_b16 v[34:35], v3 offset:35328
    s_waitcnt lgkmcnt(9)
    v_mfma_f32_32x32x16_bf16 v[64:79], v[44:47], v[188:191], v[64:79]
    ds_read_b64_tr_b16 v[36:37], v3 offset:38912
    ds_read_b64_tr_b16 v[38:39], v3 offset:39424
    v_mfma_f32_32x32x16_bf16 v[48:63], v[16:19], v[192:195], v[48:63]
    ds_read_b64_tr_b16 v[40:41], v3 offset:43008
    ds_read_b64_tr_b16 v[42:43], v3 offset:43520
    s_waitcnt lgkmcnt(9)
    v_mfma_f32_32x32x16_bf16 v[48:63], v[20:23], v[196:199], v[48:63]
    s_waitcnt lgkmcnt(6)
L_cg2:
    v_cmp_gt_u32 vcc, 32, v15
    s_cbranch_vccz L_cg2_ok
    s_add_u32 s3, s3, 1
    s_cmp_ge_u32 s3, 0x400000
    s_cbranch_scc1 L_cg2_ok
    ds_read_b32 v15, v0 offset:0
    s_waitcnt lgkmcnt(0)
    s_branch L_cg2
L_cg2_ok:
    ds_read_b64_tr_b16 v[44:45], v3 offset:47104
    ds_read_b64_tr_b16 v[46:47], v3 offset:47616
    s_add_u32 s43, s71, s48
    s_add_u32 m0, s45, 16384
    s_nop 0
    buffer_load_dwordx4 v7, s[12:15], s43 offen lds
    v_mfma_f32_32x32x16_bf16 v[48:63], v[24:27], v[200:203], v[48:63]
    ds_read_b64_tr_b16 v[16:17], v2 offset:49152
    ds_read_b64_tr_b16 v[18:19], v2 offset:49664
    s_add_u32 m0, s45, 17408
    s_nop 0
    buffer_load_dwordx4 v8, s[16:19], s43 offen lds
    v_mfma_f32_32x32x16_bf16 v[48:63], v[28:31], v[204:207], v[48:63]
    ds_read_b64_tr_b16 v[20:21], v2 offset:53248
    ds_read_b64_tr_b16 v[22:23], v2 offset:53760
    s_add_u32 s43, s72, s48
    s_add_u32 m0, s45, 18432
    s_nop 0
    buffer_load_dwordx4 v7, s[12:15], s43 offen lds
    s_waitcnt lgkmcnt(8)
    v_mfma_f32_32x32x16_bf16 v[64:79], v[32:35], v[192:195], v[64:79]
    ds_read_b64_tr_b16 v[24:25], v2 offset:57344
    ds_read_b64_tr_b16 v[26:27], v2 offset:57856
    s_add_u32 m0, s45, 19456
    s_nop 0
    buffer_load_dwordx4 v8, s[16:19], s43 offen lds
    v_mfma_f32_32x32x16_bf16 v[64:79], v[36:39], v[196:199], v[64:79]
    ds_read_b64_tr_b16 v[28:29], v2 offset:61440
    ds_read_b64_tr_b16 v[30:31], v2 offset:61952
    s_waitcnt lgkmcnt(8)
    v_mfma_f32_32x32x16_bf16 v[64:79], v[40:43], v[200:203], v[64:79]
    ds_read_b64_tr_b16 v[32:33], v3 offset:49152
    ds_read_b64_tr_b16 v[34:35], v3 offset:49664
    v_mfma_f32_32x32x16_bf16 v[64:79], v[44:47], v[204:207], v[64:79]
    ds_read_b64_tr_b16 v[36:37], v3 offset:53248
    ds_read_b64_tr_b16 v[38:39], v3 offset:53760
    s_mov_b64 exec, 1
    ds_add_u32 v0, v0 offset:0
    s_mov_b64 exec, -1
    s_waitcnt lgkmcnt(9)
    v_mfma_f32_32x32x16_bf16 v[48:63], v[16:19], v[208:211], v[48:63]
    ds_read_b64_tr_b16 v[40:41], v3 offset:57344
    ds_read_b64_tr_b16 v[42:43], v3 offset:57856
    v_mfma_f32_32x32x16_bf16 v[48:63], v[20:23], v[212:215], v[48:63]
    ds_read_b64_tr_b16 v[44:45], v3 offset:61440
    ds_read_b64_tr_b16 v[46:47], v3 offset:61952
    s_waitcnt lgkmcnt(9)
    v_mfma_f32_32x32x16_bf16 v[48:63], v[24:27], v[216:219], v[48:63]
    ds_read_b64_tr_b16 v[16:17], v2 offset:51200
    ds_read_b64_tr_b16 v[18:19], v2 offset:51712
    v_mfma_f32_32x32x16_bf16 v[48:63], v[28:31], v[220:223], v[48:63]
    ds_read_b64_tr_b16 v[20:21], v2 offset:55296
    ds_read_b64_tr_b16 v[22:23], v2 offset:55808
    s_waitcnt lgkmcnt(9)
    v_mfma_f32_32x32x16_bf16 v[64:79], v[32:35], v[208:211], v[64:79]
    ds_read_b64_tr_b16 v[24:25], v2 offset:59392
    ds_read_b64_tr_b16 v[26:27], v2 offset:59904
    v_mfma_f32_32x32x16_bf16 v[64:79], v[36:39], v[212:215], v[64:79]
    ds_read_b64_tr_b16 v[28:29], v2 offset:63488
    ds_read_b64_tr_b16 v[30:31], v2 offset:64000
    s_waitcnt lgkmcnt(8)
    v_mfma_f32_32x32x16_bf16 v[64:79], v[40:43], v[216:219], v[64:79]
    ds_read_b32 v15, v0 offset:0
    ds_read_b64_tr_b16 v[32:33], v3 offset:51200
    ds_read_b64_tr_b16 v[34:35], v3 offset:51712
    v_mfma_f32_32x32x16_bf16 v[64:79], v[44:47], v[220:223], v[64:79]
    ds_read_b64_tr_b16 v[36:37], v3 offset:55296
    ds_read_b64_tr_b16 v[38:39], v3 offset:55808
    s_waitcnt lgkmcnt(9)
    v_mfma_f32_32x32x16_bf16 v[48:63], v[16:19], v[224:227], v[48:63]
    ds_read_b64_tr_b16 v[40:41], v3 offset:59392
    ds_read_b64_tr_b16 v[42:43], v3 offset:59904
    v_mfma_f32_32x32x16_bf16 v[48:63], v[20:23], v[228:231], v[48:63]
    s_waitcnt lgkmcnt(6)
L_cg3:
    v_cmp_gt_u32 vcc, 48, v15
    s_cbranch_vccz L_cg3_ok
    s_add_u32 s3, s3, 1
    s_cmp_ge_u32 s3, 0x400000
    s_cbranch_scc1 L_cg3_ok
    ds_read_b32 v15, v0 offset:0
    s_waitcnt lgkmcnt(0)
    s_branch L_cg3
L_cg3_ok:
    ds_read_b32 v15, v0 offset:16
    s_waitcnt lgkmcnt(0)
L_cl2:
    v_cmp_gt_u32 vcc, 16, v15
    s_cbranch_vccz L_cl2_ok
    s_add_u32 s3, s3, 1
    s_cmp_ge_u32 s3, 0x400000
    s_cbranch_scc1 L_cl2_ok
    ds_read_b32 v15, v0 offset:16
    s_waitcnt lgkmcnt(0)
    s_branch L_cl2
L_cl2_ok:
    ds_read_b64_tr_b16 v[44:45], v3 offset:63488
    ds_read_b64_tr_b16 v[46:47], v3 offset:64000
    v_xor_b32 v7, 64, v9
    v_subrev_u32 v7, 2048, v7
    v_add_u32 v8, 72704, v7
    s_add_u32 m0, s45, 32768
    s_add_u32 s43, s64, s47
    buffer_load_dwordx4 v9, s[12:15], s43 offen offset:0 lds
    v_mfma_f32_32x32x16_bf16 v[48:63], v[24:27], v[232:235], v[48:63]
    v_add_u32 v2, 65536, v2
    v_add_u32 v3, 65536, v3
    v_add_u32 v4, 65536, v4
    v_add_u32 v5, 65536, v5
    ds_read_b64_tr_b16 v[16:17], v2 offset:0
    ds_read_b64_tr_b16 v[18:19], v2 offset:512
    buffer_load_dwordx4 v10, s[12:15], s43 offen offset:1024 lds
    v_mfma_f32_32x32x16_bf16 v[48:63], v[28:31], v[236:239], v[48:63]
    ds_read_b64_tr_b16 v[20:21], v2 offset:4096
    ds_read_b64_tr_b16 v[22:23], v2 offset:4608
    buffer_load_dwordx4 v7, s[16:19], s43 offen offset:2048 lds
    v_mfma_f32_32x32x16_bf16 v[64:79], v[32:35], v[224:227], v[64:79]
    ds_read_b64_tr_b16 v[24:25], v2 offset:8192
    ds_read_b64_tr_b16 v[26:27], v2 offset:8704
    buffer_load_dwordx4 v8, s[16:19], s43 offen offset:3072 lds
    v_mfma_f32_32x32x16_bf16 v[64:79], v[36:39], v[228:231], v[64:79]
    ds_read_b64_tr_b16 v[28:29], v2 offset:12288
    ds_read_b64_tr_b16 v[30:31], v2 offset:12800
    v_mfma_f32_32x32x16_bf16 v[64:79], v[40:43], v[232:235], v[64:79]
    ds_read_b64_tr_b16 v[32:33], v3 offset:0
    ds_read_b64_tr_b16 v[34:35], v3 offset:512
    s_waitcnt lgkmcnt(8)
    v_mfma_f32_32x32x16_bf16 v[64:79], v[44:47], v[236:239], v[64:79]
    ds_read_b64_tr_b16 v[36:37], v3 offset:4096
    ds_read_b64_tr_b16 v[38:39], v3 offset:4608
    s_mov_b64 exec, 1
    ds_add_u32 v0, v0 offset:0
    s_mov_b64 exec, -1
    v_mfma_f32_32x32x16_bf16 v[48:63], v[16:19], v[240:243], v[48:63]
    ds_read_b64_tr_b16 v[40:41], v3 offset:8192
    ds_read_b64_tr_b16 v[42:43], v3 offset:8704
    s_waitcnt lgkmcnt(9)
    v_mfma_f32_32x32x16_bf16 v[48:63], v[20:23], v[244:247], v[48:63]
    ds_read_b64_tr_b16 v[44:45], v3 offset:12288
    ds_read_b64_tr_b16 v[46:47], v3 offset:12800
    v_mfma_f32_32x32x16_bf16 v[48:63], v[24:27], v[248:251], v[48:63]
    ds_read_b64_tr_b16 v[16:17], v4 offset:2048
    ds_read_b64_tr_b16 v[18:19], v4 offset:2304
    s_waitcnt lgkmcnt(9)
    v_mfma_f32_32x32x16_bf16 v[48:63], v[28:31], v[252:255], v[48:63]
    ds_read_b64_tr_b16 v[20:21], v4 offset:6144
    ds_read_b64_tr_b16 v[22:23], v4 offset:6400
    v_mfma_f32_32x32x16_bf16 v[64:79], v[32:35], v[240:243], v[64:79]
    ds_read_b64_tr_b16 v[24:25], v4 offset:10240
    ds_read_b64_tr_b16 v[26:27], v4 offset:10496
    s_nop 6
    v_mul_f32 v48, 0x3eae1a93, v48
    v_mul_f32 v49, 0x3eae1a93, v49
    v_mul_f32 v50, 0x3eae1a93, v50
    v_mul_f32 v51, 0x3eae1a93, v51
    v_mul_f32 v52, 0x3eae1a93, v52
    s_waitcnt lgkmcnt(8)
    v_mfma_f32_32x32x16_bf16 v[64:79], v[36:39], v[244:247], v[64:79]
    ds_read_b64_tr_b16 v[28:29], v4 offset:14336
    ds_read_b64_tr_b16 v[30:31], v4 offset:14592
    v_mul_f32 v53, 0x3eae1a93, v53
    v_mul_f32 v54, 0x3eae1a93, v54
    v_mul_f32 v55, 0x3eae1a93, v55
    v_mul_f32 v56, 0x3eae1a93, v56
    v_mul_f32 v57, 0x3eae1a93, v57
    v_mfma_f32_32x32x16_bf16 v[64:79], v[40:43], v[248:251], v[64:79]
    ds_read_b32 v15, v0 offset:0
    ds_read_b64_tr_b16 v[32:33], v5 offset:2048
    ds_read_b64_tr_b16 v[34:35], v5 offset:2304
    v_mul_f32 v58, v56, v56
    v_fmac_f32 v58, v57, v57
    v_cndmask_b32 v58, 0, v58, s[60:61]
    v_fmac_f32 v58, v48, v48
    v_fmac_f32 v58, v49, v49
    s_waitcnt lgkmcnt(9)
    v_mfma_f32_32x32x16_bf16 v[64:79], v[44:47], v[252:255], v[64:79]
    ds_read_b64_tr_b16 v[36:37], v5 offset:6144
    ds_read_b64_tr_b16 v[38:39], v5 offset:6400
    v_fmac_f32 v58, v50, v50
    v_fmac_f32 v58, v51, v51
    v_fmac_f32 v58, v52, v52
    v_fmac_f32 v58, v53, v53
    v_fmac_f32 v58, v54, v54
    v_mfma_f32_32x32x16_bf16 v[80:95], v[16:19], v[112:115], 0
    ds_read_b64_tr_b16 v[40:41], v5 offset:10240
    ds_read_b64_tr_b16 v[42:43], v5 offset:10496
    v_fmac_f32 v58, v55, v55
    v_mov_b32 v59, v58
    s_nop 1
    v_permlane32_swap_b32 v58, v59
    v_add_f32 v58, v58, v59
    v_sqrt_f32 v58, v58
    s_waitcnt lgkmcnt(9)
    v_mfma_f32_32x32x16_bf16 v[80:95], v[20:23], v[116:119], v[80:95]
    s_waitcnt lgkmcnt(6)
L_cg4:
    v_cmp_gt_u32 vcc, 64, v15
    s_cbranch_vccz L_cg4_ok
    s_add_u32 s3, s3, 1
    s_cmp_ge_u32 s3, 0x400000
    s_cbranch_scc1 L_cg4_ok
    ds_read_b32 v15, v0 offset:0
    s_waitcnt lgkmcnt(0)
    s_branch L_cg4
L_cg4_ok:
    ds_read_b64_tr_b16 v[44:45], v5 offset:14336
    ds_read_b64_tr_b16 v[46:47], v5 offset:14592
    s_add_u32 m0, s45, 49152
    s_add_u32 s43, s65, s47
    buffer_load_dwordx4 v9, s[12:15], s43 offen offset:0 lds
    v_mul_f32 v58, 0xbf820000, v58
    v_cndmask_b32 v58, 0, v58, s[60:61]
    v_cndmask_b32 v56, 0, v56, s[60:61]
    v_cndmask_b32 v57, 0, v57, s[60:61]
    v_mov_b32 v59, 0
    v_mfma_f32_32x32x16_bf16 v[80:95], v[24:27], v[120:123], v[80:95]
    ds_read_b64_tr_b16 v[16:17], v4 offset:16384
    ds_read_b64_tr_b16 v[18:19], v4 offset:16640
    buffer_load_dwordx4 v10, s[12:15], s43 offen offset:1024 lds
    v_cvt_pk_bf16_f32 v60, v48, v49
    v_cvt_pk_bf16_f32 v61, v50, v51
    v_cvt_pk_bf16_f32 v62, v52, v53
    v_cvt_pk_bf16_f32 v63, v54, v55
    v_cvt_pk_bf16_f32 v48, v56, v57
    v_mfma_f32_32x32x16_bf16 v[80:95], v[28:31], v[124:127], v[80:95]
    ds_read_b64_tr_b16 v[20:21], v4 offset:20480
    ds_read_b64_tr_b16 v[22:23], v4 offset:20736
    buffer_load_dwordx4 v7, s[16:19], s43 offen offset:2048 lds
    v_cvt_pk_bf16_f32 v49, v58, v59
    s_mul_i32 s52, s36, 3072
    s_add_u32 s52, s52, 140288
    v_add_u32 v50, s52, v11
    v_lshl_add_u32 v51, v1, 3, s52
    s_waitcnt lgkmcnt(8)
    v_mfma_f32_32x32x16_bf16 v[96:111], v[32:35], v[112:115], 0
    ds_read_b64_tr_b16 v[24:25], v4 offset:24576
    ds_read_b64_tr_b16 v[26:27], v4 offset:24832
    buffer_load_dwordx4 v8, s[16:19], s43 offen offset:3072 lds
    ds_write_b128 v50, v[60:63]
    ds_write_b64 v51, v[48:49] offset:1024
    v_mul_f32 v64, 0x3eae1a93, v64
    v_mul_f32 v65, 0x3eae1a93, v65
    v_mul_f32 v66, 0x3eae1a93, v66
    v_mfma_f32_32x32x16_bf16 v[96:111], v[36:39], v[116:119], v[96:111]
    ds_read_b64_tr_b16 v[28:29], v4 offset:28672
    ds_read_b64_tr_b16 v[30:31], v4 offset:28928
    v_mul_f32 v67, 0x3eae1a93, v67
    v_mul_f32 v68, 0x3eae1a93, v68
    v_mul_f32 v69, 0x3eae1a93, v69
    v_mul_f32 v70, 0x3eae1a93, v70
    v_mul_f32 v71, 0x3eae1a93, v71
    s_waitcnt lgkmcnt(10)
    v_mfma_f32_32x32x16_bf16 v[96:111], v[40:43], v[120:123], v[96:111]
    ds_read_b64_tr_b16 v[32:33], v5 offset:16384
    ds_read_b64_tr_b16 v[34:35], v5 offset:16640
    v_mul_f32 v72, 0x3eae1a93, v72
    v_mul_f32 v73, 0x3eae1a93, v73
    v_mul_f32 v74, v72, v72
    v_fmac_f32 v74, v73, v73
    v_cndmask_b32 v74, 0, v74, s[60:61]
    v_mfma_f32_32x32x16_bf16 v[96:111], v[44:47], v[124:127], v[96:111]
    ds_read_b64_tr_b16 v[36:37], v5 offset:20480
    ds_read_b64_tr_b16 v[38:39], v5 offset:20736
    v_fmac_f32 v74, v64, v64
    v_fmac_f32 v74, v65, v65
    v_fmac_f32 v74, v66, v66
    v_fmac_f32 v74, v67, v67
    v_fmac_f32 v74, v68, v68
    s_mov_b64 exec, 1
    ds_add_u32 v0, v0 offset:0
    s_mov_b64 exec, -1
    s_waitcnt lgkmcnt(11)
    v_mfma_f32_32x32x16_bf16 v[80:95], v[16:19], v[128:131], v[80:95]
    ds_read_b64_tr_b16 v[40:41], v5 offset:24576
    ds_read_b64_tr_b16 v[42:43], v5 offset:24832
    v_fmac_f32 v74, v69, v69
    v_fmac_f32 v74, v70, v70
    v_fmac_f32 v74, v71, v71
    v_mov_b32 v75, v74
    s_nop 1
    v_permlane32_swap_b32 v74, v75
    v_mfma_f32_32x32x16_bf16 v[80:95], v[20:23], v[132:135], v[80:95]
    ds_read_b64_tr_b16 v[44:45], v5 offset:28672
    ds_read_b64_tr_b16 v[46:47], v5 offset:28928
    v_add_f32 v74, v74, v75
    v_sqrt_f32 v74, v74
    s_nop 0
    v_mul_f32 v74, 0xbf820000, v74
    v_cndmask_b32 v74, 0, v74, s[60:61]
    v_cndmask_b32 v72, 0, v72, s[60:61]
    s_waitcnt lgkmcnt(9)
    v_mfma_f32_32x32x16_bf16 v[80:95], v[24:27], v[136:139], v[80:95]
    ds_read_b64_tr_b16 v[16:17], v4 offset:18432
    ds_read_b64_tr_b16 v[18:19], v4 offset:18688
    v_cndmask_b32 v73, 0, v73, s[60:61]
    v_mov_b32 v75, 0
    v_cvt_pk_bf16_f32 v76, v64, v65
    v_cvt_pk_bf16_f32 v77, v66, v67
    v_cvt_pk_bf16_f32 v78, v68, v69
    v_mfma_f32_32x32x16_bf16 v[80:95], v[28:31], v[140:143], v[80:95]
    ds_read_b64_tr_b16 v[20:21], v4 offset:22528
    ds_read_b64_tr_b16 v[22:23], v4 offset:22784
    v_cvt_pk_bf16_f32 v79, v70, v71
    v_cvt_pk_bf16_f32 v64, v72, v73
    v_cvt_pk_bf16_f32 v65, v74, v75
    s_mul_i32 s52, s36, 3072
    s_add_u32 s52, s52, 141824
    s_waitcnt lgkmcnt(9)
    v_mfma_f32_32x32x16_bf16 v[96:111], v[32:35], v[128:131], v[96:111]
    ds_read_b64_tr_b16 v[24:25], v4 offset:26624
    ds_read_b64_tr_b16 v[26:27], v4 offset:26880
    v_add_u32 v66, s52, v11
    v_lshl_add_u32 v67, v1, 3, s52
    ds_write_b128 v66, v[76:79]
    ds_write_b64 v67, v[64:65] offset:1024
    v_mfma_f32_32x32x16_bf16 v[96:111], v[36:39], v[132:135], v[96:111]
    ds_read_b64_tr_b16 v[28:29], v4 offset:30720
    ds_read_b64_tr_b16 v[30:31], v4 offset:30976
    s_waitcnt lgkmcnt(10)
    v_mfma_f32_32x32x16_bf16 v[96:111], v[40:43], v[136:139], v[96:111]
    ds_read_b32 v15, v0 offset:0
    ds_read_b64_tr_b16 v[32:33], v5 offset:18432
    ds_read_b64_tr_b16 v[34:35], v5 offset:18688
    v_mfma_f32_32x32x16_bf16 v[96:111], v[44:47], v[140:143], v[96:111]
    ds_read_b64_tr_b16 v[36:37], v5 offset:22528
    ds_read_b64_tr_b16 v[38:39], v5 offset:22784
    s_waitcnt lgkmcnt(11)
    v_mfma_f32_32x32x16_bf16 v[80:95], v[16:19], v[144:147], v[80:95]
    ds_read_b64_tr_b16 v[40:41], v5 offset:26624
    ds_read_b64_tr_b16 v[42:43], v5 offset:26880
    v_mfma_f32_32x32x16_bf16 v[80:95], v[20:23], v[148:151], v[80:95]
    s_waitcnt lgkmcnt(6)
L_cg5:
    v_cmp_gt_u32 vcc, 80, v15
    s_cbranch_vccz L_cg5_ok
    s_add_u32 s3, s3, 1
    s_cmp_ge_u32 s3, 0x400000
    s_cbranch_scc1 L_cg5_ok
    ds_read_b32 v15, v0 offset:0
    s_waitcnt lgkmcnt(0)
    s_branch L_cg5
L_cg5_ok:
    ds_read_b64_tr_b16 v[44:45], v5 offset:30720
    ds_read_b64_tr_b16 v[46:47], v5 offset:30976
    s_add_u32 m0, s45, 65536
    s_add_u32 s43, s66, s47
    buffer_load_dwordx4 v9, s[12:15], s43 offen offset:0 lds
    v_mfma_f32_32x32x16_bf16 v[80:95], v[24:27], v[152:155], v[80:95]
    ds_read_b64_tr_b16 v[16:17], v4 offset:32768
    ds_read_b64_tr_b16 v[18:19], v4 offset:33024
    buffer_load_dwordx4 v10, s[12:15], s43 offen offset:1024 lds
    v_mfma_f32_32x32x16_bf16 v[80:95], v[28:31], v[156:159], v[80:95]
    ds_read_b64_tr_b16 v[20:21], v4 offset:36864
    ds_read_b64_tr_b16 v[22:23], v4 offset:37120
    buffer_load_dwordx4 v7, s[16:19], s43 offen offset:2048 lds
    s_waitcnt lgkmcnt(8)
    v_mfma_f32_32x32x16_bf16 v[96:111], v[32:35], v[144:147], v[96:111]
    ds_read_b64_tr_b16 v[24:25], v4 offset:40960
    ds_read_b64_tr_b16 v[26:27], v4 offset:41216
    buffer_load_dwordx4 v8, s[16:19], s43 offen offset:3072 lds
    v_mfma_f32_32x32x16_bf16 v[96:111], v[36:39], v[148:151], v[96:111]
    ds_read_b64_tr_b16 v[28:29], v4 offset:45056
    ds_read_b64_tr_b16 v[30:31], v4 offset:45312
    s_waitcnt lgkmcnt(8)
    v_mfma_f32_32x32x16_bf16 v[96:111], v[40:43], v[152:155], v[96:111]
    ds_read_b64_tr_b16 v[32:33], v5 offset:32768
    ds_read_b64_tr_b16 v[34:35], v5 offset:33024
    v_mfma_f32_32x32x16_bf16 v[96:111], v[44:47], v[156:159], v[96:111]
    ds_read_b64_tr_b16 v[36:37], v5 offset:36864
    ds_read_b64_tr_b16 v[38:39], v5 offset:37120
    s_waitcnt vmcnt(16)
    s_mov_b64 exec, 1
    ds_add_u32 v0, v0 offset:0
    s_mov_b64 exec, -1
    s_waitcnt lgkmcnt(9)
    s_setprio 2
    v_mfma_f32_32x32x16_bf16 v[80:95], v[16:19], v[160:163], v[80:95]
    s_setprio 0
    ds_read_b64_tr_b16 v[40:41], v5 offset:40960
    ds_read_b64_tr_b16 v[42:43], v5 offset:41216
    v_mfma_f32_32x32x16_bf16 v[80:95], v[20:23], v[164:167], v[80:95]
    ds_read_b64_tr_b16 v[44:45], v5 offset:45056
    ds_read_b64_tr_b16 v[46:47], v5 offset:45312
    s_waitcnt lgkmcnt(9)
    v_mfma_f32_32x32x16_bf16 v[80:95], v[24:27], v[168:171], v[80:95]
    ds_read_b64_tr_b16 v[16:17], v4 offset:34816
    ds_read_b64_tr_b16 v[18:19], v4 offset:35072
    s_setprio 2
    v_mfma_f32_32x32x16_bf16 v[80:95], v[28:31], v[172:175], v[80:95]
    s_setprio 0
    ds_read_b64_tr_b16 v[20:21], v4 offset:38912
    ds_read_b64_tr_b16 v[22:23], v4 offset:39168
    s_waitcnt lgkmcnt(9)
    v_mfma_f32_32x32x16_bf16 v[96:111], v[32:35], v[160:163], v[96:111]
    ds_read_b64_tr_b16 v[24:25], v4 offset:43008
    ds_read_b64_tr_b16 v[26:27], v4 offset:43264
    v_mfma_f32_32x32x16_bf16 v[96:111], v[36:39], v[164:167], v[96:111]
    ds_read_b64_tr_b16 v[28:29], v4 offset:47104
    ds_read_b64_tr_b16 v[30:31], v4 offset:47360
    s_waitcnt lgkmcnt(8)
    s_setprio 2
    v_mfma_f32_32x32x16_bf16 v[96:111], v[40:43], v[168:171], v[96:111]
    s_setprio 0
    ds_read_b32 v15, v0 offset:0
    ds_read_b64_tr_b16 v[32:33], v5 offset:34816
    ds_read_b64_tr_b16 v[34:35], v5 offset:35072
    v_mfma_f32_32x32x16_bf16 v[96:111], v[44:47], v[172:175], v[96:111]
    ds_read_b64_tr_b16 v[36:37], v5 offset:38912
    ds_read_b64_tr_b16 v[38:39], v5 offset:39168
    s_waitcnt lgkmcnt(9)
    v_mfma_f32_32x32x16_bf16 v[80:95], v[16:19], v[176:179], v[80:95]
    ds_read_b64_tr_b16 v[40:41], v5 offset:43008
    ds_read_b64_tr_b16 v[42:43], v5 offset:43264
    s_setprio 2
    v_mfma_f32_32x32x16_bf16 v[80:95], v[20:23], v[180:183], v[80:95]
    s_setprio 0
    s_setprio 2
    s_waitcnt lgkmcnt(6)
L_cg6:
    v_cmp_gt_u32 vcc, 96, v15
    s_cbranch_vccz L_cg6_ok
    s_add_u32 s3, s3, 1
    s_cmp_ge_u32 s3, 0x400000
    s_cbranch_scc1 L_cg6_ok
    ds_read_b32 v15, v0 offset:0
    s_waitcnt lgkmcnt(0)
    s_branch L_cg6
L_cg6_ok:
    s_setprio 0
    ds_read_b64_tr_b16 v[44:45], v5 offset:47104
    ds_read_b64_tr_b16 v[46:47], v5 offset:47360
    s_add_u32 m0, s45, 81920
    s_add_u32 s43, s67, s47
    buffer_load_dwordx4 v9, s[12:15], s43 offen offset:0 lds
    v_mfma_f32_32x32x16_bf16 v[80:95], v[24:27], v[184:187], v[80:95]
    s_setprio 2
    v_subrev_u32 v2, 65536, v2
    v_subrev_u32 v3, 65536, v3
    v_subrev_u32 v4, 65536, v4
    v_subrev_u32 v5, 65536, v5
    s_setprio 0
    ds_read_b64_tr_b16 v[16:17], v4 offset:0
    ds_read_b64_tr_b16 v[18:19], v4 offset:256
    buffer_load_dwordx4 v10, s[12:15], s43 offen offset:1024 lds
    v_mfma_f32_32x32x16_bf16 v[80:95], v[28:31], v[188:191], v[80:95]
    ds_read_b64_tr_b16 v[20:21], v4 offset:4096
    ds_read_b64_tr_b16 v[22:23], v4 offset:4352
    buffer_load_dwordx4 v7, s[16:19], s43 offen offset:2048 lds
    s_waitcnt lgkmcnt(8)
    s_setprio 2
    v_mfma_f32_32x32x16_bf16 v[96:111], v[32:35], v[176:179], v[96:111]
    s_setprio 0
    ds_read_b64_tr_b16 v[24:25], v4 offset:8192
    ds_read_b64_tr_b16 v[26:27], v4 offset:8448
    buffer_load_dwordx4 v8, s[16:19], s43 offen offset:3072 lds
    v_mfma_f32_32x32x16_bf16 v[96:111], v[36:39], v[180:183], v[96:111]
    ds_read_b64_tr_b16 v[28:29], v4 offset:12288
    ds_read_b64_tr_b16 v[30:31], v4 offset:12544
    s_waitcnt lgkmcnt(8)
    v_mfma_f32_32x32x16_bf16 v[96:111], v[40:43], v[184:187], v[96:111]
    ds_read_b64_tr_b16 v[32:33], v5 offset:0
    ds_read_b64_tr_b16 v[34:35], v5 offset:256
    s_setprio 2
    v_mfma_f32_32x32x16_bf16 v[96:111], v[44:47], v[188:191], v[96:111]
    s_setprio 0
    ds_read_b64_tr_b16 v[36:37], v5 offset:4096
    ds_read_b64_tr_b16 v[38:39], v5 offset:4352
    s_waitcnt vmcnt(16)
    s_mov_b64 exec, 1
    ds_add_u32 v0, v0 offset:0
    s_mov_b64 exec, -1
    s_waitcnt lgkmcnt(9)
    v_mfma_f32_32x32x16_bf16 v[80:95], v[16:19], v[192:195], v[80:95]
    ds_read_b64_tr_b16 v[40:41], v5 offset:8192
    ds_read_b64_tr_b16 v[42:43], v5 offset:8448
    v_mfma_f32_32x32x16_bf16 v[80:95], v[20:23], v[196:199], v[80:95]
    ds_read_b64_tr_b16 v[44:45], v5 offset:12288
    ds_read_b64_tr_b16 v[46:47], v5 offset:12544
    s_waitcnt lgkmcnt(9)
    s_setprio 2
    v_mfma_f32_32x32x16_bf16 v[80:95], v[24:27], v[200:203], v[80:95]
    s_setprio 0
    ds_read_b64_tr_b16 v[16:17], v4 offset:2048
    ds_read_b64_tr_b16 v[18:19], v4 offset:2304
    v_mfma_f32_32x32x16_bf16 v[80:95], v[28:31], v[204:207], v[80:95]
    ds_read_b64_tr_b16 v[20:21], v4 offset:6144
    ds_read_b64_tr_b16 v[22:23], v4 offset:6400
    s_waitcnt lgkmcnt(9)
    v_mfma_f32_32x32x16_bf16 v[96:111], v[32:35], v[192:195], v[96:111]
    ds_read_b64_tr_b16 v[24:25], v4 offset:10240
    ds_read_b64_tr_b16 v[26:27], v4 offset:10496
    s_setprio 2
    v_mfma_f32_32x32x16_bf16 v[96:111], v[36:39], v[196:199], v[96:111]
    s_setprio 0
    ds_read_b64_tr_b16 v[28:29], v4 offset:14336
    ds_read_b64_tr_b16 v[30:31], v4 offset:14592
    s_waitcnt lgkmcnt(8)
    v_mfma_f32_32x32x16_bf16 v[96:111], v[40:43], v[200:203], v[96:111]
    ds_read_b32 v15, v0 offset:0
    ds_read_b64_tr_b16 v[32:33], v5 offset:2048
    ds_read_b64_tr_b16 v[34:35], v5 offset:2304
    v_mfma_f32_32x32x16_bf16 v[96:111], v[44:47], v[204:207], v[96:111]
    ds_read_b64_tr_b16 v[36:37], v5 offset:6144
    ds_read_b64_tr_b16 v[38:39], v5 offset:6400
    s_waitcnt lgkmcnt(9)
    s_setprio 2
    v_mfma_f32_32x32x16_bf16 v[80:95], v[16:19], v[208:211], v[80:95]
    s_setprio 0
    ds_read_b64_tr_b16 v[40:41], v5 offset:10240
    ds_read_b64_tr_b16 v[42:43], v5 offset:10496
    v_mfma_f32_32x32x16_bf16 v[80:95], v[20:23], v[212:215], v[80:95]
    s_setprio 2
    s_waitcnt lgkmcnt(6)
L_cg7:
    v_cmp_gt_u32 vcc, 112, v15
    s_cbranch_vccz L_cg7_ok
    s_add_u32 s3, s3, 1
    s_cmp_ge_u32 s3, 0x400000
    s_cbranch_scc1 L_cg7_ok
    ds_read_b32 v15, v0 offset:0
    s_waitcnt lgkmcnt(0)
    s_branch L_cg7
L_cg7_ok:
    s_setprio 0
    ds_read_b64_tr_b16 v[44:45], v5 offset:14336
    ds_read_b64_tr_b16 v[46:47], v5 offset:14592
    s_add_u32 m0, s45, 98304
    s_add_u32 s43, s68, s47
    buffer_load_dwordx4 v9, s[12:15], s43 offen offset:0 lds
    v_mfma_f32_32x32x16_bf16 v[80:95], v[24:27], v[216:219], v[80:95]
    ds_read_b64_tr_b16 v[16:17], v4 offset:16384
    ds_read_b64_tr_b16 v[18:19], v4 offset:16640
    buffer_load_dwordx4 v10, s[12:15], s43 offen offset:1024 lds
    s_setprio 2
    v_mfma_f32_32x32x16_bf16 v[80:95], v[28:31], v[220:223], v[80:95]
    s_setprio 0
    ds_read_b64_tr_b16 v[20:21], v4 offset:20480
    ds_read_b64_tr_b16 v[22:23], v4 offset:20736
    buffer_load_dwordx4 v7, s[16:19], s43 offen offset:2048 lds
    s_waitcnt lgkmcnt(8)
    v_mfma_f32_32x32x16_bf16 v[96:111], v[32:35], v[208:211], v[96:111]
    ds_read_b64_tr_b16 v[24:25], v4 offset:24576
    ds_read_b64_tr_b16 v[26:27], v4 offset:24832
    buffer_load_dwordx4 v8, s[16:19], s43 offen offset:3072 lds
    v_mfma_f32_32x32x16_bf16 v[96:111], v[36:39], v[212:215], v[96:111]
    ds_read_b64_tr_b16 v[28:29], v4 offset:28672
    ds_read_b64_tr_b16 v[30:31], v4 offset:28928
    s_waitcnt lgkmcnt(8)
    s_setprio 2
    v_mfma_f32_32x32x16_bf16 v[96:111], v[40:43], v[216:219], v[96:111]
    s_setprio 0
    ds_read_b64_tr_b16 v[32:33], v5 offset:16384
    ds_read_b64_tr_b16 v[34:35], v5 offset:16640
    v_mfma_f32_32x32x16_bf16 v[96:111], v[44:47], v[220:223], v[96:111]
    ds_read_b64_tr_b16 v[36:37], v5 offset:20480
    ds_read_b64_tr_b16 v[38:39], v5 offset:20736
    s_waitcnt vmcnt(16)
    s_mov_b64 exec, 1
    ds_add_u32 v0, v0 offset:0
    s_mov_b64 exec, -1
    s_waitcnt lgkmcnt(9)
    v_mfma_f32_32x32x16_bf16 v[80:95], v[16:19], v[224:227], v[80:95]
    ds_read_b64_tr_b16 v[40:41], v5 offset:24576
    ds_read_b64_tr_b16 v[42:43], v5 offset:24832
    s_setprio 2
    v_mfma_f32_32x32x16_bf16 v[80:95], v[20:23], v[228:231], v[80:95]
    s_setprio 0
    ds_read_b64_tr_b16 v[44:45], v5 offset:28672
    ds_read_b64_tr_b16 v[46:47], v5 offset:28928
    s_waitcnt lgkmcnt(9)
    v_mfma_f32_32x32x16_bf16 v[80:95], v[24:27], v[232:235], v[80:95]
    ds_read_b64_tr_b16 v[16:17], v4 offset:18432
    ds_read_b64_tr_b16 v[18:19], v4 offset:18688
    v_mfma_f32_32x32x16_bf16 v[80:95], v[28:31], v[236:239], v[80:95]
    ds_read_b64_tr_b16 v[20:21], v4 offset:22528
    ds_read_b64_tr_b16 v[22:23], v4 offset:22784
    s_waitcnt lgkmcnt(9)
    s_setprio 2
    v_mfma_f32_32x32x16_bf16 v[96:111], v[32:35], v[224:227], v[96:111]
    s_setprio 0
    ds_read_b64_tr_b16 v[24:25], v4 offset:26624
    ds_read_b64_tr_b16 v[26:27], v4 offset:26880
    v_mfma_f32_32x32x16_bf16 v[96:111], v[36:39], v[228:231], v[96:111]
    ds_read_b64_tr_b16 v[28:29], v4 offset:30720
    ds_read_b64_tr_b16 v[30:31], v4 offset:30976
    s_waitcnt lgkmcnt(8)
    v_mfma_f32_32x32x16_bf16 v[96:111], v[40:43], v[232:235], v[96:111]
    ds_read_b32 v15, v0 offset:0
    ds_read_b64_tr_b16 v[32:33], v5 offset:18432
    ds_read_b64_tr_b16 v[34:35], v5 offset:18688
    s_setprio 2
    v_mfma_f32_32x32x16_bf16 v[96:111], v[44:47], v[236:239], v[96:111]
    s_setprio 0
    ds_read_b64_tr_b16 v[36:37], v5 offset:22528
    ds_read_b64_tr_b16 v[38:39], v5 offset:22784
    s_waitcnt lgkmcnt(9)
    v_mfma_f32_32x32x16_bf16 v[80:95], v[16:19], v[240:243], v[80:95]
    ds_read_b64_tr_b16 v[40:41], v5 offset:26624
    ds_read_b64_tr_b16 v[42:43], v5 offset:26880
    v_mfma_f32_32x32x16_bf16 v[80:95], v[20:23], v[244:247], v[80:95]
    s_setprio 2
    s_waitcnt lgkmcnt(6)
L_cg8:
    v_cmp_gt_u32 vcc, 128, v15
    s_cbranch_vccz L_cg8_ok
    s_add_u32 s3, s3, 1
    s_cmp_ge_u32 s3, 0x400000
    s_cbranch_scc1 L_cg8_ok
    ds_read_b32 v15, v0 offset:0
    s_waitcnt lgkmcnt(0)
    s_branch L_cg8
L_cg8_ok:
    s_setprio 0
    ds_read_b64_tr_b16 v[44:45], v5 offset:30720
    ds_read_b64_tr_b16 v[46:47], v5 offset:30976
    s_add_u32 m0, s45, 0
    s_add_u32 s43, s69, s47
    buffer_load_dwordx4 v9, s[12:15], s43 offen offset:0 lds
    s_setprio 2
    v_mfma_f32_32x32x16_bf16 v[80:95], v[24:27], v[248:251], v[80:95]
    s_setprio 0
    v_bfe_u32 v13, v1, 4, 1
    v_lshrrev_b32 v14, 5, v1
    v_lshl_add_u32 v14, v13, 1, v14
    v_lshlrev_b32 v2, 10, v14
    v_bfe_u32 v14, v1, 2, 2
    v_lshl_add_u32 v2, v14, 7, v2
    v_lshrrev_b32 v14, 1, v14
    v_lshl_add_u32 v14, v13, 1, v14
    v_lshl_add_u32 v2, v14, 5, v2
    v_and_b32 v14, 3, v1
    v_lshl_add_u32 v2, v14, 3, v2
    v_add_u32 v2, 1024, v2
    v_xor_b32 v3, 32, v2
    v_xor_b32 v4, 64, v2
    v_xor_b32 v5, 96, v2
    ds_read_b64_tr_b16 v[16:17], v2 offset:32768
    ds_read_b64_tr_b16 v[18:19], v2 offset:33280
    buffer_load_dwordx4 v10, s[12:15], s43 offen offset:1024 lds
    v_mfma_f32_32x32x16_bf16 v[80:95], v[28:31], v[252:255], v[80:95]
    ds_read_b64_tr_b16 v[20:21], v2 offset:36864
    ds_read_b64_tr_b16 v[22:23], v2 offset:37376
    buffer_load_dwordx4 v7, s[16:19], s43 offen offset:2048 lds
    s_waitcnt lgkmcnt(8)
    s_setprio 2
    v_mfma_f32_32x32x16_bf16 v[96:111], v[32:35], v[240:243], v[96:111]
    ds_read_b64_tr_b16 v[24:25], v2 offset:40960
    ds_read_b64_tr_b16 v[26:27], v2 offset:41472
    buffer_load_dwordx4 v8, s[16:19], s43 offen offset:3072 lds
    s_nop 2
    v_max_f32 v80, 0, v80
    v_max_f32 v81, 0, v81
    v_max_f32 v82, 0, v82
    v_max_f32 v83, 0, v83
    v_max_f32 v84, 0, v84
    v_mfma_f32_32x32x16_bf16 v[96:111], v[36:39], v[244:247], v[96:111]
    ds_read_b64_tr_b16 v[28:29], v2 offset:45056
    ds_read_b64_tr_b16 v[30:31], v2 offset:45568
    v_max_f32 v85, 0, v85
    v_max_f32 v86, 0, v86
    v_max_f32 v87, 0, v87
    v_mul_f32 v80, v80, v88
    v_mul_f32 v81, v81, v89
    s_waitcnt lgkmcnt(8)
    v_mfma_f32_32x32x16_bf16 v[96:111], v[40:43], v[248:251], v[96:111]
    ds_read_b64_tr_b16 v[32:33], v3 offset:32768
    ds_read_b64_tr_b16 v[34:35], v3 offset:33280
    v_mul_f32 v82, v82, v90
    v_mul_f32 v83, v83, v91
    v_mul_f32 v84, v84, v92
    v_mul_f32 v85, v85, v93
    v_mul_f32 v86, v86, v94
    v_mfma_f32_32x32x16_bf16 v[96:111], v[44:47], v[252:255], v[96:111]
    ds_read_b64_tr_b16 v[36:37], v3 offset:36864
    ds_read_b64_tr_b16 v[38:39], v3 offset:37376
    v_mul_f32 v87, v87, v95
    v_cvt_pk_bf16_f32 v88, v80, v81
    v_cvt_pk_bf16_f32 v89, v82, v83
    v_cvt_pk_bf16_f32 v90, v84, v85
    v_cvt_pk_bf16_f32 v91, v86, v87
    s_waitcnt vmcnt(16)
    s_mov_b64 exec, 1
    ds_add_u32 v0, v0 offset:0
    s_mov_b64 exec, -1
    s_waitcnt lgkmcnt(9)
    v_mfma_f32_32x32x16_bf16 v[48:63], v[16:19], v[112:115], 0
    ds_read_b64_tr_b16 v[40:41], v3 offset:40960
    ds_read_b64_tr_b16 v[42:43], v3 offset:41472
    s_add_u32 s52, s50, 0
    buffer_store_dwordx4 v[88:91], v11, s[24:27], s52 offen sc1
    v_mfma_f32_32x32x16_bf16 v[48:63], v[20:23], v[116:119], v[48:63]
    ds_read_b64_tr_b16 v[44:45], v3 offset:45056
    ds_read_b64_tr_b16 v[46:47], v3 offset:45568
    v_max_f32 v96, 0, v96
    v_max_f32 v97, 0, v97
    s_waitcnt lgkmcnt(9)
    v_mfma_f32_32x32x16_bf16 v[48:63], v[24:27], v[120:123], v[48:63]
    ds_read_b64_tr_b16 v[16:17], v4 offset:32768
    ds_read_b64_tr_b16 v[18:19], v4 offset:33280
    v_max_f32 v98, 0, v98
    v_max_f32 v99, 0, v99
    v_mfma_f32_32x32x16_bf16 v[48:63], v[28:31], v[124:127], v[48:63]
    ds_read_b64_tr_b16 v[20:21], v4 offset:36864
    ds_read_b64_tr_b16 v[22:23], v4 offset:37376
    v_max_f32 v100, 0, v100
    v_max_f32 v101, 0, v101
    s_waitcnt lgkmcnt(9)
    v_mfma_f32_32x32x16_bf16 v[64:79], v[32:35], v[112:115], 0
    ds_read_b64_tr_b16 v[24:25], v4 offset:40960
    ds_read_b64_tr_b16 v[26:27], v4 offset:41472
    v_max_f32 v102, 0, v102
    v_max_f32 v103, 0, v103
    v_mfma_f32_32x32x16_bf16 v[64:79], v[36:39], v[116:119], v[64:79]
    ds_read_b64_tr_b16 v[28:29], v4 offset:45056
    ds_read_b64_tr_b16 v[30:31], v4 offset:45568
    v_mul_f32 v96, v96, v104
    v_mul_f32 v97, v97, v105
    s_waitcnt lgkmcnt(8)
    v_mfma_f32_32x32x16_bf16 v[64:79], v[40:43], v[120:123], v[64:79]
    ds_read_b32 v15, v0 offset:0
    ds_read_b64_tr_b16 v[32:33], v5 offset:32768
    ds_read_b64_tr_b16 v[34:35], v5 offset:33280
    v_mul_f32 v98, v98, v106
    v_mul_f32 v99, v99, v107
    v_mfma_f32_32x32x16_bf16 v[64:79], v[44:47], v[124:127], v[64:79]
    ds_read_b64_tr_b16 v[36:37], v5 offset:36864
    ds_read_b64_tr_b16 v[38:39], v5 offset:37376
    v_mul_f32 v100, v100, v108
    v_mul_f32 v101, v101, v109
    s_waitcnt lgkmcnt(9)
    v_mfma_f32_32x32x16_bf16 v[80:95], v[16:19], v[112:115], 0
    ds_read_b64_tr_b16 v[40:41], v5 offset:40960
    ds_read_b64_tr_b16 v[42:43], v5 offset:41472
    v_mul_f32 v102, v102, v110
    v_mul_f32 v103, v103, v111
    v_mfma_f32_32x32x16_bf16 v[80:95], v[20:23], v[116:119], v[80:95]
    s_waitcnt lgkmcnt(6)
L_cg9:
    v_cmp_gt_u32 vcc, 144, v15
    s_cbranch_vccz L_cg9_ok
    s_add_u32 s3, s3, 1
    s_cmp_ge_u32 s3, 0x400000
    s_cbranch_scc1 L_cg9_ok
    ds_read_b32 v15, v0 offset:0
    s_waitcnt lgkmcnt(0)
    s_branch L_cg9
L_cg9_ok:
    ds_read_b64_tr_b16 v[44:45], v5 offset:45056
    ds_read_b64_tr_b16 v[46:47], v5 offset:45568
    s_add_u32 m0, s45, 16384
    s_add_u32 s43, s70, s47
    buffer_load_dwordx4 v9, s[12:15], s43 offen offset:0 lds
    v_cvt_pk_bf16_f32 v104, v96, v97
    v_cvt_pk_bf16_f32 v105, v98, v99
    v_mfma_f32_32x32x16_bf16 v[80:95], v[24:27], v[120:123], v[80:95]
    ds_read_b64_tr_b16 v[16:17], v2 offset:49152
    ds_read_b64_tr_b16 v[18:19], v2 offset:49664
    buffer_load_dwordx4 v10, s[12:15], s43 offen offset:1024 lds
    v_cvt_pk_bf16_f32 v106, v100, v101
    v_cvt_pk_bf16_f32 v107, v102, v103
    v_mfma_f32_32x32x16_bf16 v[80:95], v[28:31], v[124:127], v[80:95]
    ds_read_b64_tr_b16 v[20:21], v2 offset:53248
    ds_read_b64_tr_b16 v[22:23], v2 offset:53760
    buffer_load_dwordx4 v7, s[16:19], s43 offen offset:2048 lds
    s_add_u32 s52, s50, 1024
    buffer_store_dwordx4 v[104:107], v11, s[24:27], s52 offen sc1
    s_waitcnt lgkmcnt(8)
    s_nop 0
    v_mfma_f32_32x32x16_bf16 v[96:111], v[32:35], v[112:115], 0
    s_setprio 0
    ds_read_b64_tr_b16 v[24:25], v2 offset:57344
    ds_read_b64_tr_b16 v[26:27], v2 offset:57856
    buffer_load_dwordx4 v8, s[16:19], s43 offen offset:3072 lds
    v_mfma_f32_32x32x16_bf16 v[96:111], v[36:39], v[116:119], v[96:111]
    ds_read_b64_tr_b16 v[28:29], v2 offset:61440
    ds_read_b64_tr_b16 v[30:31], v2 offset:61952
    s_waitcnt lgkmcnt(8)
    v_mfma_f32_32x32x16_bf16 v[96:111], v[40:43], v[120:123], v[96:111]
    ds_read_b64_tr_b16 v[32:33], v3 offset:49152
    ds_read_b64_tr_b16 v[34:35], v3 offset:49664
    s_setprio 2
    v_mfma_f32_32x32x16_bf16 v[96:111], v[44:47], v[124:127], v[96:111]
    s_setprio 0
    ds_read_b64_tr_b16 v[36:37], v3 offset:53248
    ds_read_b64_tr_b16 v[38:39], v3 offset:53760
    s_waitcnt vmcnt(18)
    s_mov_b64 exec, 1
    ds_add_u32 v0, v0 offset:0
    s_mov_b64 exec, -1
    s_waitcnt lgkmcnt(9)
    v_mfma_f32_32x32x16_bf16 v[48:63], v[16:19], v[128:131], v[48:63]
    ds_read_b64_tr_b16 v[40:41], v3 offset:57344
    ds_read_b64_tr_b16 v[42:43], v3 offset:57856
    v_mfma_f32_32x32x16_bf16 v[48:63], v[20:23], v[132:135], v[48:63]
    ds_read_b64_tr_b16 v[44:45], v3 offset:61440
    ds_read_b64_tr_b16 v[46:47], v3 offset:61952
    s_waitcnt lgkmcnt(9)
    s_setprio 2
    v_mfma_f32_32x32x16_bf16 v[48:63], v[24:27], v[136:139], v[48:63]
    s_setprio 0
    ds_read_b64_tr_b16 v[16:17], v4 offset:49152
    ds_read_b64_tr_b16 v[18:19], v4 offset:49664
    v_mfma_f32_32x32x16_bf16 v[48:63], v[28:31], v[140:143], v[48:63]
    ds_read_b64_tr_b16 v[20:21], v4 offset:53248
    ds_read_b64_tr_b16 v[22:23], v4 offset:53760
    s_waitcnt lgkmcnt(9)
    v_mfma_f32_32x32x16_bf16 v[64:79], v[32:35], v[128:131], v[64:79]
    ds_read_b64_tr_b16 v[24:25], v4 offset:57344
    ds_read_b64_tr_b16 v[26:27], v4 offset:57856
    s_setprio 2
    v_mfma_f32_32x32x16_bf16 v[64:79], v[36:39], v[132:135], v[64:79]
    s_setprio 0
    ds_read_b64_tr_b16 v[28:29], v4 offset:61440
    ds_read_b64_tr_b16 v[30:31], v4 offset:61952
    s_waitcnt lgkmcnt(8)
    v_mfma_f32_32x32x16_bf16 v[64:79], v[40:43], v[136:139], v[64:79]
    ds_read_b32 v15, v0 offset:0
    ds_read_b64_tr_b16 v[32:33], v5 offset:49152
    ds_read_b64_tr_b16 v[34:35], v5 offset:49664
    v_mfma_f32_32x32x16_bf16 v[64:79], v[44:47], v[140:143], v[64:79]
    ds_read_b64_tr_b16 v[36:37], v5 offset:53248
    ds_read_b64_tr_b16 v[38:39], v5 offset:53760
    s_waitcnt lgkmcnt(9)
    s_setprio 2
    v_mfma_f32_32x32x16_bf16 v[80:95], v[16:19], v[128:131], v[80:95]
    s_setprio 0
    ds_read_b64_tr_b16 v[40:41], v5 offset:57344
    ds_read_b64_tr_b16 v[42:43], v5 offset:57856
    v_mfma_f32_32x32x16_bf16 v[80:95], v[20:23], v[132:135], v[80:95]
    s_setprio 2
    s_waitcnt lgkmcnt(6)
L_cg10:
    v_cmp_gt_u32 vcc, 160, v15
    s_cbranch_vccz L_cg10_ok
    s_add_u32 s3, s3, 1
    s_cmp_ge_u32 s3, 0x400000
    s_cbranch_scc1 L_cg10_ok
    ds_read_b32 v15, v0 offset:0
    s_waitcnt lgkmcnt(0)
    s_branch L_cg10
L_cg10_ok:
    s_setprio 0
    ds_read_b64_tr_b16 v[44:45], v5 offset:61440
    ds_read_b64_tr_b16 v[46:47], v5 offset:61952
    s_add_u32 m0, s45, 32768
    s_add_u32 s43, s71, s47
    buffer_load_dwordx4 v9, s[12:15], s43 offen offset:0 lds
    v_mfma_f32_32x32x16_bf16 v[80:95], v[24:27], v[136:139], v[80:95]
    s_setprio 2
    v_add_u32 v2, 65536, v2
    v_add_u32 v3, 65536, v3
    v_add_u32 v4, 65536, v4
    v_add_u32 v5, 65536, v5
    s_setprio 0
    ds_read_b64_tr_b16 v[16:17], v2 offset:0
    ds_read_b64_tr_b16 v[18:19], v2 offset:512
    buffer_load_dwordx4 v10, s[12:15], s43 offen offset:1024 lds
    s_setprio 2
    v_mfma_f32_32x32x16_bf16 v[80:95], v[28:31], v[140:143], v[80:95]
    s_setprio 0
    ds_read_b64_tr_b16 v[20:21], v2 offset:4096
    ds_read_b64_tr_b16 v[22:23], v2 offset:4608
    buffer_load_dwordx4 v7, s[16:19], s43 offen offset:2048 lds
    s_waitcnt lgkmcnt(8)
    v_mfma_f32_32x32x16_bf16 v[96:111], v[32:35], v[128:131], v[96:111]
    ds_read_b64_tr_b16 v[24:25], v2 offset:8192
    ds_read_b64_tr_b16 v[26:27], v2 offset:8704
    buffer_load_dwordx4 v8, s[16:19], s43 offen offset:3072 lds
    v_mfma_f32_32x32x16_bf16 v[96:111], v[36:39], v[132:135], v[96:111]
    ds_read_b64_tr_b16 v[28:29], v2 offset:12288
    ds_read_b64_tr_b16 v[30:31], v2 offset:12800
    s_waitcnt lgkmcnt(8)
    s_setprio 2
    v_mfma_f32_32x32x16_bf16 v[96:111], v[40:43], v[136:139], v[96:111]
    s_setprio 0
    ds_read_b64_tr_b16 v[32:33], v3 offset:0
    ds_read_b64_tr_b16 v[34:35], v3 offset:512
    v_mfma_f32_32x32x16_bf16 v[96:111], v[44:47], v[140:143], v[96:111]
    ds_read_b64_tr_b16 v[36:37], v3 offset:4096
    ds_read_b64_tr_b16 v[38:39], v3 offset:4608
    s_waitcnt vmcnt(18)
    s_mov_b64 exec, 1
    ds_add_u32 v0, v0 offset:0
    s_mov_b64 exec, -1
    s_waitcnt lgkmcnt(9)
    v_mfma_f32_32x32x16_bf16 v[48:63], v[16:19], v[144:147], v[48:63]
    ds_read_b64_tr_b16 v[40:41], v3 offset:8192
    ds_read_b64_tr_b16 v[42:43], v3 offset:8704
    s_setprio 2
    v_mfma_f32_32x32x16_bf16 v[48:63], v[20:23], v[148:151], v[48:63]
    s_setprio 0
    ds_read_b64_tr_b16 v[44:45], v3 offset:12288
    ds_read_b64_tr_b16 v[46:47], v3 offset:12800
    s_waitcnt lgkmcnt(9)
    v_mfma_f32_32x32x16_bf16 v[48:63], v[24:27], v[152:155], v[48:63]
    ds_read_b64_tr_b16 v[16:17], v4 offset:0
    ds_read_b64_tr_b16 v[18:19], v4 offset:512
    v_mfma_f32_32x32x16_bf16 v[48:63], v[28:31], v[156:159], v[48:63]
    ds_read_b64_tr_b16 v[20:21], v4 offset:4096
    ds_read_b64_tr_b16 v[22:23], v4 offset:4608
    s_waitcnt lgkmcnt(9)
    s_setprio 2
    v_mfma_f32_32x32x16_bf16 v[64:79], v[32:35], v[144:147], v[64:79]
    s_setprio 0
    ds_read_b64_tr_b16 v[24:25], v4 offset:8192
    ds_read_b64_tr_b16 v[26:27], v4 offset:8704
    v_mfma_f32_32x32x16_bf16 v[64:79], v[36:39], v[148:151], v[64:79]
    ds_read_b64_tr_b16 v[28:29], v4 offset:12288
    ds_read_b64_tr_b16 v[30:31], v4 offset:12800
    s_waitcnt lgkmcnt(8)
    v_mfma_f32_32x32x16_bf16 v[64:79], v[40:43], v[152:155], v[64:79]
    ds_read_b32 v15, v0 offset:0
    ds_read_b64_tr_b16 v[32:33], v5 offset:0
    ds_read_b64_tr_b16 v[34:35], v5 offset:512
    s_setprio 2
    v_mfma_f32_32x32x16_bf16 v[64:79], v[44:47], v[156:159], v[64:79]
    s_setprio 0
    ds_read_b64_tr_b16 v[36:37], v5 offset:4096
    ds_read_b64_tr_b16 v[38:39], v5 offset:4608
    s_waitcnt lgkmcnt(9)
    v_mfma_f32_32x32x16_bf16 v[80:95], v[16:19], v[144:147], v[80:95]
    ds_read_b64_tr_b16 v[40:41], v5 offset:8192
    ds_read_b64_tr_b16 v[42:43], v5 offset:8704
    v_mfma_f32_32x32x16_bf16 v[80:95], v[20:23], v[148:151], v[80:95]
    s_setprio 2
    s_waitcnt lgkmcnt(6)
L_cg11:
    v_cmp_gt_u32 vcc, 176, v15
    s_cbranch_vccz L_cg11_ok
    s_add_u32 s3, s3, 1
    s_cmp_ge_u32 s3, 0x400000
    s_cbranch_scc1 L_cg11_ok
    ds_read_b32 v15, v0 offset:0
    s_waitcnt lgkmcnt(0)
    s_branch L_cg11
L_cg11_ok:
    s_setprio 0
    ds_read_b64_tr_b16 v[44:45], v5 offset:12288
    ds_read_b64_tr_b16 v[46:47], v5 offset:12800
    s_add_u32 m0, s45, 49152
    s_add_u32 s43, s72, s47
    s_add_u32 s47, s47, 128
    buffer_load_dwordx4 v9, s[12:15], s43 offen offset:0 lds
    s_setprio 2
    v_mfma_f32_32x32x16_bf16 v[80:95], v[24:27], v[152:155], v[80:95]
    s_setprio 0
    ds_read_b64_tr_b16 v[16:17], v2 offset:16384
    ds_read_b64_tr_b16 v[18:19], v2 offset:16896
    buffer_load_dwordx4 v10, s[12:15], s43 offen offset:1024 lds
    v_mfma_f32_32x32x16_bf16 v[80:95], v[28:31], v[156:159], v[80:95]
    ds_read_b64_tr_b16 v[20:21], v2 offset:20480
    ds_read_b64_tr_b16 v[22:23], v2 offset:20992
    buffer_load_dwordx4 v7, s[16:19], s43 offen offset:2048 lds
    s_waitcnt lgkmcnt(8)
    v_mfma_f32_32x32x16_bf16 v[96:111], v[32:35], v[144:147], v[96:111]
    ds_read_b64_tr_b16 v[24:25], v2 offset:24576
    ds_read_b64_tr_b16 v[26:27], v2 offset:25088
    buffer_load_dwordx4 v8, s[16:19], s43 offen offset:3072 lds
    s_setprio 2
    v_mfma_f32_32x32x16_bf16 v[96:111], v[36:39], v[148:151], v[96:111]
    s_setprio 0
    ds_read_b64_tr_b16 v[28:29], v2 offset:28672
    ds_read_b64_tr_b16 v[30:31], v2 offset:29184
    s_waitcnt lgkmcnt(8)
    v_mfma_f32_32x32x16_bf16 v[96:111], v[40:43], v[152:155], v[96:111]
    ds_read_b64_tr_b16 v[32:33], v3 offset:16384
    ds_read_b64_tr_b16 v[34:35], v3 offset:16896
    v_mfma_f32_32x32x16_bf16 v[96:111], v[44:47], v[156:159], v[96:111]
    ds_read_b64_tr_b16 v[36:37], v3 offset:20480
    ds_read_b64_tr_b16 v[38:39], v3 offset:20992
    s_waitcnt vmcnt(18)
    s_mov_b64 exec, 1
    ds_add_u32 v0, v0 offset:0
    s_mov_b64 exec, -1
    s_waitcnt lgkmcnt(9)
    s_setprio 2
    v_mfma_f32_32x32x16_bf16 v[48:63], v[16:19], v[160:163], v[48:63]
    s_setprio 0
    ds_read_b64_tr_b16 v[40:41], v3 offset:24576
    ds_read_b64_tr_b16 v[42:43], v3 offset:25088
    v_mfma_f32_32x32x16_bf16 v[48:63], v[20:23], v[164:167], v[48:63]
    ds_read_b64_tr_b16 v[44:45], v3 offset:28672
    ds_read_b64_tr_b16 v[46:47], v3 offset:29184
    s_waitcnt lgkmcnt(9)
    v_mfma_f32_32x32x16_bf16 v[48:63], v[24:27], v[168:171], v[48:63]
    ds_read_b64_tr_b16 v[16:17], v4 offset:16384
    ds_read_b64_tr_b16 v[18:19], v4 offset:16896
    s_setprio 2
    v_mfma_f32_32x32x16_bf16 v[48:63], v[28:31], v[172:175], v[48:63]
    s_setprio 0
    ds_read_b64_tr_b16 v[20:21], v4 offset:20480
    ds_read_b64_tr_b16 v[22:23], v4 offset:20992
    s_waitcnt lgkmcnt(9)
    v_mfma_f32_32x32x16_bf16 v[64:79], v[32:35], v[160:163], v[64:79]
    ds_read_b64_tr_b16 v[24:25], v4 offset:24576
    ds_read_b64_tr_b16 v[26:27], v4 offset:25088
    v_mfma_f32_32x32x16_bf16 v[64:79], v[36:39], v[164:167], v[64:79]
    ds_read_b64_tr_b16 v[28:29], v4 offset:28672
    ds_read_b64_tr_b16 v[30:31], v4 offset:29184
    s_waitcnt lgkmcnt(8)
    s_setprio 2
    v_mfma_f32_32x32x16_bf16 v[64:79], v[40:43], v[168:171], v[64:79]
    s_setprio 0
    ds_read_b32 v15, v0 offset:0
    ds_read_b64_tr_b16 v[32:33], v5 offset:16384
    ds_read_b64_tr_b16 v[34:35], v5 offset:16896
    v_mfma_f32_32x32x16_bf16 v[64:79], v[44:47], v[172:175], v[64:79]
    ds_read_b64_tr_b16 v[36:37], v5 offset:20480
    ds_read_b64_tr_b16 v[38:39], v5 offset:20992
    s_waitcnt lgkmcnt(9)
    v_mfma_f32_32x32x16_bf16 v[80:95], v[16:19], v[160:163], v[80:95]
    ds_read_b64_tr_b16 v[40:41], v5 offset:24576
    ds_read_b64_tr_b16 v[42:43], v5 offset:25088
    s_setprio 2
    v_mfma_f32_32x32x16_bf16 v[80:95], v[20:23], v[164:167], v[80:95]
    s_setprio 0
    s_setprio 2
    s_waitcnt lgkmcnt(6)
L_cg12:
    v_cmp_gt_u32 vcc, 192, v15
    s_cbranch_vccz L_cg12_ok
    s_add_u32 s3, s3, 1
    s_cmp_ge_u32 s3, 0x400000
    s_cbranch_scc1 L_cg12_ok
    ds_read_b32 v15, v0 offset:0
    s_waitcnt lgkmcnt(0)
    s_branch L_cg12
L_cg12_ok:
    s_setprio 0
    ds_read_b64_tr_b16 v[44:45], v5 offset:28672
    ds_read_b64_tr_b16 v[46:47], v5 offset:29184
    s_add_u32 m0, s45, 65536
    s_add_u32 s43, s64, s47
    buffer_load_dwordx4 v9, s[12:15], s43 offen offset:0 lds
    v_mfma_f32_32x32x16_bf16 v[80:95], v[24:27], v[168:171], v[80:95]
    ds_read_b64_tr_b16 v[16:17], v2 offset:32768
    ds_read_b64_tr_b16 v[18:19], v2 offset:33280
    buffer_load_dwordx4 v10, s[12:15], s43 offen offset:1024 lds
    v_mfma_f32_32x32x16_bf16 v[80:95], v[28:31], v[172:175], v[80:95]
    ds_read_b64_tr_b16 v[20:21], v2 offset:36864
    ds_read_b64_tr_b16 v[22:23], v2 offset:37376
    buffer_load_dwordx4 v7, s[16:19], s43 offen offset:2048 lds
    s_waitcnt lgkmcnt(8)
    s_setprio 2
    v_mfma_f32_32x32x16_bf16 v[96:111], v[32:35], v[160:163], v[96:111]
    s_setprio 0
    ds_read_b64_tr_b16 v[24:25], v2 offset:40960
    ds_read_b64_tr_b16 v[26:27], v2 offset:41472
    buffer_load_dwordx4 v8, s[16:19], s43 offen offset:3072 lds
    v_mfma_f32_32x32x16_bf16 v[96:111], v[36:39], v[164:167], v[96:111]
    ds_read_b64_tr_b16 v[28:29], v2 offset:45056
    ds_read_b64_tr_b16 v[30:31], v2 offset:45568
    s_waitcnt lgkmcnt(8)
    v_mfma_f32_32x32x16_bf16 v[96:111], v[40:43], v[168:171], v[96:111]
    ds_read_b64_tr_b16 v[32:33], v3 offset:32768
    ds_read_b64_tr_b16 v[34:35], v3 offset:33280
    s_setprio 2
    v_mfma_f32_32x32x16_bf16 v[96:111], v[44:47], v[172:175], v[96:111]
    s_setprio 0
    ds_read_b64_tr_b16 v[36:37], v3 offset:36864
    ds_read_b64_tr_b16 v[38:39], v3 offset:37376
    s_waitcnt vmcnt(18)
    s_mov_b64 exec, 1
    ds_add_u32 v0, v0 offset:0
    s_mov_b64 exec, -1
    s_waitcnt lgkmcnt(9)
    v_mfma_f32_32x32x16_bf16 v[48:63], v[16:19], v[176:179], v[48:63]
    ds_read_b64_tr_b16 v[40:41], v3 offset:40960
    ds_read_b64_tr_b16 v[42:43], v3 offset:41472
    v_mfma_f32_32x32x16_bf16 v[48:63], v[20:23], v[180:183], v[48:63]
    ds_read_b64_tr_b16 v[44:45], v3 offset:45056
    ds_read_b64_tr_b16 v[46:47], v3 offset:45568
    s_waitcnt lgkmcnt(9)
    s_setprio 2
    v_mfma_f32_32x32x16_bf16 v[48:63], v[24:27], v[184:187], v[48:63]
    s_setprio 0
    ds_read_b64_tr_b16 v[16:17], v4 offset:32768
    ds_read_b64_tr_b16 v[18:19], v4 offset:33280
    v_mfma_f32_32x32x16_bf16 v[48:63], v[28:31], v[188:191], v[48:63]
    ds_read_b64_tr_b16 v[20:21], v4 offset:36864
    ds_read_b64_tr_b16 v[22:23], v4 offset:37376
    s_waitcnt lgkmcnt(9)
    v_mfma_f32_32x32x16_bf16 v[64:79], v[32:35], v[176:179], v[64:79]
    ds_read_b64_tr_b16 v[24:25], v4 offset:40960
    ds_read_b64_tr_b16 v[26:27], v4 offset:41472
    s_setprio 2
    v_mfma_f32_32x32x16_bf16 v[64:79], v[36:39], v[180:183], v[64:79]
    s_setprio 0
    ds_read_b64_tr_b16 v[28:29], v4 offset:45056
    ds_read_b64_tr_b16 v[30:31], v4 offset:45568
    s_waitcnt lgkmcnt(8)
    v_mfma_f32_32x32x16_bf16 v[64:79], v[40:43], v[184:187], v[64:79]
    ds_read_b32 v15, v0 offset:0
    ds_read_b64_tr_b16 v[32:33], v5 offset:32768
    ds_read_b64_tr_b16 v[34:35], v5 offset:33280
    v_mfma_f32_32x32x16_bf16 v[64:79], v[44:47], v[188:191], v[64:79]
    ds_read_b64_tr_b16 v[36:37], v5 offset:36864
    ds_read_b64_tr_b16 v[38:39], v5 offset:37376
    s_waitcnt lgkmcnt(9)
    s_setprio 2
    v_mfma_f32_32x32x16_bf16 v[80:95], v[16:19], v[176:179], v[80:95]
    s_setprio 0
    ds_read_b64_tr_b16 v[40:41], v5 offset:40960
    ds_read_b64_tr_b16 v[42:43], v5 offset:41472
    v_mfma_f32_32x32x16_bf16 v[80:95], v[20:23], v[180:183], v[80:95]
    s_setprio 2
    s_waitcnt lgkmcnt(6)
L_cg13:
    v_cmp_gt_u32 vcc, 208, v15
    s_cbranch_vccz L_cg13_ok
    s_add_u32 s3, s3, 1
    s_cmp_ge_u32 s3, 0x400000
    s_cbranch_scc1 L_cg13_ok
    ds_read_b32 v15, v0 offset:0
    s_waitcnt lgkmcnt(0)
    s_branch L_cg13
L_cg13_ok:
    s_setprio 0
    ds_read_b64_tr_b16 v[44:45], v5 offset:45056
    ds_read_b64_tr_b16 v[46:47], v5 offset:45568
    s_add_u32 m0, s45, 81920
    s_add_u32 s43, s65, s47
    buffer_load_dwordx4 v9, s[12:15], s43 offen offset:0 lds
    v_mfma_f32_32x32x16_bf16 v[80:95], v[24:27], v[184:187], v[80:95]
    s_setprio 2
    v_subrev_u32 v2, 65536, v2
    v_subrev_u32 v3, 65536, v3
    v_subrev_u32 v4, 65536, v4
    v_subrev_u32 v5, 65536, v5
    s_setprio 0
    ds_read_b64_tr_b16 v[16:17], v2 offset:0
    ds_read_b64_tr_b16 v[18:19], v2 offset:512
    buffer_load_dwordx4 v10, s[12:15], s43 offen offset:1024 lds
    s_setprio 2
    v_mfma_f32_32x32x16_bf16 v[80:95], v[28:31], v[188:191], v[80:95]
    s_setprio 0
    ds_read_b64_tr_b16 v[20:21], v2 offset:4096
    ds_read_b64_tr_b16 v[22:23], v2 offset:4608
    buffer_load_dwordx4 v7, s[16:19], s43 offen offset:2048 lds
    s_waitcnt lgkmcnt(8)
    v_mfma_f32_32x32x16_bf16 v[96:111], v[32:35], v[176:179], v[96:111]
    ds_read_b64_tr_b16 v[24:25], v2 offset:8192
    ds_read_b64_tr_b16 v[26:27], v2 offset:8704
    buffer_load_dwordx4 v8, s[16:19], s43 offen offset:3072 lds
    v_mfma_f32_32x32x16_bf16 v[96:111], v[36:39], v[180:183], v[96:111]
    ds_read_b64_tr_b16 v[28:29], v2 offset:12288
    ds_read_b64_tr_b16 v[30:31], v2 offset:12800
    s_waitcnt lgkmcnt(8)
    s_setprio 2
    v_mfma_f32_32x32x16_bf16 v[96:111], v[40:43], v[184:187], v[96:111]
    s_setprio 0
    ds_read_b64_tr_b16 v[32:33], v3 offset:0
    ds_read_b64_tr_b16 v[34:35], v3 offset:512
    v_mfma_f32_32x32x16_bf16 v[96:111], v[44:47], v[188:191], v[96:111]
    ds_read_b64_tr_b16 v[36:37], v3 offset:4096
    ds_read_b64_tr_b16 v[38:39], v3 offset:4608
    s_waitcnt vmcnt(16)
    s_mov_b64 exec, 1
    ds_add_u32 v0, v0 offset:0
    s_mov_b64 exec, -1
    s_waitcnt lgkmcnt(9)
    v_mfma_f32_32x32x16_bf16 v[48:63], v[16:19], v[192:195], v[48:63]
    ds_read_b64_tr_b16 v[40:41], v3 offset:8192
    ds_read_b64_tr_b16 v[42:43], v3 offset:8704
    s_setprio 2
    v_mfma_f32_32x32x16_bf16 v[48:63], v[20:23], v[196:199], v[48:63]
    s_setprio 0
    ds_read_b64_tr_b16 v[44:45], v3 offset:12288
    ds_read_b64_tr_b16 v[46:47], v3 offset:12800
    s_waitcnt lgkmcnt(9)
    v_mfma_f32_32x32x16_bf16 v[48:63], v[24:27], v[200:203], v[48:63]
    ds_read_b64_tr_b16 v[16:17], v4 offset:0
    ds_read_b64_tr_b16 v[18:19], v4 offset:512
    v_mfma_f32_32x32x16_bf16 v[48:63], v[28:31], v[204:207], v[48:63]
    ds_read_b64_tr_b16 v[20:21], v4 offset:4096
    ds_read_b64_tr_b16 v[22:23], v4 offset:4608
    s_waitcnt lgkmcnt(9)
    s_setprio 2
    v_mfma_f32_32x32x16_bf16 v[64:79], v[32:35], v[192:195], v[64:79]
    s_setprio 0
    ds_read_b64_tr_b16 v[24:25], v4 offset:8192
    ds_read_b64_tr_b16 v[26:27], v4 offset:8704
    v_mfma_f32_32x32x16_bf16 v[64:79], v[36:39], v[196:199], v[64:79]
    ds_read_b64_tr_b16 v[28:29], v4 offset:12288
    ds_read_b64_tr_b16 v[30:31], v4 offset:12800
    s_waitcnt lgkmcnt(8)
    v_mfma_f32_32x32x16_bf16 v[64:79], v[40:43], v[200:203], v[64:79]
    ds_read_b32 v15, v0 offset:0
    ds_read_b64_tr_b16 v[32:33], v5 offset:0
    ds_read_b64_tr_b16 v[34:35], v5 offset:512
    s_setprio 2
    v_mfma_f32_32x32x16_bf16 v[64:79], v[44:47], v[204:207], v[64:79]
    s_setprio 0
    ds_read_b64_tr_b16 v[36:37], v5 offset:4096
    ds_read_b64_tr_b16 v[38:39], v5 offset:4608
    s_waitcnt lgkmcnt(9)
    v_mfma_f32_32x32x16_bf16 v[80:95], v[16:19], v[192:195], v[80:95]
    ds_read_b64_tr_b16 v[40:41], v5 offset:8192
    ds_read_b64_tr_b16 v[42:43], v5 offset:8704
    v_mfma_f32_32x32x16_bf16 v[80:95], v[20:23], v[196:199], v[80:95]
    s_setprio 2
    s_waitcnt lgkmcnt(6)
L_cg14:
    v_cmp_gt_u32 vcc, 224, v15
    s_cbranch_vccz L_cg14_ok
    s_add_u32 s3, s3, 1
    s_cmp_ge_u32 s3, 0x400000
    s_cbranch_scc1 L_cg14_ok
    ds_read_b32 v15, v0 offset:0
    s_waitcnt lgkmcnt(0)
    s_branch L_cg14
L_cg14_ok:
    s_setprio 0
    ds_read_b64_tr_b16 v[44:45], v5 offset:12288
    ds_read_b64_tr_b16 v[46:47], v5 offset:12800
    s_add_u32 m0, s45, 98304
    s_add_u32 s43, s66, s47
    buffer_load_dwordx4 v9, s[12:15], s43 offen offset:0 lds
    s_setprio 2
    v_mfma_f32_32x32x16_bf16 v[80:95], v[24:27], v[200:203], v[80:95]
    s_setprio 0
    ds_read_b64_tr_b16 v[16:17], v2 offset:16384
    ds_read_b64_tr_b16 v[18:19], v2 offset:16896
    buffer_load_dwordx4 v10, s[12:15], s43 offen offset:1024 lds
    v_mfma_f32_32x32x16_bf16 v[80:95], v[28:31], v[204:207], v[80:95]
    ds_read_b64_tr_b16 v[20:21], v2 offset:20480
    ds_read_b64_tr_b16 v[22:23], v2 offset:20992
    buffer_load_dwordx4 v7, s[16:19], s43 offen offset:2048 lds
    s_waitcnt lgkmcnt(8)
    v_mfma_f32_32x32x16_bf16 v[96:111], v[32:35], v[192:195], v[96:111]
    ds_read_b64_tr_b16 v[24:25], v2 offset:24576
    ds_read_b64_tr_b16 v[26:27], v2 offset:25088
    buffer_load_dwordx4 v8, s[16:19], s43 offen offset:3072 lds
    s_setprio 2
    v_mfma_f32_32x32x16_bf16 v[96:111], v[36:39], v[196:199], v[96:111]
    s_setprio 0
    ds_read_b64_tr_b16 v[28:29], v2 offset:28672
    ds_read_b64_tr_b16 v[30:31], v2 offset:29184
    s_lshr_b32 s73, s38, 2
    s_and_b32 s74, s38, 3
    s_add_u32 s28, s86, 22020096
    s_addc_u32 s29, s87, 0
    s_waitcnt lgkmcnt(8)
    v_mfma_f32_32x32x16_bf16 v[96:111], v[40:43], v[200:203], v[96:111]
    ds_read_b64_tr_b16 v[32:33], v3 offset:16384
    ds_read_b64_tr_b16 v[34:35], v3 offset:16896
    s_mov_b32 s30, 9469952
    s_mov_b32 s31, 0x20000
    s_mul_i32 s63, s36, 5120
    s_add_u32 s63, s63, 1024
    v_mfma_f32_32x32x16_bf16 v[96:111], v[44:47], v[204:207], v[96:111]
    ds_read_b64_tr_b16 v[36:37], v3 offset:20480
    ds_read_b64_tr_b16 v[38:39], v3 offset:20992
    s_mul_i32 s75, s73, 165888
    s_mul_i32 s40, s74, 288
    s_add_u32 s75, s75, s40
    s_add_u32 s40, s74, 0
    s_waitcnt vmcnt(16)
    s_mov_b64 exec, 1
    ds_add_u32 v0, v0 offset:0
    s_mov_b64 exec, -1
    s_waitcnt lgkmcnt(9)
    s_setprio 2
    v_mfma_f32_32x32x16_bf16 v[48:63], v[16:19], v[208:211], v[48:63]
    s_setprio 0
    ds_read_b64_tr_b16 v[40:41], v3 offset:24576
    ds_read_b64_tr_b16 v[42:43], v3 offset:25088
    v_mfma_f32_32x32x16_bf16 v[48:63], v[20:23], v[212:215], v[48:63]
    ds_read_b64_tr_b16 v[44:45], v3 offset:28672
    ds_read_b64_tr_b16 v[46:47], v3 offset:29184
    s_waitcnt lgkmcnt(9)
    v_mfma_f32_32x32x16_bf16 v[48:63], v[24:27], v[216:219], v[48:63]
    ds_read_b64_tr_b16 v[16:17], v4 offset:16384
    ds_read_b64_tr_b16 v[18:19], v4 offset:16896
    s_setprio 2
    v_mfma_f32_32x32x16_bf16 v[48:63], v[28:31], v[220:223], v[48:63]
    s_setprio 0
    ds_read_b64_tr_b16 v[20:21], v4 offset:20480
    ds_read_b64_tr_b16 v[22:23], v4 offset:20992
    s_waitcnt lgkmcnt(9)
    v_mfma_f32_32x32x16_bf16 v[64:79], v[32:35], v[208:211], v[64:79]
    ds_read_b64_tr_b16 v[24:25], v4 offset:24576
    ds_read_b64_tr_b16 v[26:27], v4 offset:25088
    v_mfma_f32_32x32x16_bf16 v[64:79], v[36:39], v[212:215], v[64:79]
    ds_read_b64_tr_b16 v[28:29], v4 offset:28672
    ds_read_b64_tr_b16 v[30:31], v4 offset:29184
    s_waitcnt lgkmcnt(8)
    s_setprio 2
    v_mfma_f32_32x32x16_bf16 v[64:79], v[40:43], v[216:219], v[64:79]
    s_setprio 0
    ds_read_b32 v15, v0 offset:0
    ds_read_b64_tr_b16 v[32:33], v5 offset:16384
    ds_read_b64_tr_b16 v[34:35], v5 offset:16896
    v_mfma_f32_32x32x16_bf16 v[64:79], v[44:47], v[220:223], v[64:79]
    ds_read_b64_tr_b16 v[36:37], v5 offset:20480
    ds_read_b64_tr_b16 v[38:39], v5 offset:20992
    s_waitcnt lgkmcnt(9)
    v_mfma_f32_32x32x16_bf16 v[80:95], v[16:19], v[208:211], v[80:95]
    ds_read_b64_tr_b16 v[40:41], v5 offset:24576
    ds_read_b64_tr_b16 v[42:43], v5 offset:25088
    s_setprio 2
    v_mfma_f32_32x32x16_bf16 v[80:95], v[20:23], v[212:215], v[80:95]
    s_setprio 0
    s_setprio 2
    s_waitcnt lgkmcnt(6)
L_cg15:
    v_cmp_gt_u32 vcc, 240, v15
    s_cbranch_vccz L_cg15_ok
    s_add_u32 s3, s3, 1
    s_cmp_ge_u32 s3, 0x400000
    s_cbranch_scc1 L_cg15_ok
    ds_read_b32 v15, v0 offset:0
    s_waitcnt lgkmcnt(0)
    s_branch L_cg15
L_cg15_ok:
    s_setprio 0
    ds_read_b64_tr_b16 v[44:45], v5 offset:28672
    ds_read_b64_tr_b16 v[46:47], v5 offset:29184
    s_add_u32 m0, s45, 0
    s_add_u32 s43, s67, s47
    buffer_load_dwordx4 v9, s[12:15], s43 offen offset:0 lds
    v_mfma_f32_32x32x16_bf16 v[80:95], v[24:27], v[216:219], v[80:95]
    ds_read_b64_tr_b16 v[16:17], v2 offset:32768
    ds_read_b64_tr_b16 v[18:19], v2 offset:33280
    buffer_load_dwordx4 v10, s[12:15], s43 offen offset:1024 lds
    v_mfma_f32_32x32x16_bf16 v[80:95], v[28:31], v[220:223], v[80:95]
    ds_read_b64_tr_b16 v[20:21], v2 offset:36864
    ds_read_b64_tr_b16 v[22:23], v2 offset:37376
    buffer_load_dwordx4 v7, s[16:19], s43 offen offset:2048 lds
    s_waitcnt lgkmcnt(8)
    s_setprio 2
    v_mfma_f32_32x32x16_bf16 v[96:111], v[32:35], v[208:211], v[96:111]
    s_setprio 0
    ds_read_b64_tr_b16 v[24:25], v2 offset:40960
    ds_read_b64_tr_b16 v[26:27], v2 offset:41472
    buffer_load_dwordx4 v8, s[16:19], s43 offen offset:3072 lds
    v_mfma_f32_32x32x16_bf16 v[96:111], v[36:39], v[212:215], v[96:111]
    ds_read_b64_tr_b16 v[28:29], v2 offset:45056
    ds_read_b64_tr_b16 v[30:31], v2 offset:45568
    s_and_b32 s40, s40, 3
    s_lshl_b32 s41, s73, 2
    s_add_u32 s40, s40, s41
    s_mul_i32 s40, s40, 18432
    s_waitcnt lgkmcnt(8)
    v_mfma_f32_32x32x16_bf16 v[96:111], v[40:43], v[216:219], v[96:111]
    ds_read_b64_tr_b16 v[32:33], v3 offset:32768
    ds_read_b64_tr_b16 v[34:35], v3 offset:33280
    s_add_u32 s76, s40, s51
    s_add_u32 s40, s74, 1
    s_and_b32 s40, s40, 3
    s_lshl_b32 s41, s73, 2
    s_setprio 2
    v_mfma_f32_32x32x16_bf16 v[96:111], v[44:47], v[220:223], v[96:111]
    s_setprio 0
    ds_read_b64_tr_b16 v[36:37], v3 offset:36864
    ds_read_b64_tr_b16 v[38:39], v3 offset:37376
    s_add_u32 s40, s40, s41
    s_mul_i32 s40, s40, 18432
    s_add_u32 s77, s40, s51
    s_add_u32 s40, s74, 2
    s_waitcnt vmcnt(16)
    s_mov_b64 exec, 1
    ds_add_u32 v0, v0 offset:0
    s_mov_b64 exec, -1
    s_waitcnt lgkmcnt(9)
    v_mfma_f32_32x32x16_bf16 v[48:63], v[16:19], v[224:227], v[48:63]
    ds_read_b64_tr_b16 v[40:41], v3 offset:40960
    ds_read_b64_tr_b16 v[42:43], v3 offset:41472
    v_mfma_f32_32x32x16_bf16 v[48:63], v[20:23], v[228:231], v[48:63]
    ds_read_b64_tr_b16 v[44:45], v3 offset:45056
    ds_read_b64_tr_b16 v[46:47], v3 offset:45568
    s_waitcnt lgkmcnt(9)
    s_setprio 2
    v_mfma_f32_32x32x16_bf16 v[48:63], v[24:27], v[232:235], v[48:63]
    s_setprio 0
    ds_read_b64_tr_b16 v[16:17], v4 offset:32768
    ds_read_b64_tr_b16 v[18:19], v4 offset:33280
    v_mfma_f32_32x32x16_bf16 v[48:63], v[28:31], v[236:239], v[48:63]
    ds_read_b64_tr_b16 v[20:21], v4 offset:36864
    ds_read_b64_tr_b16 v[22:23], v4 offset:37376
    s_waitcnt lgkmcnt(9)
    v_mfma_f32_32x32x16_bf16 v[64:79], v[32:35], v[224:227], v[64:79]
    ds_read_b64_tr_b16 v[24:25], v4 offset:40960
    ds_read_b64_tr_b16 v[26:27], v4 offset:41472
    s_setprio 2
    v_mfma_f32_32x32x16_bf16 v[64:79], v[36:39], v[228:231], v[64:79]
    s_setprio 0
    ds_read_b64_tr_b16 v[28:29], v4 offset:45056
    ds_read_b64_tr_b16 v[30:31], v4 offset:45568
    s_waitcnt lgkmcnt(8)
    v_mfma_f32_32x32x16_bf16 v[64:79], v[40:43], v[232:235], v[64:79]
    ds_read_b32 v15, v0 offset:0
    ds_read_b64_tr_b16 v[32:33], v5 offset:32768
    ds_read_b64_tr_b16 v[34:35], v5 offset:33280
    v_mfma_f32_32x32x16_bf16 v[64:79], v[44:47], v[236:239], v[64:79]
    ds_read_b64_tr_b16 v[36:37], v5 offset:36864
    ds_read_b64_tr_b16 v[38:39], v5 offset:37376
    s_waitcnt lgkmcnt(9)
    s_setprio 2
    v_mfma_f32_32x32x16_bf16 v[80:95], v[16:19], v[224:227], v[80:95]
    s_setprio 0
    ds_read_b64_tr_b16 v[40:41], v5 offset:40960
    ds_read_b64_tr_b16 v[42:43], v5 offset:41472
    v_mfma_f32_32x32x16_bf16 v[80:95], v[20:23], v[228:231], v[80:95]
    s_setprio 2
    s_waitcnt lgkmcnt(6)
L_cg16:
    v_cmp_gt_u32 vcc, 256, v15
    s_cbranch_vccz L_cg16_ok
    s_add_u32 s3, s3, 1
    s_cmp_ge_u32 s3, 0x400000
    s_cbranch_scc1 L_cg16_ok
    ds_read_b32 v15, v0 offset:0
    s_waitcnt lgkmcnt(0)
    s_branch L_cg16
L_cg16_ok:
    s_setprio 0
    ds_read_b64_tr_b16 v[44:45], v5 offset:45056
    ds_read_b64_tr_b16 v[46:47], v5 offset:45568
    s_add_u32 m0, s45, 16384
    s_add_u32 s43, s68, s47
    buffer_load_dwordx4 v9, s[12:15], s43 offen offset:0 lds
    v_mfma_f32_32x32x16_bf16 v[80:95], v[24:27], v[232:235], v[80:95]
    ds_read_b64_tr_b16 v[16:17], v2 offset:49152
    ds_read_b64_tr_b16 v[18:19], v2 offset:49664
    buffer_load_dwordx4 v10, s[12:15], s43 offen offset:1024 lds
    s_setprio 2
    v_mfma_f32_32x32x16_bf16 v[80:95], v[28:31], v[236:239], v[80:95]
    s_setprio 0
    ds_read_b64_tr_b16 v[20:21], v2 offset:53248
    ds_read_b64_tr_b16 v[22:23], v2 offset:53760
    buffer_load_dwordx4 v7, s[16:19], s43 offen offset:2048 lds
    s_waitcnt lgkmcnt(8)
    v_mfma_f32_32x32x16_bf16 v[96:111], v[32:35], v[224:227], v[96:111]
    ds_read_b64_tr_b16 v[24:25], v2 offset:57344
    ds_read_b64_tr_b16 v[26:27], v2 offset:57856
    buffer_load_dwordx4 v8, s[16:19], s43 offen offset:3072 lds
    v_mfma_f32_32x32x16_bf16 v[96:111], v[36:39], v[228:231], v[96:111]
    ds_read_b64_tr_b16 v[28:29], v2 offset:61440
    ds_read_b64_tr_b16 v[30:31], v2 offset:61952
    s_and_b32 s40, s40, 3
    s_lshl_b32 s41, s73, 2
    s_add_u32 s40, s40, s41
    s_mul_i32 s40, s40, 18432
    s_waitcnt lgkmcnt(8)
    s_setprio 2
    v_mfma_f32_32x32x16_bf16 v[96:111], v[40:43], v[232:235], v[96:111]
    s_setprio 0
    ds_read_b64_tr_b16 v[32:33], v3 offset:49152
    ds_read_b64_tr_b16 v[34:35], v3 offset:49664
    s_add_u32 s78, s40, s51
    s_add_u32 s40, s74, 3
    s_and_b32 s40, s40, 3
    s_lshl_b32 s41, s73, 2
    v_mfma_f32_32x32x16_bf16 v[96:111], v[44:47], v[236:239], v[96:111]
    ds_read_b64_tr_b16 v[36:37], v3 offset:53248
    ds_read_b64_tr_b16 v[38:39], v3 offset:53760
    s_add_u32 s40, s40, s41
    s_mul_i32 s40, s40, 18432
    s_add_u32 s79, s40, s51
    s_lshl_b32 s40, s73, 13
    s_waitcnt vmcnt(16)
    s_mov_b64 exec, 1
    ds_add_u32 v0, v0 offset:0
    s_mov_b64 exec, -1
    s_waitcnt lgkmcnt(9)
    v_mfma_f32_32x32x16_bf16 v[48:63], v[16:19], v[240:243], v[48:63]
    ds_read_b64_tr_b16 v[40:41], v3 offset:57344
    ds_read_b64_tr_b16 v[42:43], v3 offset:57856
    s_setprio 2
    v_mfma_f32_32x32x16_bf16 v[48:63], v[20:23], v[244:247], v[48:63]
    s_setprio 0
    ds_read_b64_tr_b16 v[44:45], v3 offset:61440
    ds_read_b64_tr_b16 v[46:47], v3 offset:61952
    s_waitcnt lgkmcnt(9)
    v_mfma_f32_32x32x16_bf16 v[48:63], v[24:27], v[248:251], v[48:63]
    ds_read_b64_tr_b16 v[16:17], v4 offset:49152
    ds_read_b64_tr_b16 v[18:19], v4 offset:49664
    v_mfma_f32_32x32x16_bf16 v[48:63], v[28:31], v[252:255], v[48:63]
    ds_read_b64_tr_b16 v[20:21], v4 offset:53248
    ds_read_b64_tr_b16 v[22:23], v4 offset:53760
    s_waitcnt lgkmcnt(9)
    s_setprio 2
    v_mfma_f32_32x32x16_bf16 v[64:79], v[32:35], v[240:243], v[64:79]
    ds_read_b64_tr_b16 v[24:25], v4 offset:57344
    ds_read_b64_tr_b16 v[26:27], v4 offset:57856
    s_nop 4
    v_max_f32 v48, 0, v48
    v_max_f32 v49, 0, v49
    v_mfma_f32_32x32x16_bf16 v[64:79], v[36:39], v[244:247], v[64:79]
    ds_read_b64_tr_b16 v[28:29], v4 offset:61440
    ds_read_b64_tr_b16 v[30:31], v4 offset:61952
    v_max_f32 v50, 0, v50
    v_max_f32 v51, 0, v51
    s_waitcnt lgkmcnt(8)
    v_mfma_f32_32x32x16_bf16 v[64:79], v[40:43], v[248:251], v[64:79]
    ds_read_b32 v15, v0 offset:0
    ds_read_b64_tr_b16 v[32:33], v5 offset:49152
    ds_read_b64_tr_b16 v[34:35], v5 offset:49664
    v_max_f32 v52, 0, v52
    v_max_f32 v53, 0, v53
    v_mfma_f32_32x32x16_bf16 v[64:79], v[44:47], v[252:255], v[64:79]
    ds_read_b64_tr_b16 v[36:37], v5 offset:53248
    ds_read_b64_tr_b16 v[38:39], v5 offset:53760
    v_max_f32 v54, 0, v54
    v_max_f32 v55, 0, v55
    s_waitcnt lgkmcnt(9)
    v_mfma_f32_32x32x16_bf16 v[80:95], v[16:19], v[240:243], v[80:95]
    ds_read_b64_tr_b16 v[40:41], v5 offset:57344
    ds_read_b64_tr_b16 v[42:43], v5 offset:57856
    v_mul_f32 v48, v48, v56
    v_mul_f32 v49, v49, v57
    v_mfma_f32_32x32x16_bf16 v[80:95], v[20:23], v[244:247], v[80:95]
    s_waitcnt lgkmcnt(6)
L_cg17:
    v_cmp_gt_u32 vcc, 272, v15
    s_cbranch_vccz L_cg17_ok
    s_add_u32 s3, s3, 1
    s_cmp_ge_u32 s3, 0x400000
    s_cbranch_scc1 L_cg17_ok
    ds_read_b32 v15, v0 offset:0
    s_waitcnt lgkmcnt(0)
    s_branch L_cg17
L_cg17_ok:
    ds_read_b64_tr_b16 v[44:45], v5 offset:61440
    ds_read_b64_tr_b16 v[46:47], v5 offset:61952
    s_add_u32 m0, s45, 32768
    s_add_u32 s43, s69, s47
    buffer_load_dwordx4 v9, s[12:15], s43 offen offset:0 lds
    v_mul_f32 v50, v50, v58
    v_mul_f32 v51, v51, v59
    v_mfma_f32_32x32x16_bf16 v[80:95], v[24:27], v[248:251], v[80:95]
    v_add_u32 v2, 65536, v2
    v_add_u32 v3, 65536, v3
    v_add_u32 v4, 65536, v4
    v_add_u32 v5, 65536, v5
    ds_read_b64_tr_b16 v[16:17], v2 offset:0
    ds_read_b64_tr_b16 v[18:19], v2 offset:512
    buffer_load_dwordx4 v10, s[12:15], s43 offen offset:1024 lds
    v_mul_f32 v52, v52, v60
    v_mul_f32 v53, v53, v61
    v_mfma_f32_32x32x16_bf16 v[80:95], v[28:31], v[252:255], v[80:95]
    ds_read_b64_tr_b16 v[20:21], v2 offset:4096
    ds_read_b64_tr_b16 v[22:23], v2 offset:4608
    buffer_load_dwordx4 v7, s[16:19], s43 offen offset:2048 lds
    v_mul_f32 v54, v54, v62
    v_mul_f32 v55, v55, v63
    s_waitcnt lgkmcnt(8)
    v_mfma_f32_32x32x16_bf16 v[96:111], v[32:35], v[240:243], v[96:111]
    ds_read_b64_tr_b16 v[24:25], v2 offset:8192
    ds_read_b64_tr_b16 v[26:27], v2 offset:8704
    buffer_load_dwordx4 v8, s[16:19], s43 offen offset:3072 lds
    v_cvt_pk_bf16_f32 v56, v48, v49
    v_cvt_pk_bf16_f32 v57, v50, v51
    v_mfma_f32_32x32x16_bf16 v[96:111], v[36:39], v[244:247], v[96:111]
    ds_read_b64_tr_b16 v[28:29], v2 offset:12288
    ds_read_b64_tr_b16 v[30:31], v2 offset:12800
    s_add_u32 s40, s40, s51
    s_add_u32 s48, s40, 294912
    s_lshl_b32 s40, s73, 10
    s_add_u32 s40, s40, s51
    v_cvt_pk_bf16_f32 v58, v52, v53
    v_cvt_pk_bf16_f32 v59, v54, v55
    s_waitcnt lgkmcnt(8)
    v_mfma_f32_32x32x16_bf16 v[96:111], v[40:43], v[248:251], v[96:111]
    ds_read_b64_tr_b16 v[32:33], v3 offset:0
    ds_read_b64_tr_b16 v[34:35], v3 offset:512
    s_add_u32 s49, s40, 327680
    s_lshl_b32 s40, s37, 4
    s_add_u32 s41, s40, s38
    s_lshl_b32 s41, s41, 7
    s_add_u32 s52, s50, 2048
    buffer_store_dwordx4 v[56:59], v11, s[24:27], s52 offen sc1
    v_mfma_f32_32x32x16_bf16 v[96:111], v[44:47], v[252:255], v[96:111]
    ds_read_b64_tr_b16 v[36:37], v3 offset:4096
    ds_read_b64_tr_b16 v[38:39], v3 offset:4608
    s_add_u32 s44, s41, 9437184
    s_and_b32 s41, s38, 12
    s_add_u32 s41, s41, s40
    s_lshl_b32 s41, s41, 7
    v_max_f32 v64, 0, v64
    v_max_f32 v65, 0, v65
    s_waitcnt vmcnt(17)
    s_mov_b64 exec, 1
    ds_add_u32 v0, v0 offset:0
    s_mov_b64 exec, -1
    s_waitcnt lgkmcnt(9)
    v_mfma_f32_32x32x16_bf16 v[48:63], v[16:19], v[112:115], 0
    ds_read_b64_tr_b16 v[40:41], v3 offset:8192
    ds_read_b64_tr_b16 v[42:43], v3 offset:8704
    v_max_f32 v66, 0, v66
    v_max_f32 v67, 0, v67
    v_mfma_f32_32x32x16_bf16 v[48:63], v[20:23], v[116:119], v[48:63]
    ds_read_b64_tr_b16 v[44:45], v3 offset:12288
    ds_read_b64_tr_b16 v[46:47], v3 offset:12800
    v_max_f32 v68, 0, v68
    v_max_f32 v69, 0, v69
    s_waitcnt lgkmcnt(9)
    v_mfma_f32_32x32x16_bf16 v[48:63], v[24:27], v[120:123], v[48:63]
    ds_read_b64_tr_b16 v[16:17], v4 offset:0
    ds_read_b64_tr_b16 v[18:19], v4 offset:512
    v_max_f32 v70, 0, v70
    v_max_f32 v71, 0, v71
    v_mfma_f32_32x32x16_bf16 v[48:63], v[28:31], v[124:127], v[48:63]
    ds_read_b64_tr_b16 v[20:21], v4 offset:4096
    ds_read_b64_tr_b16 v[22:23], v4 offset:4608
    v_mul_f32 v64, v64, v72
    v_mul_f32 v65, v65, v73
    v_mul_f32 v66, v66, v74
    v_mul_f32 v67, v67, v75
    v_mul_f32 v68, v68, v76
    v_mul_f32 v69, v69, v77
    v_mul_f32 v70, v70, v78
    v_mul_f32 v71, v71, v79
    v_cvt_pk_bf16_f32 v72, v64, v65
    v_cvt_pk_bf16_f32 v73, v66, v67
    v_cvt_pk_bf16_f32 v74, v68, v69
    v_cvt_pk_bf16_f32 v75, v70, v71
    s_add_u32 s52, s50, 3072
    buffer_store_dwordx4 v[72:75], v11, s[24:27], s52 offen sc1
    s_waitcnt lgkmcnt(9)
    s_nop 0
    v_mfma_f32_32x32x16_bf16 v[64:79], v[32:35], v[112:115], 0
    ds_read_b64_tr_b16 v[24:25], v4 offset:8192
    ds_read_b64_tr_b16 v[26:27], v4 offset:8704
    v_max_f32 v80, 0, v80
    v_max_f32 v81, 0, v81
    v_mfma_f32_32x32x16_bf16 v[64:79], v[36:39], v[116:119], v[64:79]
    ds_read_b64_tr_b16 v[28:29], v4 offset:12288
    ds_read_b64_tr_b16 v[30:31], v4 offset:12800
    v_max_f32 v82, 0, v82
    v_max_f32 v83, 0, v83
    s_waitcnt lgkmcnt(8)
    v_mfma_f32_32x32x16_bf16 v[64:79], v[40:43], v[120:123], v[64:79]
    ds_read_b32 v15, v0 offset:0
    ds_read_b64_tr_b16 v[32:33], v5 offset:0
    ds_read_b64_tr_b16 v[34:35], v5 offset:512
    v_max_f32 v84, 0, v84
    v_max_f32 v85, 0, v85
    v_mfma_f32_32x32x16_bf16 v[64:79], v[44:47], v[124:127], v[64:79]
    ds_read_b64_tr_b16 v[36:37], v5 offset:4096
    ds_read_b64_tr_b16 v[38:39], v5 offset:4608
    v_max_f32 v86, 0, v86
    v_max_f32 v87, 0, v87
    v_mul_f32 v80, v80, v88
    v_mul_f32 v81, v81, v89
    v_mul_f32 v82, v82, v90
    v_mul_f32 v83, v83, v91
    v_mul_f32 v84, v84, v92
    v_mul_f32 v85, v85, v93
    v_mul_f32 v86, v86, v94
    v_mul_f32 v87, v87, v95
    v_cvt_pk_bf16_f32 v88, v80, v81
    v_cvt_pk_bf16_f32 v89, v82, v83
    v_cvt_pk_bf16_f32 v90, v84, v85
    v_cvt_pk_bf16_f32 v91, v86, v87
    s_add_u32 s52, s50, 4096
    buffer_store_dwordx4 v[88:91], v11, s[24:27], s52 offen sc1
    s_waitcnt lgkmcnt(9)
    s_nop 0
    v_mfma_f32_32x32x16_bf16 v[80:95], v[16:19], v[112:115], 0
    ds_read_b64_tr_b16 v[40:41], v5 offset:8192
    ds_read_b64_tr_b16 v[42:43], v5 offset:8704
    v_max_f32 v96, 0, v96
    v_max_f32 v97, 0, v97
    v_mfma_f32_32x32x16_bf16 v[80:95], v[20:23], v[116:119], v[80:95]
    s_waitcnt lgkmcnt(6)
L_cg18:
    v_cmp_gt_u32 vcc, 288, v15
    s_cbranch_vccz L_cg18_ok
    s_add_u32 s3, s3, 1
    s_cmp_ge_u32 s3, 0x400000
    s_cbranch_scc1 L_cg18_ok
    ds_read_b32 v15, v0 offset:0
    s_waitcnt lgkmcnt(0)
    s_branch L_cg18
L_cg18_ok:
    ds_read_b64_tr_b16 v[44:45], v5 offset:12288
    ds_read_b64_tr_b16 v[46:47], v5 offset:12800
    s_add_u32 m0, s45, 49152
    s_add_u32 s43, s70, s47
    buffer_load_dwordx4 v9, s[12:15], s43 offen offset:0 lds
    v_max_f32 v98, 0, v98
    v_max_f32 v99, 0, v99
    v_mfma_f32_32x32x16_bf16 v[80:95], v[24:27], v[120:123], v[80:95]
    ds_read_b64_tr_b16 v[16:17], v2 offset:16384
    ds_read_b64_tr_b16 v[18:19], v2 offset:16896
    buffer_load_dwordx4 v10, s[12:15], s43 offen offset:1024 lds
    v_max_f32 v100, 0, v100
    v_max_f32 v101, 0, v101
    v_mfma_f32_32x32x16_bf16 v[80:95], v[28:31], v[124:127], v[80:95]
    ds_read_b64_tr_b16 v[20:21], v2 offset:20480
    ds_read_b64_tr_b16 v[22:23], v2 offset:20992
    buffer_load_dwordx4 v7, s[16:19], s43 offen offset:2048 lds
    v_max_f32 v102, 0, v102
    v_max_f32 v103, 0, v103
    v_mul_f32 v96, v96, v104
    v_mul_f32 v97, v97, v105
    v_mul_f32 v98, v98, v106
    v_mul_f32 v99, v99, v107
    v_mul_f32 v100, v100, v108
    v_mul_f32 v101, v101, v109
    v_mul_f32 v102, v102, v110
    v_mul_f32 v103, v103, v111
    v_cvt_pk_bf16_f32 v104, v96, v97
    v_cvt_pk_bf16_f32 v105, v98, v99
    v_cvt_pk_bf16_f32 v106, v100, v101
    v_cvt_pk_bf16_f32 v107, v102, v103
    s_add_u32 s52, s50, 5120
    buffer_store_dwordx4 v[104:107], v11, s[24:27], s52 offen sc1
    s_waitcnt lgkmcnt(8)
    s_nop 0
    v_mfma_f32_32x32x16_bf16 v[96:111], v[32:35], v[112:115], 0
    s_setprio 0
    ds_read_b64_tr_b16 v[24:25], v2 offset:24576
    ds_read_b64_tr_b16 v[26:27], v2 offset:25088
    buffer_load_dwordx4 v8, s[16:19], s43 offen offset:3072 lds
    v_mfma_f32_32x32x16_bf16 v[96:111], v[36:39], v[116:119], v[96:111]
    ds_read_b64_tr_b16 v[28:29], v2 offset:28672
    ds_read_b64_tr_b16 v[30:31], v2 offset:29184
    s_lshl_b32 s46, s74, 2
    s_add_u32 s41, s41, s46
    s_add_u32 s46, s41, 9437184
    s_add_u32 s41, s40, s74
    s_waitcnt lgkmcnt(8)
    v_mfma_f32_32x32x16_bf16 v[96:111], v[40:43], v[120:123], v[96:111]
    ds_read_b64_tr_b16 v[32:33], v3 offset:16384
    ds_read_b64_tr_b16 v[34:35], v3 offset:16896
    s_lshl_b32 s41, s41, 7
    s_lshl_b32 s62, s73, 2
    s_add_u32 s41, s41, s62
    s_add_u32 s62, s41, 9437280
    s_setprio 2
    v_mfma_f32_32x32x16_bf16 v[96:111], v[44:47], v[124:127], v[96:111]
    s_setprio 0
    ds_read_b64_tr_b16 v[36:37], v3 offset:20480
    ds_read_b64_tr_b16 v[38:39], v3 offset:20992
    s_lshl_b32 s40, s37, 2
    s_add_u32 s40, s40, s74
    s_lshl_b32 s40, s40, 2
    s_add_u32 s40, s40, s36
    s_waitcnt vmcnt(20)
    s_mov_b64 exec, 1
    ds_add_u32 v0, v0 offset:0
    s_mov_b64 exec, -1
    s_waitcnt lgkmcnt(9)
    v_mfma_f32_32x32x16_bf16 v[48:63], v[16:19], v[128:131], v[48:63]
    ds_read_b64_tr_b16 v[40:41], v3 offset:24576
    ds_read_b64_tr_b16 v[42:43], v3 offset:25088
    v_mfma_f32_32x32x16_bf16 v[48:63], v[20:23], v[132:135], v[48:63]
    ds_read_b64_tr_b16 v[44:45], v3 offset:28672
    ds_read_b64_tr_b16 v[46:47], v3 offset:29184
    s_waitcnt lgkmcnt(9)
    s_setprio 2
    v_mfma_f32_32x32x16_bf16 v[48:63], v[24:27], v[136:139], v[48:63]
    s_setprio 0
    ds_read_b64_tr_b16 v[16:17], v4 offset:16384
    ds_read_b64_tr_b16 v[18:19], v4 offset:16896
    v_mfma_f32_32x32x16_bf16 v[48:63], v[28:31], v[140:143], v[48:63]
    ds_read_b64_tr_b16 v[20:21], v4 offset:20480
    ds_read_b64_tr_b16 v[22:23], v4 offset:20992
    s_waitcnt lgkmcnt(9)
    v_mfma_f32_32x32x16_bf16 v[64:79], v[32:35], v[128:131], v[64:79]
    ds_read_b64_tr_b16 v[24:25], v4 offset:24576
    ds_read_b64_tr_b16 v[26:27], v4 offset:25088
    s_setprio 2
    v_mfma_f32_32x32x16_bf16 v[64:79], v[36:39], v[132:135], v[64:79]
    s_setprio 0
    ds_read_b64_tr_b16 v[28:29], v4 offset:28672
    ds_read_b64_tr_b16 v[30:31], v4 offset:29184
    s_waitcnt lgkmcnt(8)
    v_mfma_f32_32x32x16_bf16 v[64:79], v[40:43], v[136:139], v[64:79]
    ds_read_b32 v15, v0 offset:0
    ds_read_b64_tr_b16 v[32:33], v5 offset:16384
    ds_read_b64_tr_b16 v[34:35], v5 offset:16896
    v_mfma_f32_32x32x16_bf16 v[64:79], v[44:47], v[140:143], v[64:79]
    ds_read_b64_tr_b16 v[36:37], v5 offset:20480
    ds_read_b64_tr_b16 v[38:39], v5 offset:20992
    s_waitcnt lgkmcnt(9)
    s_setprio 2
    v_mfma_f32_32x32x16_bf16 v[80:95], v[16:19], v[128:131], v[80:95]
    s_setprio 0
    ds_read_b64_tr_b16 v[40:41], v5 offset:24576
    ds_read_b64_tr_b16 v[42:43], v5 offset:25088
    v_mfma_f32_32x32x16_bf16 v[80:95], v[20:23], v[132:135], v[80:95]
    s_setprio 2
    s_waitcnt lgkmcnt(6)
L_cg19:
    v_cmp_gt_u32 vcc, 304, v15
    s_cbranch_vccz L_cg19_ok
    s_add_u32 s3, s3, 1
    s_cmp_ge_u32 s3, 0x400000
    s_cbranch_scc1 L_cg19_ok
    ds_read_b32 v15, v0 offset:0
    s_waitcnt lgkmcnt(0)
    s_branch L_cg19
L_cg19_ok:
    s_setprio 0
    ds_read_b64_tr_b16 v[44:45], v5 offset:28672
    ds_read_b64_tr_b16 v[46:47], v5 offset:29184
    s_add_u32 m0, s45, 65536
    s_add_u32 s43, s71, s47
    buffer_load_dwordx4 v9, s[12:15], s43 offen offset:0 lds
    v_mfma_f32_32x32x16_bf16 v[80:95], v[24:27], v[136:139], v[80:95]
    ds_read_b64_tr_b16 v[16:17], v2 offset:32768
    ds_read_b64_tr_b16 v[18:19], v2 offset:33280
    buffer_load_dwordx4 v10, s[12:15], s43 offen offset:1024 lds
    s_setprio 2
    v_mfma_f32_32x32x16_bf16 v[80:95], v[28:31], v[140:143], v[80:95]
    s_setprio 0
    ds_read_b64_tr_b16 v[20:21], v2 offset:36864
    ds_read_b64_tr_b16 v[22:23], v2 offset:37376
    buffer_load_dwordx4 v7, s[16:19], s43 offen offset:2048 lds
    s_waitcnt lgkmcnt(8)
    v_mfma_f32_32x32x16_bf16 v[96:111], v[32:35], v[128:131], v[96:111]
    ds_read_b64_tr_b16 v[24:25], v2 offset:40960
    ds_read_b64_tr_b16 v[26:27], v2 offset:41472
    buffer_load_dwordx4 v8, s[16:19], s43 offen offset:3072 lds
    v_mfma_f32_32x32x16_bf16 v[96:111], v[36:39], v[132:135], v[96:111]
    ds_read_b64_tr_b16 v[28:29], v2 offset:45056
    ds_read_b64_tr_b16 v[30:31], v2 offset:45568
    s_lshl_b32 s40, s40, 2
    s_add_u32 s40, s40, s73
    s_mul_i32 s57, s40, 9216
    s_waitcnt lgkmcnt(8)
    s_setprio 2
    v_mfma_f32_32x32x16_bf16 v[96:111], v[40:43], v[136:139], v[96:111]
    s_setprio 0
    ds_read_b64_tr_b16 v[32:33], v3 offset:32768
    ds_read_b64_tr_b16 v[34:35], v3 offset:33280
    v_mfma_f32_32x32x16_bf16 v[96:111], v[44:47], v[140:143], v[96:111]
    ds_read_b64_tr_b16 v[36:37], v3 offset:36864
    ds_read_b64_tr_b16 v[38:39], v3 offset:37376
    s_waitcnt vmcnt(20)
    s_mov_b64 exec, 1
    ds_add_u32 v0, v0 offset:0
    s_mov_b64 exec, -1
    s_waitcnt lgkmcnt(9)
    v_mfma_f32_32x32x16_bf16 v[48:63], v[16:19], v[144:147], v[48:63]
    ds_read_b64_tr_b16 v[40:41], v3 offset:40960
    ds_read_b64_tr_b16 v[42:43], v3 offset:41472
    s_setprio 2
    v_mfma_f32_32x32x16_bf16 v[48:63], v[20:23], v[148:151], v[48:63]
    s_setprio 0
    ds_read_b64_tr_b16 v[44:45], v3 offset:45056
    ds_read_b64_tr_b16 v[46:47], v3 offset:45568
    s_waitcnt lgkmcnt(9)
    v_mfma_f32_32x32x16_bf16 v[48:63], v[24:27], v[152:155], v[48:63]
    ds_read_b64_tr_b16 v[16:17], v4 offset:32768
    ds_read_b64_tr_b16 v[18:19], v4 offset:33280
    v_mfma_f32_32x32x16_bf16 v[48:63], v[28:31], v[156:159], v[48:63]
    ds_read_b64_tr_b16 v[20:21], v4 offset:36864
    ds_read_b64_tr_b16 v[22:23], v4 offset:37376
    s_waitcnt lgkmcnt(9)
    s_setprio 2
    v_mfma_f32_32x32x16_bf16 v[64:79], v[32:35], v[144:147], v[64:79]
    s_setprio 0
    ds_read_b64_tr_b16 v[24:25], v4 offset:40960
    ds_read_b64_tr_b16 v[26:27], v4 offset:41472
    v_mfma_f32_32x32x16_bf16 v[64:79], v[36:39], v[148:151], v[64:79]
    ds_read_b64_tr_b16 v[28:29], v4 offset:45056
    ds_read_b64_tr_b16 v[30:31], v4 offset:45568
    s_waitcnt lgkmcnt(8)
    v_mfma_f32_32x32x16_bf16 v[64:79], v[40:43], v[152:155], v[64:79]
    ds_read_b32 v15, v0 offset:0
    ds_read_b64_tr_b16 v[32:33], v5 offset:32768
    ds_read_b64_tr_b16 v[34:35], v5 offset:33280
    s_setprio 2
    v_mfma_f32_32x32x16_bf16 v[64:79], v[44:47], v[156:159], v[64:79]
    s_setprio 0
    ds_read_b64_tr_b16 v[36:37], v5 offset:36864
    ds_read_b64_tr_b16 v[38:39], v5 offset:37376
    s_waitcnt lgkmcnt(9)
    v_mfma_f32_32x32x16_bf16 v[80:95], v[16:19], v[144:147], v[80:95]
    ds_read_b64_tr_b16 v[40:41], v5 offset:40960
    ds_read_b64_tr_b16 v[42:43], v5 offset:41472
    v_mfma_f32_32x32x16_bf16 v[80:95], v[20:23], v[148:151], v[80:95]
    s_setprio 2
    s_waitcnt lgkmcnt(6)
L_cg20:
    v_cmp_gt_u32 vcc, 320, v15
    s_cbranch_vccz L_cg20_ok
    s_add_u32 s3, s3, 1
    s_cmp_ge_u32 s3, 0x400000
    s_cbranch_scc1 L_cg20_ok
    ds_read_b32 v15, v0 offset:0
    s_waitcnt lgkmcnt(0)
    s_branch L_cg20
L_cg20_ok:
    s_setprio 0
    ds_read_b64_tr_b16 v[44:45], v5 offset:45056
    ds_read_b64_tr_b16 v[46:47], v5 offset:45568
    s_add_u32 m0, s45, 81920
    s_add_u32 s43, s72, s47
    s_add_u32 s47, s47, 128
    buffer_load_dwordx4 v9, s[12:15], s43 offen offset:0 lds
    s_setprio 2
    v_mfma_f32_32x32x16_bf16 v[80:95], v[24:27], v[152:155], v[80:95]
    s_setprio 0
    s_setprio 2
    v_subrev_u32 v2, 65536, v2
    v_subrev_u32 v3, 65536, v3
    v_subrev_u32 v4, 65536, v4
    v_subrev_u32 v5, 65536, v5
    s_setprio 0
    ds_read_b64_tr_b16 v[16:17], v2 offset:0
    ds_read_b64_tr_b16 v[18:19], v2 offset:512
    buffer_load_dwordx4 v10, s[12:15], s43 offen offset:1024 lds
    v_mfma_f32_32x32x16_bf16 v[80:95], v[28:31], v[156:159], v[80:95]
    ds_read_b64_tr_b16 v[20:21], v2 offset:4096
    ds_read_b64_tr_b16 v[22:23], v2 offset:4608
    buffer_load_dwordx4 v7, s[16:19], s43 offen offset:2048 lds
    s_waitcnt lgkmcnt(8)
    v_mfma_f32_32x32x16_bf16 v[96:111], v[32:35], v[144:147], v[96:111]
    ds_read_b64_tr_b16 v[24:25], v2 offset:8192
    ds_read_b64_tr_b16 v[26:27], v2 offset:8704
    buffer_load_dwordx4 v8, s[16:19], s43 offen offset:3072 lds
    s_setprio 2
    v_mfma_f32_32x32x16_bf16 v[96:111], v[36:39], v[148:151], v[96:111]
    s_setprio 0
    ds_read_b64_tr_b16 v[28:29], v2 offset:12288
    ds_read_b64_tr_b16 v[30:31], v2 offset:12800
    s_waitcnt lgkmcnt(8)
    v_mfma_f32_32x32x16_bf16 v[96:111], v[40:43], v[152:155], v[96:111]
    ds_read_b64_tr_b16 v[32:33], v3 offset:0
    ds_read_b64_tr_b16 v[34:35], v3 offset:512
    v_mfma_f32_32x32x16_bf16 v[96:111], v[44:47], v[156:159], v[96:111]
    ds_read_b64_tr_b16 v[36:37], v3 offset:4096
    ds_read_b64_tr_b16 v[38:39], v3 offset:4608
    s_waitcnt vmcnt(20)
    s_mov_b64 exec, 1
    ds_add_u32 v0, v0 offset:0
    s_mov_b64 exec, -1
    s_waitcnt lgkmcnt(9)
    s_setprio 2
    v_mfma_f32_32x32x16_bf16 v[48:63], v[16:19], v[160:163], v[48:63]
    s_setprio 0
    ds_read_b64_tr_b16 v[40:41], v3 offset:8192
    ds_read_b64_tr_b16 v[42:43], v3 offset:8704
    v_mfma_f32_32x32x16_bf16 v[48:63], v[20:23], v[164:167], v[48:63]
    ds_read_b64_tr_b16 v[44:45], v3 offset:12288
    ds_read_b64_tr_b16 v[46:47], v3 offset:12800
    s_waitcnt lgkmcnt(9)
    v_mfma_f32_32x32x16_bf16 v[48:63], v[24:27], v[168:171], v[48:63]
    ds_read_b64_tr_b16 v[16:17], v4 offset:0
    ds_read_b64_tr_b16 v[18:19], v4 offset:512
    s_setprio 2
    v_mfma_f32_32x32x16_bf16 v[48:63], v[28:31], v[172:175], v[48:63]
    s_setprio 0
    ds_read_b64_tr_b16 v[20:21], v4 offset:4096
    ds_read_b64_tr_b16 v[22:23], v4 offset:4608
    s_waitcnt lgkmcnt(9)
    v_mfma_f32_32x32x16_bf16 v[64:79], v[32:35], v[160:163], v[64:79]
    ds_read_b64_tr_b16 v[24:25], v4 offset:8192
    ds_read_b64_tr_b16 v[26:27], v4 offset:8704
    v_mfma_f32_32x32x16_bf16 v[64:79], v[36:39], v[164:167], v[64:79]
    ds_read_b64_tr_b16 v[28:29], v4 offset:12288
    ds_read_b64_tr_b16 v[30:31], v4 offset:12800
    s_waitcnt lgkmcnt(8)
    s_setprio 2
    v_mfma_f32_32x32x16_bf16 v[64:79], v[40:43], v[168:171], v[64:79]
    s_setprio 0
    ds_read_b32 v15, v0 offset:0
    ds_read_b64_tr_b16 v[32:33], v5 offset:0
    ds_read_b64_tr_b16 v[34:35], v5 offset:512
    v_mfma_f32_32x32x16_bf16 v[64:79], v[44:47], v[172:175], v[64:79]
    ds_read_b64_tr_b16 v[36:37], v5 offset:4096
    ds_read_b64_tr_b16 v[38:39], v5 offset:4608
    s_waitcnt lgkmcnt(9)
    v_mfma_f32_32x32x16_bf16 v[80:95], v[16:19], v[160:163], v[80:95]
    ds_read_b64_tr_b16 v[40:41], v5 offset:8192
    ds_read_b64_tr_b16 v[42:43], v5 offset:8704
    s_setprio 2
    v_mfma_f32_32x32x16_bf16 v[80:95], v[20:23], v[164:167], v[80:95]
    s_setprio 0
    s_setprio 2
    s_waitcnt lgkmcnt(6)
L_cg21:
    v_cmp_gt_u32 vcc, 336, v15
    s_cbranch_vccz L_cg21_ok
    s_add_u32 s3, s3, 1
    s_cmp_ge_u32 s3, 0x400000
    s_cbranch_scc1 L_cg21_ok
    ds_read_b32 v15, v0 offset:0
    s_waitcnt lgkmcnt(0)
    s_branch L_cg21
L_cg21_ok:
    s_setprio 0
    ds_read_b32 v15, v0 offset:4
    s_setprio 2
    s_waitcnt lgkmcnt(0)
L_ctg:
    v_cmp_gt_u32 vcc, 16, v15
    s_cbranch_vccz L_ctg_ok
    s_add_u32 s3, s3, 1
    s_cmp_ge_u32 s3, 0x400000
    s_cbranch_scc1 L_ctg_ok
    s_sleep 2
    ds_read_b32 v15, v0 offset:4
    s_waitcnt lgkmcnt(0)
    s_branch L_ctg
L_ctg_ok:
    ds_read_b64_tr_b16 v[44:45], v5 offset:12288
    ds_read_b64_tr_b16 v[46:47], v5 offset:12800
    s_add_u32 m0, s45, 98304
    s_add_u32 s43, s64, s47
    buffer_load_dwordx4 v9, s[12:15], s43 offen offset:0 lds
    s_setprio 0
    v_mfma_f32_32x32x16_bf16 v[80:95], v[24:27], v[168:171], v[80:95]
    ds_read_b64_tr_b16 v[16:17], v2 offset:16384
    ds_read_b64_tr_b16 v[18:19], v2 offset:16896
    buffer_load_dwordx4 v10, s[12:15], s43 offen offset:1024 lds
    v_mfma_f32_32x32x16_bf16 v[80:95], v[28:31], v[172:175], v[80:95]
    ds_read_b64_tr_b16 v[20:21], v2 offset:20480
    ds_read_b64_tr_b16 v[22:23], v2 offset:20992
    buffer_load_dwordx4 v7, s[16:19], s43 offen offset:2048 lds
    s_setprio 2
    v_mfma_f32_32x32x16_bf16 v[96:111], v[32:35], v[160:163], v[96:111]
    s_setprio 0
    ds_read_b64_tr_b16 v[24:25], v2 offset:24576
    ds_read_b64_tr_b16 v[26:27], v2 offset:25088
    buffer_load_dwordx4 v8, s[16:19], s43 offen offset:3072 lds
    v_mfma_f32_32x32x16_bf16 v[96:111], v[36:39], v[164:167], v[96:111]
    ds_read_b64_tr_b16 v[28:29], v2 offset:28672
    ds_read_b64_tr_b16 v[30:31], v2 offset:29184
    v_mfma_f32_32x32x16_bf16 v[96:111], v[40:43], v[168:171], v[96:111]
    ds_read_b64_tr_b16 v[32:33], v3 offset:16384
    ds_read_b64_tr_b16 v[34:35], v3 offset:16896
    s_waitcnt lgkmcnt(8)
    s_setprio 2
    v_mfma_f32_32x32x16_bf16 v[96:111], v[44:47], v[172:175], v[96:111]
    s_setprio 0
    ds_read_b64_tr_b16 v[36:37], v3 offset:20480
    ds_read_b64_tr_b16 v[38:39], v3 offset:20992
    s_waitcnt vmcnt(20)
    s_mov_b64 exec, 1
    ds_add_u32 v0, v0 offset:0
    s_mov_b64 exec, -1
    v_mfma_f32_32x32x16_bf16 v[48:63], v[16:19], v[176:179], v[48:63]
    ds_read_b64_tr_b16 v[40:41], v3 offset:24576
    ds_read_b64_tr_b16 v[42:43], v3 offset:25088
    s_waitcnt lgkmcnt(9)
    v_mfma_f32_32x32x16_bf16 v[48:63], v[20:23], v[180:183], v[48:63]
    ds_read_b64_tr_b16 v[44:45], v3 offset:28672
    ds_read_b64_tr_b16 v[46:47], v3 offset:29184
    s_setprio 2
    v_mfma_f32_32x32x16_bf16 v[48:63], v[24:27], v[184:187], v[48:63]
    s_setprio 0
    ds_read_b64_tr_b16 v[16:17], v4 offset:16384
    ds_read_b64_tr_b16 v[18:19], v4 offset:16896
    s_waitcnt lgkmcnt(9)
    v_mfma_f32_32x32x16_bf16 v[48:63], v[28:31], v[188:191], v[48:63]
    ds_read_b64_tr_b16 v[20:21], v4 offset:20480
    ds_read_b64_tr_b16 v[22:23], v4 offset:20992
    v_mfma_f32_32x32x16_bf16 v[64:79], v[32:35], v[176:179], v[64:79]
    ds_read_b64_tr_b16 v[24:25], v4 offset:24576
    ds_read_b64_tr_b16 v[26:27], v4 offset:25088
    s_waitcnt lgkmcnt(8)
    s_setprio 2
    v_mfma_f32_32x32x16_bf16 v[64:79], v[36:39], v[180:183], v[64:79]
    s_setprio 0
    ds_read_b64_tr_b16 v[28:29], v4 offset:28672
    ds_read_b64_tr_b16 v[30:31], v4 offset:29184
    v_mfma_f32_32x32x16_bf16 v[64:79], v[40:43], v[184:187], v[64:79]
    ds_read_b32 v15, v0 offset:0
    ds_read_b64_tr_b16 v[32:33], v5 offset:16384
    ds_read_b64_tr_b16 v[34:35], v5 offset:16896
    s_waitcnt lgkmcnt(9)
    v_mfma_f32_32x32x16_bf16 v[64:79], v[44:47], v[188:191], v[64:79]
    ds_read_b64_tr_b16 v[36:37], v5 offset:20480
    ds_read_b64_tr_b16 v[38:39], v5 offset:20992
    s_setprio 2
    v_mfma_f32_32x32x16_bf16 v[80:95], v[16:19], v[176:179], v[80:95]
    s_setprio 0
    ds_read_b64_tr_b16 v[40:41], v5 offset:24576
    ds_read_b64_tr_b16 v[42:43], v5 offset:25088
    s_waitcnt lgkmcnt(9)
    v_mfma_f32_32x32x16_bf16 v[80:95], v[20:23], v[180:183], v[80:95]
    s_setprio 2
    s_waitcnt lgkmcnt(6)
L_cg22:
    v_cmp_gt_u32 vcc, 352, v15
    s_cbranch_vccz L_cg22_ok
    s_add_u32 s3, s3, 1
    s_cmp_ge_u32 s3, 0x400000
    s_cbranch_scc1 L_cg22_ok
    ds_read_b32 v15, v0 offset:0
    s_waitcnt lgkmcnt(0)
    s_branch L_cg22
L_cg22_ok:
    s_setprio 0
    ds_read_b64_tr_b16 v[44:45], v5 offset:28672
    ds_read_b64_tr_b16 v[46:47], v5 offset:29184
    s_add_u32 m0, s45, 0
    s_add_u32 s43, s65, s47
    buffer_load_dwordx4 v9, s[12:15], s43 offen offset:0 lds
    v_mfma_f32_32x32x16_bf16 v[80:95], v[24:27], v[184:187], v[80:95]
    ds_read_b64_tr_b16 v[16:17], v2 offset:32768
    ds_read_b64_tr_b16 v[18:19], v2 offset:33280
    buffer_load_dwordx4 v10, s[12:15], s43 offen offset:1024 lds
    s_setprio 2
    v_mfma_f32_32x32x16_bf16 v[80:95], v[28:31], v[188:191], v[80:95]
    s_setprio 0
    ds_read_b64_tr_b16 v[20:21], v2 offset:36864
    ds_read_b64_tr_b16 v[22:23], v2 offset:37376
    buffer_load_dwordx4 v7, s[16:19], s43 offen offset:2048 lds
    s_waitcnt lgkmcnt(8)
    v_mfma_f32_32x32x16_bf16 v[96:111], v[32:35], v[176:179], v[96:111]
    ds_read_b64_tr_b16 v[24:25], v2 offset:40960
    ds_read_b64_tr_b16 v[26:27], v2 offset:41472
    buffer_load_dwordx4 v8, s[16:19], s43 offen offset:3072 lds
    v_mfma_f32_32x32x16_bf16 v[96:111], v[36:39], v[180:183], v[96:111]
    ds_read_b64_tr_b16 v[28:29], v2 offset:45056
    ds_read_b64_tr_b16 v[30:31], v2 offset:45568
    ds_read_b32 v13, v0 offset:28
    ds_read_b32 v14, v0 offset:32
    s_waitcnt lgkmcnt(10)
    s_setprio 2
    v_mfma_f32_32x32x16_bf16 v[96:111], v[40:43], v[184:187], v[96:111]
    s_setprio 0
    ds_read_b64_tr_b16 v[32:33], v3 offset:32768
    ds_read_b64_tr_b16 v[34:35], v3 offset:33280
    v_mfma_f32_32x32x16_bf16 v[96:111], v[44:47], v[188:191], v[96:111]
    ds_read_b64_tr_b16 v[36:37], v3 offset:36864
    ds_read_b64_tr_b16 v[38:39], v3 offset:37376
    s_waitcnt vmcnt(16)
    s_mov_b64 exec, 1
    ds_add_u32 v0, v0 offset:0
    s_mov_b64 exec, -1
    s_waitcnt lgkmcnt(11)
    v_mfma_f32_32x32x16_bf16 v[48:63], v[16:19], v[192:195], v[48:63]
    ds_read_b64_tr_b16 v[40:41], v3 offset:40960
    ds_read_b64_tr_b16 v[42:43], v3 offset:41472
    s_setprio 2
    v_mfma_f32_32x32x16_bf16 v[48:63], v[20:23], v[196:199], v[48:63]
    s_setprio 0
    ds_read_b64_tr_b16 v[44:45], v3 offset:45056
    ds_read_b64_tr_b16 v[46:47], v3 offset:45568
    s_waitcnt lgkmcnt(11)
    v_mfma_f32_32x32x16_bf16 v[48:63], v[24:27], v[200:203], v[48:63]
    ds_read_b64_tr_b16 v[16:17], v4 offset:32768
    ds_read_b64_tr_b16 v[18:19], v4 offset:33280
    v_mfma_f32_32x32x16_bf16 v[48:63], v[28:31], v[204:207], v[48:63]
    ds_read_b64_tr_b16 v[20:21], v4 offset:36864
    ds_read_b64_tr_b16 v[22:23], v4 offset:37376
    s_waitcnt lgkmcnt(9)
    s_setprio 2
    v_mfma_f32_32x32x16_bf16 v[64:79], v[32:35], v[192:195], v[64:79]
    s_setprio 0
    ds_read_b64_tr_b16 v[24:25], v4 offset:40960
    ds_read_b64_tr_b16 v[26:27], v4 offset:41472
    v_mfma_f32_32x32x16_bf16 v[64:79], v[36:39], v[196:199], v[64:79]
    ds_read_b64_tr_b16 v[28:29], v4 offset:45056
    ds_read_b64_tr_b16 v[30:31], v4 offset:45568
    s_waitcnt lgkmcnt(8)
    v_mfma_f32_32x32x16_bf16 v[64:79], v[40:43], v[200:203], v[64:79]
    ds_read_b32 v15, v0 offset:0
    ds_read_b64_tr_b16 v[32:33], v5 offset:32768
    ds_read_b64_tr_b16 v[34:35], v5 offset:33280
    s_setprio 2
    v_mfma_f32_32x32x16_bf16 v[64:79], v[44:47], v[204:207], v[64:79]
    s_setprio 0
    ds_read_b64_tr_b16 v[36:37], v5 offset:36864
    ds_read_b64_tr_b16 v[38:39], v5 offset:37376
    s_waitcnt lgkmcnt(9)
    v_mfma_f32_32x32x16_bf16 v[80:95], v[16:19], v[192:195], v[80:95]
    ds_read_b64_tr_b16 v[40:41], v5 offset:40960
    ds_read_b64_tr_b16 v[42:43], v5 offset:41472
    v_mfma_f32_32x32x16_bf16 v[80:95], v[20:23], v[196:199], v[80:95]
    s_setprio 2
    s_waitcnt lgkmcnt(6)
L_cg23:
    v_cmp_gt_u32 vcc, 368, v15
    s_cbranch_vccz L_cg23_ok
    s_add_u32 s3, s3, 1
    s_cmp_ge_u32 s3, 0x400000
    s_cbranch_scc1 L_cg23_ok
    ds_read_b32 v15, v0 offset:0
    s_waitcnt lgkmcnt(0)
    s_branch L_cg23
L_cg23_ok:
    s_setprio 0
    s_setprio 2
    v_readfirstlane_b32 s60, v13
    v_readfirstlane_b32 s61, v14
    s_setprio 0
    ds_read_b64_tr_b16 v[44:45], v5 offset:45056
    ds_read_b64_tr_b16 v[46:47], v5 offset:45568
    s_add_u32 m0, s45, 16384
    s_add_u32 s43, s66, s47
    buffer_load_dwordx4 v9, s[12:15], s43 offen offset:0 lds
    s_setprio 2
    v_mfma_f32_32x32x16_bf16 v[80:95], v[24:27], v[200:203], v[80:95]
    s_setprio 0
    ds_read_b64_tr_b16 v[16:17], v2 offset:49152
    ds_read_b64_tr_b16 v[18:19], v2 offset:49664
    buffer_load_dwordx4 v10, s[12:15], s43 offen offset:1024 lds
    v_mfma_f32_32x32x16_bf16 v[80:95], v[28:31], v[204:207], v[80:95]
    ds_read_b64_tr_b16 v[20:21], v2 offset:53248
    ds_read_b64_tr_b16 v[22:23], v2 offset:53760
    buffer_load_dwordx4 v7, s[16:19], s43 offen offset:2048 lds
    s_waitcnt lgkmcnt(8)
    v_mfma_f32_32x32x16_bf16 v[96:111], v[32:35], v[192:195], v[96:111]
    ds_read_b64_tr_b16 v[24:25], v2 offset:57344
    ds_read_b64_tr_b16 v[26:27], v2 offset:57856
    buffer_load_dwordx4 v8, s[16:19], s43 offen offset:3072 lds
    s_setprio 2
    v_mfma_f32_32x32x16_bf16 v[96:111], v[36:39], v[196:199], v[96:111]
    s_setprio 0
    ds_read_b64_tr_b16 v[28:29], v2 offset:61440
    ds_read_b64_tr_b16 v[30:31], v2 offset:61952
    s_waitcnt lgkmcnt(8)
    v_mfma_f32_32x32x16_bf16 v[96:111], v[40:43], v[200:203], v[96:111]
    ds_read_b64_tr_b16 v[32:33], v3 offset:49152
    ds_read_b64_tr_b16 v[34:35], v3 offset:49664
    v_mfma_f32_32x32x16_bf16 v[96:111], v[44:47], v[204:207], v[96:111]
    ds_read_b64_tr_b16 v[36:37], v3 offset:53248
    ds_read_b64_tr_b16 v[38:39], v3 offset:53760
    s_waitcnt vmcnt(16)
    s_mov_b64 exec, 1
    ds_add_u32 v0, v0 offset:0
    s_mov_b64 exec, -1
    s_waitcnt lgkmcnt(9)
    s_setprio 2
    v_mfma_f32_32x32x16_bf16 v[48:63], v[16:19], v[208:211], v[48:63]
    s_setprio 0
    ds_read_b64_tr_b16 v[40:41], v3 offset:57344
    ds_read_b64_tr_b16 v[42:43], v3 offset:57856
    v_mfma_f32_32x32x16_bf16 v[48:63], v[20:23], v[212:215], v[48:63]
    ds_read_b64_tr_b16 v[44:45], v3 offset:61440
    ds_read_b64_tr_b16 v[46:47], v3 offset:61952
    s_waitcnt lgkmcnt(9)
    v_mfma_f32_32x32x16_bf16 v[48:63], v[24:27], v[216:219], v[48:63]
    ds_read_b64_tr_b16 v[16:17], v4 offset:49152
    ds_read_b64_tr_b16 v[18:19], v4 offset:49664
    s_setprio 2
    v_mfma_f32_32x32x16_bf16 v[48:63], v[28:31], v[220:223], v[48:63]
    s_setprio 0
    ds_read_b64_tr_b16 v[20:21], v4 offset:53248
    ds_read_b64_tr_b16 v[22:23], v4 offset:53760
    s_waitcnt lgkmcnt(9)
    v_mfma_f32_32x32x16_bf16 v[64:79], v[32:35], v[208:211], v[64:79]
    ds_read_b64_tr_b16 v[24:25], v4 offset:57344
    ds_read_b64_tr_b16 v[26:27], v4 offset:57856
    v_mfma_f32_32x32x16_bf16 v[64:79], v[36:39], v[212:215], v[64:79]
    ds_read_b64_tr_b16 v[28:29], v4 offset:61440
    ds_read_b64_tr_b16 v[30:31], v4 offset:61952
    s_waitcnt lgkmcnt(8)
    s_setprio 2
    v_mfma_f32_32x32x16_bf16 v[64:79], v[40:43], v[216:219], v[64:79]
    s_setprio 0
    ds_read_b32 v15, v0 offset:0
    ds_read_b64_tr_b16 v[32:33], v5 offset:49152
    ds_read_b64_tr_b16 v[34:35], v5 offset:49664
    v_mfma_f32_32x32x16_bf16 v[64:79], v[44:47], v[220:223], v[64:79]
    ds_read_b64_tr_b16 v[36:37], v5 offset:53248
    ds_read_b64_tr_b16 v[38:39], v5 offset:53760
    s_waitcnt lgkmcnt(9)
    v_mfma_f32_32x32x16_bf16 v[80:95], v[16:19], v[208:211], v[80:95]
    ds_read_b64_tr_b16 v[40:41], v5 offset:57344
    ds_read_b64_tr_b16 v[42:43], v5 offset:57856
    s_setprio 2
    v_mfma_f32_32x32x16_bf16 v[80:95], v[20:23], v[212:215], v[80:95]
    s_setprio 0
    s_setprio 2
    s_waitcnt lgkmcnt(6)
L_cg24:
    v_cmp_gt_u32 vcc, 384, v15
    s_cbranch_vccz L_cg24_ok
    s_add_u32 s3, s3, 1
    s_cmp_ge_u32 s3, 0x400000
    s_cbranch_scc1 L_cg24_ok
    ds_read_b32 v15, v0 offset:0
    s_waitcnt lgkmcnt(0)
    s_branch L_cg24
L_cg24_ok:
    s_setprio 0
    ds_read_b64_tr_b16 v[44:45], v5 offset:61440
    ds_read_b64_tr_b16 v[46:47], v5 offset:61952
    s_add_u32 m0, s45, 32768
    s_add_u32 s43, s67, s47
    buffer_load_dwordx4 v9, s[12:15], s43 offen offset:0 lds
    v_mfma_f32_32x32x16_bf16 v[80:95], v[24:27], v[216:219], v[80:95]
    s_setprio 2
    v_add_u32 v2, 65536, v2
    v_add_u32 v3, 65536, v3
    v_add_u32 v4, 65536, v4
    v_add_u32 v5, 65536, v5
    s_setprio 0
    ds_read_b64_tr_b16 v[16:17], v2 offset:0
    ds_read_b64_tr_b16 v[18:19], v2 offset:512
    buffer_load_dwordx4 v10, s[12:15], s43 offen offset:1024 lds
    v_mfma_f32_32x32x16_bf16 v[80:95], v[28:31], v[220:223], v[80:95]
    ds_read_b64_tr_b16 v[20:21], v2 offset:4096
    ds_read_b64_tr_b16 v[22:23], v2 offset:4608
    buffer_load_dwordx4 v7, s[16:19], s43 offen offset:2048 lds
    s_waitcnt lgkmcnt(8)
    s_setprio 2
    v_mfma_f32_32x32x16_bf16 v[96:111], v[32:35], v[208:211], v[96:111]
    s_setprio 0
    ds_read_b64_tr_b16 v[24:25], v2 offset:8192
    ds_read_b64_tr_b16 v[26:27], v2 offset:8704
    buffer_load_dwordx4 v8, s[16:19], s43 offen offset:3072 lds
    v_mfma_f32_32x32x16_bf16 v[96:111], v[36:39], v[212:215], v[96:111]
    ds_read_b64_tr_b16 v[28:29], v2 offset:12288
    ds_read_b64_tr_b16 v[30:31], v2 offset:12800
    s_waitcnt lgkmcnt(8)
    v_mfma_f32_32x32x16_bf16 v[96:111], v[40:43], v[216:219], v[96:111]
    ds_read_b64_tr_b16 v[32:33], v3 offset:0
    ds_read_b64_tr_b16 v[34:35], v3 offset:512
    s_setprio 2
    v_mfma_f32_32x32x16_bf16 v[96:111], v[44:47], v[220:223], v[96:111]
    s_setprio 0
    ds_read_b64_tr_b16 v[36:37], v3 offset:4096
    ds_read_b64_tr_b16 v[38:39], v3 offset:4608
    s_waitcnt vmcnt(16)
    s_mov_b64 exec, 1
    ds_add_u32 v0, v0 offset:0
    s_mov_b64 exec, -1
    s_waitcnt lgkmcnt(9)
    v_mfma_f32_32x32x16_bf16 v[48:63], v[16:19], v[224:227], v[48:63]
    ds_read_b64_tr_b16 v[40:41], v3 offset:8192
    ds_read_b64_tr_b16 v[42:43], v3 offset:8704
    v_mfma_f32_32x32x16_bf16 v[48:63], v[20:23], v[228:231], v[48:63]
    ds_read_b64_tr_b16 v[44:45], v3 offset:12288
    ds_read_b64_tr_b16 v[46:47], v3 offset:12800
    s_waitcnt lgkmcnt(9)
    s_setprio 2
    v_mfma_f32_32x32x16_bf16 v[48:63], v[24:27], v[232:235], v[48:63]
    s_setprio 0
    ds_read_b64_tr_b16 v[16:17], v4 offset:0
    ds_read_b64_tr_b16 v[18:19], v4 offset:512
    v_mfma_f32_32x32x16_bf16 v[48:63], v[28:31], v[236:239], v[48:63]
    ds_read_b64_tr_b16 v[20:21], v4 offset:4096
    ds_read_b64_tr_b16 v[22:23], v4 offset:4608
    s_waitcnt lgkmcnt(9)
    v_mfma_f32_32x32x16_bf16 v[64:79], v[32:35], v[224:227], v[64:79]
    ds_read_b64_tr_b16 v[24:25], v4 offset:8192
    ds_read_b64_tr_b16 v[26:27], v4 offset:8704
    s_setprio 2
    v_mfma_f32_32x32x16_bf16 v[64:79], v[36:39], v[228:231], v[64:79]
    s_setprio 0
    ds_read_b64_tr_b16 v[28:29], v4 offset:12288
    ds_read_b64_tr_b16 v[30:31], v4 offset:12800
    s_waitcnt lgkmcnt(8)
    v_mfma_f32_32x32x16_bf16 v[64:79], v[40:43], v[232:235], v[64:79]
    ds_read_b32 v15, v0 offset:0
    ds_read_b64_tr_b16 v[32:33], v5 offset:0
    ds_read_b64_tr_b16 v[34:35], v5 offset:512
    v_mfma_f32_32x32x16_bf16 v[64:79], v[44:47], v[236:239], v[64:79]
    ds_read_b64_tr_b16 v[36:37], v5 offset:4096
    ds_read_b64_tr_b16 v[38:39], v5 offset:4608
    s_waitcnt lgkmcnt(9)
    s_setprio 2
    v_mfma_f32_32x32x16_bf16 v[80:95], v[16:19], v[224:227], v[80:95]
    s_setprio 0
    ds_read_b64_tr_b16 v[40:41], v5 offset:8192
    ds_read_b64_tr_b16 v[42:43], v5 offset:8704
    v_mfma_f32_32x32x16_bf16 v[80:95], v[20:23], v[228:231], v[80:95]
    s_setprio 2
    s_waitcnt lgkmcnt(6)
L_cg25:
    v_cmp_gt_u32 vcc, 400, v15
    s_cbranch_vccz L_cg25_ok
    s_add_u32 s3, s3, 1
    s_cmp_ge_u32 s3, 0x400000
    s_cbranch_scc1 L_cg25_ok
    ds_read_b32 v15, v0 offset:0
    s_waitcnt lgkmcnt(0)
    s_branch L_cg25
L_cg25_ok:
    s_setprio 0
    ds_read_b64_tr_b16 v[44:45], v5 offset:12288
    ds_read_b64_tr_b16 v[46:47], v5 offset:12800
    s_add_u32 m0, s45, 49152
    s_add_u32 s43, s68, s47
    buffer_load_dwordx4 v9, s[12:15], s43 offen offset:0 lds
    v_mfma_f32_32x32x16_bf16 v[80:95], v[24:27], v[232:235], v[80:95]
    ds_read_b64_tr_b16 v[16:17], v2 offset:16384
    ds_read_b64_tr_b16 v[18:19], v2 offset:16896
    buffer_load_dwordx4 v10, s[12:15], s43 offen offset:1024 lds
    s_setprio 2
    v_mfma_f32_32x32x16_bf16 v[80:95], v[28:31], v[236:239], v[80:95]
    s_setprio 0
    ds_read_b64_tr_b16 v[20:21], v2 offset:20480
    ds_read_b64_tr_b16 v[22:23], v2 offset:20992
    buffer_load_dwordx4 v7, s[16:19], s43 offen offset:2048 lds
    s_waitcnt lgkmcnt(8)
    v_mfma_f32_32x32x16_bf16 v[96:111], v[32:35], v[224:227], v[96:111]
    ds_read_b64_tr_b16 v[24:25], v2 offset:24576
    ds_read_b64_tr_b16 v[26:27], v2 offset:25088
    buffer_load_dwordx4 v8, s[16:19], s43 offen offset:3072 lds
    v_mfma_f32_32x32x16_bf16 v[96:111], v[36:39], v[228:231], v[96:111]
    ds_read_b64_tr_b16 v[28:29], v2 offset:28672
    ds_read_b64_tr_b16 v[30:31], v2 offset:29184
    s_waitcnt lgkmcnt(8)
    s_setprio 2
    v_mfma_f32_32x32x16_bf16 v[96:111], v[40:43], v[232:235], v[96:111]
    s_setprio 0
    ds_read_b64_tr_b16 v[32:33], v3 offset:16384
    ds_read_b64_tr_b16 v[34:35], v3 offset:16896
    v_mfma_f32_32x32x16_bf16 v[96:111], v[44:47], v[236:239], v[96:111]
    ds_read_b64_tr_b16 v[36:37], v3 offset:20480
    ds_read_b64_tr_b16 v[38:39], v3 offset:20992
    s_waitcnt vmcnt(16)
    s_mov_b64 exec, 1
    ds_add_u32 v0, v0 offset:0
    s_mov_b64 exec, -1
    s_waitcnt lgkmcnt(9)
    v_mfma_f32_32x32x16_bf16 v[48:63], v[16:19], v[240:243], v[48:63]
    ds_read_b64_tr_b16 v[40:41], v3 offset:24576
    ds_read_b64_tr_b16 v[42:43], v3 offset:25088
    s_setprio 2
    v_mfma_f32_32x32x16_bf16 v[48:63], v[20:23], v[244:247], v[48:63]
    s_setprio 0
    ds_read_b64_tr_b16 v[44:45], v3 offset:28672
    ds_read_b64_tr_b16 v[46:47], v3 offset:29184
    s_waitcnt lgkmcnt(9)
    v_mfma_f32_32x32x16_bf16 v[48:63], v[24:27], v[248:251], v[48:63]
    ds_read_b64_tr_b16 v[16:17], v4 offset:16384
    ds_read_b64_tr_b16 v[18:19], v4 offset:16896
    v_mfma_f32_32x32x16_bf16 v[48:63], v[28:31], v[252:255], v[48:63]
    ds_read_b64_tr_b16 v[20:21], v4 offset:20480
    ds_read_b64_tr_b16 v[22:23], v4 offset:20992
    s_waitcnt lgkmcnt(9)
    s_setprio 2
    v_mfma_f32_32x32x16_bf16 v[64:79], v[32:35], v[240:243], v[64:79]
    ds_read_b64_tr_b16 v[24:25], v4 offset:24576
    ds_read_b64_tr_b16 v[26:27], v4 offset:25088
    s_nop 4
    v_max_f32 v48, 0, v48
    v_max_f32 v49, 0, v49
    v_mfma_f32_32x32x16_bf16 v[64:79], v[36:39], v[244:247], v[64:79]
    ds_read_b64_tr_b16 v[28:29], v4 offset:28672
    ds_read_b64_tr_b16 v[30:31], v4 offset:29184
    v_max_f32 v50, 0, v50
    v_max_f32 v51, 0, v51
    s_waitcnt lgkmcnt(8)
    v_mfma_f32_32x32x16_bf16 v[64:79], v[40:43], v[248:251], v[64:79]
    ds_read_b32 v15, v0 offset:0
    ds_read_b64_tr_b16 v[32:33], v5 offset:16384
    ds_read_b64_tr_b16 v[34:35], v5 offset:16896
    v_max_f32 v52, 0, v52
    v_max_f32 v53, 0, v53
    v_mfma_f32_32x32x16_bf16 v[64:79], v[44:47], v[252:255], v[64:79]
    ds_read_b64_tr_b16 v[36:37], v5 offset:20480
    ds_read_b64_tr_b16 v[38:39], v5 offset:20992
    v_max_f32 v54, 0, v54
    v_max_f32 v55, 0, v55
    s_waitcnt lgkmcnt(9)
    v_mfma_f32_32x32x16_bf16 v[80:95], v[16:19], v[240:243], v[80:95]
    ds_read_b64_tr_b16 v[40:41], v5 offset:24576
    ds_read_b64_tr_b16 v[42:43], v5 offset:25088
    v_mul_f32 v48, v48, v56
    v_mul_f32 v49, v49, v57
    v_mfma_f32_32x32x16_bf16 v[80:95], v[20:23], v[244:247], v[80:95]
    s_waitcnt lgkmcnt(6)
L_cg26:
    v_cmp_gt_u32 vcc, 416, v15
    s_cbranch_vccz L_cg26_ok
    s_add_u32 s3, s3, 1
    s_cmp_ge_u32 s3, 0x400000
    s_cbranch_scc1 L_cg26_ok
    ds_read_b32 v15, v0 offset:0
    s_waitcnt lgkmcnt(0)
    s_branch L_cg26
L_cg26_ok:
    ds_read_b64_tr_b16 v[44:45], v5 offset:28672
    ds_read_b64_tr_b16 v[46:47], v5 offset:29184
    s_add_u32 m0, s45, 65536
    s_add_u32 s43, s69, s47
    buffer_load_dwordx4 v9, s[12:15], s43 offen offset:0 lds
    v_mul_f32 v50, v50, v58
    v_mul_f32 v51, v51, v59
    v_mfma_f32_32x32x16_bf16 v[80:95], v[24:27], v[248:251], v[80:95]
    ds_read_b64_tr_b16 v[16:17], v2 offset:32768
    ds_read_b64_tr_b16 v[18:19], v2 offset:33280
    buffer_load_dwordx4 v10, s[12:15], s43 offen offset:1024 lds
    v_mul_f32 v52, v52, v60
    v_mul_f32 v53, v53, v61
    v_mfma_f32_32x32x16_bf16 v[80:95], v[28:31], v[252:255], v[80:95]
    ds_read_b64_tr_b16 v[20:21], v2 offset:36864
    ds_read_b64_tr_b16 v[22:23], v2 offset:37376
    buffer_load_dwordx4 v7, s[16:19], s43 offen offset:2048 lds
    v_mul_f32 v54, v54, v62
    v_mul_f32 v55, v55, v63
    s_waitcnt lgkmcnt(8)
    v_mfma_f32_32x32x16_bf16 v[96:111], v[32:35], v[240:243], v[96:111]
    ds_read_b64_tr_b16 v[24:25], v2 offset:40960
    ds_read_b64_tr_b16 v[26:27], v2 offset:41472
    buffer_load_dwordx4 v8, s[16:19], s43 offen offset:3072 lds
    v_cvt_pk_bf16_f32 v56, v48, v49
    v_cvt_pk_bf16_f32 v57, v50, v51
    v_mfma_f32_32x32x16_bf16 v[96:111], v[36:39], v[244:247], v[96:111]
    ds_read_b64_tr_b16 v[28:29], v2 offset:45056
    ds_read_b64_tr_b16 v[30:31], v2 offset:45568
    v_cvt_pk_bf16_f32 v58, v52, v53
    v_cvt_pk_bf16_f32 v59, v54, v55
    s_waitcnt lgkmcnt(8)
    v_mfma_f32_32x32x16_bf16 v[96:111], v[40:43], v[248:251], v[96:111]
    ds_read_b64_tr_b16 v[32:33], v3 offset:32768
    ds_read_b64_tr_b16 v[34:35], v3 offset:33280
    s_add_u32 s52, s50, 6144
    buffer_store_dwordx4 v[56:59], v11, s[24:27], s52 offen sc1
    v_mfma_f32_32x32x16_bf16 v[96:111], v[44:47], v[252:255], v[96:111]
    ds_read_b64_tr_b16 v[36:37], v3 offset:36864
    ds_read_b64_tr_b16 v[38:39], v3 offset:37376
    v_max_f32 v64, 0, v64
    v_max_f32 v65, 0, v65
    s_waitcnt vmcnt(17)
    s_mov_b64 exec, 1
    ds_add_u32 v0, v0 offset:0
    s_mov_b64 exec, -1
    s_waitcnt lgkmcnt(9)
    v_mfma_f32_32x32x16_bf16 v[48:63], v[16:19], v[112:115], 0
    ds_read_b64_tr_b16 v[40:41], v3 offset:40960
    ds_read_b64_tr_b16 v[42:43], v3 offset:41472
    v_max_f32 v66, 0, v66
    v_max_f32 v67, 0, v67
    v_mfma_f32_32x32x16_bf16 v[48:63], v[20:23], v[116:119], v[48:63]
    ds_read_b64_tr_b16 v[44:45], v3 offset:45056
    ds_read_b64_tr_b16 v[46:47], v3 offset:45568
    v_max_f32 v68, 0, v68
    v_max_f32 v69, 0, v69
    s_waitcnt lgkmcnt(9)
    v_mfma_f32_32x32x16_bf16 v[48:63], v[24:27], v[120:123], v[48:63]
    ds_read_b64_tr_b16 v[16:17], v4 offset:32768
    ds_read_b64_tr_b16 v[18:19], v4 offset:33280
    v_max_f32 v70, 0, v70
    v_max_f32 v71, 0, v71
    v_mfma_f32_32x32x16_bf16 v[48:63], v[28:31], v[124:127], v[48:63]
    ds_read_b64_tr_b16 v[20:21], v4 offset:36864
    ds_read_b64_tr_b16 v[22:23], v4 offset:37376
    v_mul_f32 v64, v64, v72
    v_mul_f32 v65, v65, v73
    v_mul_f32 v66, v66, v74
    v_mul_f32 v67, v67, v75
    v_mul_f32 v68, v68, v76
    v_mul_f32 v69, v69, v77
    v_mul_f32 v70, v70, v78
    v_mul_f32 v71, v71, v79
    v_cvt_pk_bf16_f32 v72, v64, v65
    v_cvt_pk_bf16_f32 v73, v66, v67
    v_cvt_pk_bf16_f32 v74, v68, v69
    v_cvt_pk_bf16_f32 v75, v70, v71
    s_add_u32 s52, s50, 7168
    buffer_store_dwordx4 v[72:75], v11, s[24:27], s52 offen sc1
    s_waitcnt lgkmcnt(9)
    s_nop 0
    v_mfma_f32_32x32x16_bf16 v[64:79], v[32:35], v[112:115], 0
    ds_read_b64_tr_b16 v[24:25], v4 offset:40960
    ds_read_b64_tr_b16 v[26:27], v4 offset:41472
    v_max_f32 v80, 0, v80
    v_max_f32 v81, 0, v81
    v_mfma_f32_32x32x16_bf16 v[64:79], v[36:39], v[116:119], v[64:79]
    ds_read_b64_tr_b16 v[28:29], v4 offset:45056
    ds_read_b64_tr_b16 v[30:31], v4 offset:45568
    v_max_f32 v82, 0, v82
    v_max_f32 v83, 0, v83
    s_waitcnt lgkmcnt(8)
    v_mfma_f32_32x32x16_bf16 v[64:79], v[40:43], v[120:123], v[64:79]
    ds_read_b32 v15, v0 offset:0
    ds_read_b64_tr_b16 v[32:33], v5 offset:32768
    ds_read_b64_tr_b16 v[34:35], v5 offset:33280
    v_max_f32 v84, 0, v84
    v_max_f32 v85, 0, v85
    v_mfma_f32_32x32x16_bf16 v[64:79], v[44:47], v[124:127], v[64:79]
    ds_read_b64_tr_b16 v[36:37], v5 offset:36864
    ds_read_b64_tr_b16 v[38:39], v5 offset:37376
    v_max_f32 v86, 0, v86
    v_max_f32 v87, 0, v87
    v_mul_f32 v80, v80, v88
    v_mul_f32 v81, v81, v89
    v_mul_f32 v82, v82, v90
    v_mul_f32 v83, v83, v91
    v_mul_f32 v84, v84, v92
    v_mul_f32 v85, v85, v93
    v_mul_f32 v86, v86, v94
    v_mul_f32 v87, v87, v95
    v_cvt_pk_bf16_f32 v88, v80, v81
    v_cvt_pk_bf16_f32 v89, v82, v83
    v_cvt_pk_bf16_f32 v90, v84, v85
    v_cvt_pk_bf16_f32 v91, v86, v87
    s_add_u32 s52, s50, 8192
    buffer_store_dwordx4 v[88:91], v11, s[24:27], s52 offen sc1
    s_waitcnt lgkmcnt(9)
    s_nop 0
    v_mfma_f32_32x32x16_bf16 v[80:95], v[16:19], v[112:115], 0
    ds_read_b64_tr_b16 v[40:41], v5 offset:40960
    ds_read_b64_tr_b16 v[42:43], v5 offset:41472
    v_max_f32 v96, 0, v96
    v_max_f32 v97, 0, v97
    v_mfma_f32_32x32x16_bf16 v[80:95], v[20:23], v[116:119], v[80:95]
    s_waitcnt lgkmcnt(6)
L_cg27:
    v_cmp_gt_u32 vcc, 432, v15
    s_cbranch_vccz L_cg27_ok
    s_add_u32 s3, s3, 1
    s_cmp_ge_u32 s3, 0x400000
    s_cbranch_scc1 L_cg27_ok
    ds_read_b32 v15, v0 offset:0
    s_waitcnt lgkmcnt(0)
    s_branch L_cg27
L_cg27_ok:
    ds_read_b64_tr_b16 v[44:45], v5 offset:45056
    ds_read_b64_tr_b16 v[46:47], v5 offset:45568
    s_add_u32 m0, s45, 81920
    s_add_u32 s43, s70, s47
    buffer_load_dwordx4 v9, s[12:15], s43 offen offset:0 lds
    v_max_f32 v98, 0, v98
    v_max_f32 v99, 0, v99
    v_mfma_f32_32x32x16_bf16 v[80:95], v[24:27], v[120:123], v[80:95]
    v_subrev_u32 v2, 65536, v2
    v_subrev_u32 v3, 65536, v3
    v_subrev_u32 v4, 65536, v4
    v_subrev_u32 v5, 65536, v5
    ds_read_b64_tr_b16 v[16:17], v2 offset:0
    ds_read_b64_tr_b16 v[18:19], v2 offset:512
    buffer_load_dwordx4 v10, s[12:15], s43 offen offset:1024 lds
    v_max_f32 v100, 0, v100
    v_max_f32 v101, 0, v101
    v_mfma_f32_32x32x16_bf16 v[80:95], v[28:31], v[124:127], v[80:95]
    ds_read_b64_tr_b16 v[20:21], v2 offset:4096
    ds_read_b64_tr_b16 v[22:23], v2 offset:4608
    buffer_load_dwordx4 v7, s[16:19], s43 offen offset:2048 lds
    v_max_f32 v102, 0, v102
    v_max_f32 v103, 0, v103
    v_mul_f32 v96, v96, v104
    v_mul_f32 v97, v97, v105
    v_mul_f32 v98, v98, v106
    v_mul_f32 v99, v99, v107
    v_mul_f32 v100, v100, v108
    v_mul_f32 v101, v101, v109
    v_mul_f32 v102, v102, v110
    v_mul_f32 v103, v103, v111
    v_cvt_pk_bf16_f32 v104, v96, v97
    v_cvt_pk_bf16_f32 v105, v98, v99
    v_cvt_pk_bf16_f32 v106, v100, v101
    v_cvt_pk_bf16_f32 v107, v102, v103
    s_add_u32 s52, s50, 9216
    buffer_store_dwordx4 v[104:107], v11, s[24:27], s52 offen sc1
    s_waitcnt lgkmcnt(8)
    s_nop 0
    v_mfma_f32_32x32x16_bf16 v[96:111], v[32:35], v[112:115], 0
    s_setprio 0
    ds_read_b64_tr_b16 v[24:25], v2 offset:8192
    ds_read_b64_tr_b16 v[26:27], v2 offset:8704
    buffer_load_dwordx4 v8, s[16:19], s43 offen offset:3072 lds
    v_mfma_f32_32x32x16_bf16 v[96:111], v[36:39], v[116:119], v[96:111]
    ds_read_b64_tr_b16 v[28:29], v2 offset:12288
    ds_read_b64_tr_b16 v[30:31], v2 offset:12800
    s_waitcnt lgkmcnt(8)
    v_mfma_f32_32x32x16_bf16 v[96:111], v[40:43], v[120:123], v[96:111]
    ds_read_b64_tr_b16 v[32:33], v3 offset:0
    ds_read_b64_tr_b16 v[34:35], v3 offset:512
    s_setprio 2
    v_mfma_f32_32x32x16_bf16 v[96:111], v[44:47], v[124:127], v[96:111]
    s_setprio 0
    ds_read_b64_tr_b16 v[36:37], v3 offset:4096
    ds_read_b64_tr_b16 v[38:39], v3 offset:4608
    s_waitcnt vmcnt(20)
    s_mov_b64 exec, 1
    ds_add_u32 v0, v0 offset:0
    s_mov_b64 exec, -1
    s_waitcnt lgkmcnt(9)
    v_mfma_f32_32x32x16_bf16 v[48:63], v[16:19], v[128:131], v[48:63]
    ds_read_b64_tr_b16 v[40:41], v3 offset:8192
    ds_read_b64_tr_b16 v[42:43], v3 offset:8704
    v_mfma_f32_32x32x16_bf16 v[48:63], v[20:23], v[132:135], v[48:63]
    ds_read_b64_tr_b16 v[44:45], v3 offset:12288
    ds_read_b64_tr_b16 v[46:47], v3 offset:12800
    s_waitcnt lgkmcnt(9)
    s_setprio 2
    v_mfma_f32_32x32x16_bf16 v[48:63], v[24:27], v[136:139], v[48:63]
    s_setprio 0
    ds_read_b64_tr_b16 v[16:17], v4 offset:0
    ds_read_b64_tr_b16 v[18:19], v4 offset:512
    v_mfma_f32_32x32x16_bf16 v[48:63], v[28:31], v[140:143], v[48:63]
    ds_read_b64_tr_b16 v[20:21], v4 offset:4096
    ds_read_b64_tr_b16 v[22:23], v4 offset:4608
    s_waitcnt lgkmcnt(9)
    v_mfma_f32_32x32x16_bf16 v[64:79], v[32:35], v[128:131], v[64:79]
    ds_read_b64_tr_b16 v[24:25], v4 offset:8192
    ds_read_b64_tr_b16 v[26:27], v4 offset:8704
    s_setprio 2
    v_mfma_f32_32x32x16_bf16 v[64:79], v[36:39], v[132:135], v[64:79]
    s_setprio 0
    ds_read_b64_tr_b16 v[28:29], v4 offset:12288
    ds_read_b64_tr_b16 v[30:31], v4 offset:12800
    s_waitcnt lgkmcnt(8)
    v_mfma_f32_32x32x16_bf16 v[64:79], v[40:43], v[136:139], v[64:79]
    ds_read_b32 v15, v0 offset:0
    ds_read_b64_tr_b16 v[32:33], v5 offset:0
    ds_read_b64_tr_b16 v[34:35], v5 offset:512
    v_mfma_f32_32x32x16_bf16 v[64:79], v[44:47], v[140:143], v[64:79]
    ds_read_b64_tr_b16 v[36:37], v5 offset:4096
    ds_read_b64_tr_b16 v[38:39], v5 offset:4608
    s_waitcnt lgkmcnt(9)
    s_setprio 2
    v_mfma_f32_32x32x16_bf16 v[80:95], v[16:19], v[128:131], v[80:95]
    s_setprio 0
    ds_read_b64_tr_b16 v[40:41], v5 offset:8192
    ds_read_b64_tr_b16 v[42:43], v5 offset:8704
    v_mfma_f32_32x32x16_bf16 v[80:95], v[20:23], v[132:135], v[80:95]
    s_setprio 2
    s_waitcnt lgkmcnt(6)
L_cg28:
    v_cmp_gt_u32 vcc, 448, v15
    s_cbranch_vccz L_cg28_ok
    s_add_u32 s3, s3, 1
    s_cmp_ge_u32 s3, 0x400000
    s_cbranch_scc1 L_cg28_ok
    ds_read_b32 v15, v0 offset:0
    s_waitcnt lgkmcnt(0)
    s_branch L_cg28
L_cg28_ok:
    s_setprio 0
    ds_read_b64_tr_b16 v[44:45], v5 offset:12288
    ds_read_b64_tr_b16 v[46:47], v5 offset:12800
    s_add_u32 m0, s45, 98304
    s_add_u32 s43, s71, s47
    buffer_load_dwordx4 v9, s[12:15], s43 offen offset:0 lds
    v_mfma_f32_32x32x16_bf16 v[80:95], v[24:27], v[136:139], v[80:95]
    ds_read_b64_tr_b16 v[16:17], v2 offset:16384
    ds_read_b64_tr_b16 v[18:19], v2 offset:16896
    buffer_load_dwordx4 v10, s[12:15], s43 offen offset:1024 lds
    s_setprio 2
    v_mfma_f32_32x32x16_bf16 v[80:95], v[28:31], v[140:143], v[80:95]
    s_setprio 0
    ds_read_b64_tr_b16 v[20:21], v2 offset:20480
    ds_read_b64_tr_b16 v[22:23], v2 offset:20992
    buffer_load_dwordx4 v7, s[16:19], s43 offen offset:2048 lds
    s_waitcnt lgkmcnt(8)
    v_mfma_f32_32x32x16_bf16 v[96:111], v[32:35], v[128:131], v[96:111]
    ds_read_b64_tr_b16 v[24:25], v2 offset:24576
    ds_read_b64_tr_b16 v[26:27], v2 offset:25088
    buffer_load_dwordx4 v8, s[16:19], s43 offen offset:3072 lds
    v_mfma_f32_32x32x16_bf16 v[96:111], v[36:39], v[132:135], v[96:111]
    ds_read_b64_tr_b16 v[28:29], v2 offset:28672
    ds_read_b64_tr_b16 v[30:31], v2 offset:29184
    s_waitcnt lgkmcnt(8)
    s_setprio 2
    v_mfma_f32_32x32x16_bf16 v[96:111], v[40:43], v[136:139], v[96:111]
    s_setprio 0
    ds_read_b64_tr_b16 v[32:33], v3 offset:16384
    ds_read_b64_tr_b16 v[34:35], v3 offset:16896
    v_mfma_f32_32x32x16_bf16 v[96:111], v[44:47], v[140:143], v[96:111]
    ds_read_b64_tr_b16 v[36:37], v3 offset:20480
    ds_read_b64_tr_b16 v[38:39], v3 offset:20992
    s_waitcnt vmcnt(20)
    s_mov_b64 exec, 1
    ds_add_u32 v0, v0 offset:0
    s_mov_b64 exec, -1
    s_waitcnt lgkmcnt(9)
    v_mfma_f32_32x32x16_bf16 v[48:63], v[16:19], v[144:147], v[48:63]
    ds_read_b64_tr_b16 v[40:41], v3 offset:24576
    ds_read_b64_tr_b16 v[42:43], v3 offset:25088
    s_setprio 2
    v_mfma_f32_32x32x16_bf16 v[48:63], v[20:23], v[148:151], v[48:63]
    s_setprio 0
    ds_read_b64_tr_b16 v[44:45], v3 offset:28672
    ds_read_b64_tr_b16 v[46:47], v3 offset:29184
    s_waitcnt lgkmcnt(9)
    v_mfma_f32_32x32x16_bf16 v[48:63], v[24:27], v[152:155], v[48:63]
    ds_read_b64_tr_b16 v[16:17], v4 offset:16384
    ds_read_b64_tr_b16 v[18:19], v4 offset:16896
    v_mfma_f32_32x32x16_bf16 v[48:63], v[28:31], v[156:159], v[48:63]
    ds_read_b64_tr_b16 v[20:21], v4 offset:20480
    ds_read_b64_tr_b16 v[22:23], v4 offset:20992
    s_waitcnt lgkmcnt(9)
    s_setprio 2
    v_mfma_f32_32x32x16_bf16 v[64:79], v[32:35], v[144:147], v[64:79]
    s_setprio 0
    ds_read_b64_tr_b16 v[24:25], v4 offset:24576
    ds_read_b64_tr_b16 v[26:27], v4 offset:25088
    v_mfma_f32_32x32x16_bf16 v[64:79], v[36:39], v[148:151], v[64:79]
    ds_read_b64_tr_b16 v[28:29], v4 offset:28672
    ds_read_b64_tr_b16 v[30:31], v4 offset:29184
    s_waitcnt lgkmcnt(8)
    v_mfma_f32_32x32x16_bf16 v[64:79], v[40:43], v[152:155], v[64:79]
    ds_read_b32 v15, v0 offset:0
    ds_read_b64_tr_b16 v[32:33], v5 offset:16384
    ds_read_b64_tr_b16 v[34:35], v5 offset:16896
    s_setprio 2
    v_mfma_f32_32x32x16_bf16 v[64:79], v[44:47], v[156:159], v[64:79]
    s_setprio 0
    ds_read_b64_tr_b16 v[36:37], v5 offset:20480
    ds_read_b64_tr_b16 v[38:39], v5 offset:20992
    s_waitcnt lgkmcnt(9)
    v_mfma_f32_32x32x16_bf16 v[80:95], v[16:19], v[144:147], v[80:95]
    ds_read_b64_tr_b16 v[40:41], v5 offset:24576
    ds_read_b64_tr_b16 v[42:43], v5 offset:25088
    v_mfma_f32_32x32x16_bf16 v[80:95], v[20:23], v[148:151], v[80:95]
    s_setprio 2
    s_waitcnt lgkmcnt(6)
L_cg29:
    v_cmp_gt_u32 vcc, 464, v15
    s_cbranch_vccz L_cg29_ok
    s_add_u32 s3, s3, 1
    s_cmp_ge_u32 s3, 0x400000
    s_cbranch_scc1 L_cg29_ok
    ds_read_b32 v15, v0 offset:0
    s_waitcnt lgkmcnt(0)
    s_branch L_cg29
L_cg29_ok:
    s_setprio 0
    ds_read_b64_tr_b16 v[44:45], v5 offset:28672
    ds_read_b64_tr_b16 v[46:47], v5 offset:29184
    s_add_u32 m0, s45, 0
    s_add_u32 s43, s72, s47
    s_add_u32 s47, s47, 128
    buffer_load_dwordx4 v9, s[12:15], s43 offen offset:0 lds
    s_setprio 2
    v_mfma_f32_32x32x16_bf16 v[80:95], v[24:27], v[152:155], v[80:95]
    s_setprio 0
    ds_read_b64_tr_b16 v[16:17], v2 offset:32768
    ds_read_b64_tr_b16 v[18:19], v2 offset:33280
    buffer_load_dwordx4 v10, s[12:15], s43 offen offset:1024 lds
    v_mfma_f32_32x32x16_bf16 v[80:95], v[28:31], v[156:159], v[80:95]
    ds_read_b64_tr_b16 v[20:21], v2 offset:36864
    ds_read_b64_tr_b16 v[22:23], v2 offset:37376
    buffer_load_dwordx4 v7, s[16:19], s43 offen offset:2048 lds
    s_waitcnt lgkmcnt(8)
    v_mfma_f32_32x32x16_bf16 v[96:111], v[32:35], v[144:147], v[96:111]
    ds_read_b64_tr_b16 v[24:25], v2 offset:40960
    ds_read_b64_tr_b16 v[26:27], v2 offset:41472
    buffer_load_dwordx4 v8, s[16:19], s43 offen offset:3072 lds
    s_setprio 2
    v_mfma_f32_32x32x16_bf16 v[96:111], v[36:39], v[148:151], v[96:111]
    s_setprio 0
    ds_read_b64_tr_b16 v[28:29], v2 offset:45056
    ds_read_b64_tr_b16 v[30:31], v2 offset:45568
    s_waitcnt lgkmcnt(8)
    v_mfma_f32_32x32x16_bf16 v[96:111], v[40:43], v[152:155], v[96:111]
    ds_read_b64_tr_b16 v[32:33], v3 offset:32768
    ds_read_b64_tr_b16 v[34:35], v3 offset:33280
    v_mfma_f32_32x32x16_bf16 v[96:111], v[44:47], v[156:159], v[96:111]
    ds_read_b64_tr_b16 v[36:37], v3 offset:36864
    ds_read_b64_tr_b16 v[38:39], v3 offset:37376
    s_waitcnt vmcnt(20)
    s_mov_b64 exec, 1
    ds_add_u32 v0, v0 offset:0
    s_mov_b64 exec, -1
    s_waitcnt lgkmcnt(9)
    s_setprio 2
    v_mfma_f32_32x32x16_bf16 v[48:63], v[16:19], v[160:163], v[48:63]
    s_setprio 0
    ds_read_b64_tr_b16 v[40:41], v3 offset:40960
    ds_read_b64_tr_b16 v[42:43], v3 offset:41472
    v_mfma_f32_32x32x16_bf16 v[48:63], v[20:23], v[164:167], v[48:63]
    ds_read_b64_tr_b16 v[44:45], v3 offset:45056
    ds_read_b64_tr_b16 v[46:47], v3 offset:45568
    s_waitcnt lgkmcnt(9)
    v_mfma_f32_32x32x16_bf16 v[48:63], v[24:27], v[168:171], v[48:63]
    ds_read_b64_tr_b16 v[16:17], v4 offset:32768
    ds_read_b64_tr_b16 v[18:19], v4 offset:33280
    s_setprio 2
    v_mfma_f32_32x32x16_bf16 v[48:63], v[28:31], v[172:175], v[48:63]
    s_setprio 0
    ds_read_b64_tr_b16 v[20:21], v4 offset:36864
    ds_read_b64_tr_b16 v[22:23], v4 offset:37376
    s_waitcnt lgkmcnt(9)
    v_mfma_f32_32x32x16_bf16 v[64:79], v[32:35], v[160:163], v[64:79]
    ds_read_b64_tr_b16 v[24:25], v4 offset:40960
    ds_read_b64_tr_b16 v[26:27], v4 offset:41472
    v_mfma_f32_32x32x16_bf16 v[64:79], v[36:39], v[164:167], v[64:79]
    ds_read_b64_tr_b16 v[28:29], v4 offset:45056
    ds_read_b64_tr_b16 v[30:31], v4 offset:45568
    s_waitcnt lgkmcnt(8)
    s_setprio 2
    v_mfma_f32_32x32x16_bf16 v[64:79], v[40:43], v[168:171], v[64:79]
    s_setprio 0
    ds_read_b32 v15, v0 offset:0
    ds_read_b64_tr_b16 v[32:33], v5 offset:32768
    ds_read_b64_tr_b16 v[34:35], v5 offset:33280
    v_mfma_f32_32x32x16_bf16 v[64:79], v[44:47], v[172:175], v[64:79]
    ds_read_b64_tr_b16 v[36:37], v5 offset:36864
    ds_read_b64_tr_b16 v[38:39], v5 offset:37376
    s_waitcnt lgkmcnt(9)
    v_mfma_f32_32x32x16_bf16 v[80:95], v[16:19], v[160:163], v[80:95]
    ds_read_b64_tr_b16 v[40:41], v5 offset:40960
    ds_read_b64_tr_b16 v[42:43], v5 offset:41472
    s_setprio 2
    v_mfma_f32_32x32x16_bf16 v[80:95], v[20:23], v[164:167], v[80:95]
    s_setprio 0
    s_setprio 2
    s_waitcnt lgkmcnt(6)
L_cg30:
    v_cmp_gt_u32 vcc, 480, v15
    s_cbranch_vccz L_cg30_ok
    s_add_u32 s3, s3, 1
    s_cmp_ge_u32 s3, 0x400000
    s_cbranch_scc1 L_cg30_ok
    ds_read_b32 v15, v0 offset:0
    s_waitcnt lgkmcnt(0)
    s_branch L_cg30
L_cg30_ok:
    s_setprio 0
    ds_read_b64_tr_b16 v[44:45], v5 offset:45056
    ds_read_b64_tr_b16 v[46:47], v5 offset:45568
    s_add_u32 m0, s45, 16384
    s_add_u32 s43, s64, s47
    buffer_load_dwordx4 v9, s[12:15], s43 offen offset:0 lds
    v_mfma_f32_32x32x16_bf16 v[80:95], v[24:27], v[168:171], v[80:95]
    ds_read_b64_tr_b16 v[16:17], v2 offset:49152
    ds_read_b64_tr_b16 v[18:19], v2 offset:49664
    buffer_load_dwordx4 v10, s[12:15], s43 offen offset:1024 lds
    v_mfma_f32_32x32x16_bf16 v[80:95], v[28:31], v[172:175], v[80:95]
    ds_read_b64_tr_b16 v[20:21], v2 offset:53248
    ds_read_b64_tr_b16 v[22:23], v2 offset:53760
    buffer_load_dwordx4 v7, s[16:19], s43 offen offset:2048 lds
    s_waitcnt lgkmcnt(8)
    s_setprio 2
    v_mfma_f32_32x32x16_bf16 v[96:111], v[32:35], v[160:163], v[96:111]
    s_setprio 0
    ds_read_b64_tr_b16 v[24:25], v2 offset:57344
    ds_read_b64_tr_b16 v[26:27], v2 offset:57856
    buffer_load_dwordx4 v8, s[16:19], s43 offen offset:3072 lds
    v_mfma_f32_32x32x16_bf16 v[96:111], v[36:39], v[164:167], v[96:111]
    ds_read_b64_tr_b16 v[28:29], v2 offset:61440
    ds_read_b64_tr_b16 v[30:31], v2 offset:61952
    s_waitcnt lgkmcnt(8)
    v_mfma_f32_32x32x16_bf16 v[96:111], v[40:43], v[168:171], v[96:111]
    ds_read_b64_tr_b16 v[32:33], v3 offset:49152
    ds_read_b64_tr_b16 v[34:35], v3 offset:49664
    s_setprio 2
    v_mfma_f32_32x32x16_bf16 v[96:111], v[44:47], v[172:175], v[96:111]
    s_setprio 0
    ds_read_b64_tr_b16 v[36:37], v3 offset:53248
    ds_read_b64_tr_b16 v[38:39], v3 offset:53760
    s_waitcnt vmcnt(20)
    s_mov_b64 exec, 1
    ds_add_u32 v0, v0 offset:0
    s_mov_b64 exec, -1
    s_waitcnt lgkmcnt(9)
    v_mfma_f32_32x32x16_bf16 v[48:63], v[16:19], v[176:179], v[48:63]
    ds_read_b64_tr_b16 v[40:41], v3 offset:57344
    ds_read_b64_tr_b16 v[42:43], v3 offset:57856
    v_mfma_f32_32x32x16_bf16 v[48:63], v[20:23], v[180:183], v[48:63]
    ds_read_b64_tr_b16 v[44:45], v3 offset:61440
    ds_read_b64_tr_b16 v[46:47], v3 offset:61952
    s_waitcnt lgkmcnt(9)
    s_setprio 2
    v_mfma_f32_32x32x16_bf16 v[48:63], v[24:27], v[184:187], v[48:63]
    s_setprio 0
    ds_read_b64_tr_b16 v[16:17], v4 offset:49152
    ds_read_b64_tr_b16 v[18:19], v4 offset:49664
    v_mfma_f32_32x32x16_bf16 v[48:63], v[28:31], v[188:191], v[48:63]
    ds_read_b64_tr_b16 v[20:21], v4 offset:53248
    ds_read_b64_tr_b16 v[22:23], v4 offset:53760
    s_waitcnt lgkmcnt(9)
    v_mfma_f32_32x32x16_bf16 v[64:79], v[32:35], v[176:179], v[64:79]
    ds_read_b64_tr_b16 v[24:25], v4 offset:57344
    ds_read_b64_tr_b16 v[26:27], v4 offset:57856
    s_setprio 2
    v_mfma_f32_32x32x16_bf16 v[64:79], v[36:39], v[180:183], v[64:79]
    s_setprio 0
    ds_read_b64_tr_b16 v[28:29], v4 offset:61440
    ds_read_b64_tr_b16 v[30:31], v4 offset:61952
    s_waitcnt lgkmcnt(8)
    v_mfma_f32_32x32x16_bf16 v[64:79], v[40:43], v[184:187], v[64:79]
    ds_read_b32 v15, v0 offset:0
    ds_read_b64_tr_b16 v[32:33], v5 offset:49152
    ds_read_b64_tr_b16 v[34:35], v5 offset:49664
    v_mfma_f32_32x32x16_bf16 v[64:79], v[44:47], v[188:191], v[64:79]
    ds_read_b64_tr_b16 v[36:37], v5 offset:53248
    ds_read_b64_tr_b16 v[38:39], v5 offset:53760
    s_waitcnt lgkmcnt(9)
    s_setprio 2
    v_mfma_f32_32x32x16_bf16 v[80:95], v[16:19], v[176:179], v[80:95]
    s_setprio 0
    ds_read_b64_tr_b16 v[40:41], v5 offset:57344
    ds_read_b64_tr_b16 v[42:43], v5 offset:57856
    v_mfma_f32_32x32x16_bf16 v[80:95], v[20:23], v[180:183], v[80:95]
    s_setprio 2
    s_waitcnt lgkmcnt(6)
L_cg31:
    v_cmp_gt_u32 vcc, 496, v15
    s_cbranch_vccz L_cg31_ok
    s_add_u32 s3, s3, 1
    s_cmp_ge_u32 s3, 0x400000
    s_cbranch_scc1 L_cg31_ok
    ds_read_b32 v15, v0 offset:0
    s_waitcnt lgkmcnt(0)
    s_branch L_cg31
L_cg31_ok:
    s_setprio 0
    ds_read_b64_tr_b16 v[44:45], v5 offset:61440
    ds_read_b64_tr_b16 v[46:47], v5 offset:61952
    s_add_u32 m0, s45, 32768
    s_add_u32 s43, s65, s47
    buffer_load_dwordx4 v9, s[12:15], s43 offen offset:0 lds
    v_mfma_f32_32x32x16_bf16 v[80:95], v[24:27], v[184:187], v[80:95]
    s_setprio 2
    v_add_u32 v2, 65536, v2
    v_add_u32 v3, 65536, v3
    v_add_u32 v4, 65536, v4
    v_add_u32 v5, 65536, v5
    s_setprio 0
    ds_read_b64_tr_b16 v[16:17], v2 offset:0
    ds_read_b64_tr_b16 v[18:19], v2 offset:512
    buffer_load_dwordx4 v10, s[12:15], s43 offen offset:1024 lds
    s_setprio 2
    v_mfma_f32_32x32x16_bf16 v[80:95], v[28:31], v[188:191], v[80:95]
    s_setprio 0
    ds_read_b64_tr_b16 v[20:21], v2 offset:4096
    ds_read_b64_tr_b16 v[22:23], v2 offset:4608
    buffer_load_dwordx4 v7, s[16:19], s43 offen offset:2048 lds
    s_waitcnt lgkmcnt(8)
    v_mfma_f32_32x32x16_bf16 v[96:111], v[32:35], v[176:179], v[96:111]
    ds_read_b64_tr_b16 v[24:25], v2 offset:8192
    ds_read_b64_tr_b16 v[26:27], v2 offset:8704
    buffer_load_dwordx4 v8, s[16:19], s43 offen offset:3072 lds
    v_mfma_f32_32x32x16_bf16 v[96:111], v[36:39], v[180:183], v[96:111]
    ds_read_b64_tr_b16 v[28:29], v2 offset:12288
    ds_read_b64_tr_b16 v[30:31], v2 offset:12800
    s_waitcnt lgkmcnt(8)
    s_setprio 2
    v_mfma_f32_32x32x16_bf16 v[96:111], v[40:43], v[184:187], v[96:111]
    s_setprio 0
    ds_read_b64_tr_b16 v[32:33], v3 offset:0
    ds_read_b64_tr_b16 v[34:35], v3 offset:512
    v_mfma_f32_32x32x16_bf16 v[96:111], v[44:47], v[188:191], v[96:111]
    ds_read_b64_tr_b16 v[36:37], v3 offset:4096
    ds_read_b64_tr_b16 v[38:39], v3 offset:4608
    s_waitcnt vmcnt(16)
    s_mov_b64 exec, 1
    ds_add_u32 v0, v0 offset:0
    s_mov_b64 exec, -1
    s_waitcnt lgkmcnt(9)
    v_mfma_f32_32x32x16_bf16 v[48:63], v[16:19], v[192:195], v[48:63]
    ds_read_b64_tr_b16 v[40:41], v3 offset:8192
    ds_read_b64_tr_b16 v[42:43], v3 offset:8704
    s_setprio 2
    v_mfma_f32_32x32x16_bf16 v[48:63], v[20:23], v[196:199], v[48:63]
    s_setprio 0
    ds_read_b64_tr_b16 v[44:45], v3 offset:12288
    ds_read_b64_tr_b16 v[46:47], v3 offset:12800
    s_waitcnt lgkmcnt(9)
    v_mfma_f32_32x32x16_bf16 v[48:63], v[24:27], v[200:203], v[48:63]
    ds_read_b64_tr_b16 v[16:17], v4 offset:0
    ds_read_b64_tr_b16 v[18:19], v4 offset:512
    v_mfma_f32_32x32x16_bf16 v[48:63], v[28:31], v[204:207], v[48:63]
    ds_read_b64_tr_b16 v[20:21], v4 offset:4096
    ds_read_b64_tr_b16 v[22:23], v4 offset:4608
    s_waitcnt lgkmcnt(9)
    s_setprio 2
    v_mfma_f32_32x32x16_bf16 v[64:79], v[32:35], v[192:195], v[64:79]
    s_setprio 0
    ds_read_b64_tr_b16 v[24:25], v4 offset:8192
    ds_read_b64_tr_b16 v[26:27], v4 offset:8704
    v_mfma_f32_32x32x16_bf16 v[64:79], v[36:39], v[196:199], v[64:79]
    ds_read_b64_tr_b16 v[28:29], v4 offset:12288
    ds_read_b64_tr_b16 v[30:31], v4 offset:12800
    s_waitcnt lgkmcnt(8)
    v_mfma_f32_32x32x16_bf16 v[64:79], v[40:43], v[200:203], v[64:79]
    ds_read_b32 v15, v0 offset:0
    ds_read_b64_tr_b16 v[32:33], v5 offset:0
    ds_read_b64_tr_b16 v[34:35], v5 offset:512
    s_setprio 2
    v_mfma_f32_32x32x16_bf16 v[64:79], v[44:47], v[204:207], v[64:79]
    s_setprio 0
    ds_read_b64_tr_b16 v[36:37], v5 offset:4096
    ds_read_b64_tr_b16 v[38:39], v5 offset:4608
    s_waitcnt lgkmcnt(9)
    v_mfma_f32_32x32x16_bf16 v[80:95], v[16:19], v[192:195], v[80:95]
    ds_read_b64_tr_b16 v[40:41], v5 offset:8192
    ds_read_b64_tr_b16 v[42:43], v5 offset:8704
    v_mfma_f32_32x32x16_bf16 v[80:95], v[20:23], v[196:199], v[80:95]
    s_setprio 2
    s_waitcnt lgkmcnt(6)
L_cg32:
    v_cmp_gt_u32 vcc, 512, v15
    s_cbranch_vccz L_cg32_ok
    s_add_u32 s3, s3, 1
    s_cmp_ge_u32 s3, 0x400000
    s_cbranch_scc1 L_cg32_ok
    ds_read_b32 v15, v0 offset:0
    s_waitcnt lgkmcnt(0)
    s_branch L_cg32
L_cg32_ok:
    s_setprio 0
    ds_read_b64_tr_b16 v[44:45], v5 offset:12288
    ds_read_b64_tr_b16 v[46:47], v5 offset:12800
    s_add_u32 m0, s45, 49152
    s_add_u32 s43, s66, s47
    buffer_load_dwordx4 v9, s[12:15], s43 offen offset:0 lds
    s_setprio 2
    v_mfma_f32_32x32x16_bf16 v[80:95], v[24:27], v[200:203], v[80:95]
    s_setprio 0
    ds_read_b64_tr_b16 v[16:17], v2 offset:16384
    ds_read_b64_tr_b16 v[18:19], v2 offset:16896
    buffer_load_dwordx4 v10, s[12:15], s43 offen offset:1024 lds
    v_mfma_f32_32x32x16_bf16 v[80:95], v[28:31], v[204:207], v[80:95]
    ds_read_b64_tr_b16 v[20:21], v2 offset:20480
    ds_read_b64_tr_b16 v[22:23], v2 offset:20992
    buffer_load_dwordx4 v7, s[16:19], s43 offen offset:2048 lds
    s_waitcnt lgkmcnt(8)
    v_mfma_f32_32x32x16_bf16 v[96:111], v[32:35], v[192:195], v[96:111]
    ds_read_b64_tr_b16 v[24:25], v2 offset:24576
    ds_read_b64_tr_b16 v[26:27], v2 offset:25088
    buffer_load_dwordx4 v8, s[16:19], s43 offen offset:3072 lds
    s_setprio 2
    v_mfma_f32_32x32x16_bf16 v[96:111], v[36:39], v[196:199], v[96:111]
    s_setprio 0
    ds_read_b64_tr_b16 v[28:29], v2 offset:28672
    ds_read_b64_tr_b16 v[30:31], v2 offset:29184
    s_waitcnt lgkmcnt(8)
    v_mfma_f32_32x32x16_bf16 v[96:111], v[40:43], v[200:203], v[96:111]
    ds_read_b64_tr_b16 v[32:33], v3 offset:16384
    ds_read_b64_tr_b16 v[34:35], v3 offset:16896
    v_mfma_f32_32x32x16_bf16 v[96:111], v[44:47], v[204:207], v[96:111]
    ds_read_b64_tr_b16 v[36:37], v3 offset:20480
    ds_read_b64_tr_b16 v[38:39], v3 offset:20992
    s_waitcnt vmcnt(16)
    s_mov_b64 exec, 1
    ds_add_u32 v0, v0 offset:0
    s_mov_b64 exec, -1
    s_waitcnt lgkmcnt(9)
    s_setprio 2
    v_mfma_f32_32x32x16_bf16 v[48:63], v[16:19], v[208:211], v[48:63]
    s_setprio 0
    ds_read_b64_tr_b16 v[40:41], v3 offset:24576
    ds_read_b64_tr_b16 v[42:43], v3 offset:25088
    v_mfma_f32_32x32x16_bf16 v[48:63], v[20:23], v[212:215], v[48:63]
    ds_read_b64_tr_b16 v[44:45], v3 offset:28672
    ds_read_b64_tr_b16 v[46:47], v3 offset:29184
    s_waitcnt lgkmcnt(9)
    v_mfma_f32_32x32x16_bf16 v[48:63], v[24:27], v[216:219], v[48:63]
    ds_read_b64_tr_b16 v[16:17], v4 offset:16384
    ds_read_b64_tr_b16 v[18:19], v4 offset:16896
    s_setprio 2
    v_mfma_f32_32x32x16_bf16 v[48:63], v[28:31], v[220:223], v[48:63]
    s_setprio 0
    ds_read_b64_tr_b16 v[20:21], v4 offset:20480
    ds_read_b64_tr_b16 v[22:23], v4 offset:20992
    s_waitcnt lgkmcnt(9)
    v_mfma_f32_32x32x16_bf16 v[64:79], v[32:35], v[208:211], v[64:79]
    ds_read_b64_tr_b16 v[24:25], v4 offset:24576
    ds_read_b64_tr_b16 v[26:27], v4 offset:25088
    v_mfma_f32_32x32x16_bf16 v[64:79], v[36:39], v[212:215], v[64:79]
    ds_read_b64_tr_b16 v[28:29], v4 offset:28672
    ds_read_b64_tr_b16 v[30:31], v4 offset:29184
    s_waitcnt lgkmcnt(8)
    s_setprio 2
    v_mfma_f32_32x32x16_bf16 v[64:79], v[40:43], v[216:219], v[64:79]
    s_setprio 0
    ds_read_b32 v15, v0 offset:0
    ds_read_b64_tr_b16 v[32:33], v5 offset:16384
    ds_read_b64_tr_b16 v[34:35], v5 offset:16896
    v_mfma_f32_32x32x16_bf16 v[64:79], v[44:47], v[220:223], v[64:79]
    ds_read_b64_tr_b16 v[36:37], v5 offset:20480
    ds_read_b64_tr_b16 v[38:39], v5 offset:20992
    s_waitcnt lgkmcnt(9)
    v_mfma_f32_32x32x16_bf16 v[80:95], v[16:19], v[208:211], v[80:95]
    ds_read_b64_tr_b16 v[40:41], v5 offset:24576
    ds_read_b64_tr_b16 v[42:43], v5 offset:25088
    s_setprio 2
    v_mfma_f32_32x32x16_bf16 v[80:95], v[20:23], v[212:215], v[80:95]
    s_setprio 0
    s_setprio 2
    s_waitcnt lgkmcnt(6)
L_cg33:
    v_cmp_gt_u32 vcc, 528, v15
    s_cbranch_vccz L_cg33_ok
    s_add_u32 s3, s3, 1
    s_cmp_ge_u32 s3, 0x400000
    s_cbranch_scc1 L_cg33_ok
    ds_read_b32 v15, v0 offset:0
    s_waitcnt lgkmcnt(0)
    s_branch L_cg33
L_cg33_ok:
    s_setprio 0
    ds_read_b64_tr_b16 v[44:45], v5 offset:28672
    ds_read_b64_tr_b16 v[46:47], v5 offset:29184
    s_add_u32 m0, s45, 65536
    s_add_u32 s43, s67, s47
    buffer_load_dwordx4 v9, s[12:15], s43 offen offset:0 lds
    v_mfma_f32_32x32x16_bf16 v[80:95], v[24:27], v[216:219], v[80:95]
    ds_read_b64_tr_b16 v[16:17], v2 offset:32768
    ds_read_b64_tr_b16 v[18:19], v2 offset:33280
    buffer_load_dwordx4 v10, s[12:15], s43 offen offset:1024 lds
    v_mfma_f32_32x32x16_bf16 v[80:95], v[28:31], v[220:223], v[80:95]
    ds_read_b64_tr_b16 v[20:21], v2 offset:36864
    ds_read_b64_tr_b16 v[22:23], v2 offset:37376
    buffer_load_dwordx4 v7, s[16:19], s43 offen offset:2048 lds
    s_waitcnt lgkmcnt(8)
    s_setprio 2
    v_mfma_f32_32x32x16_bf16 v[96:111], v[32:35], v[208:211], v[96:111]
    s_setprio 0
    ds_read_b64_tr_b16 v[24:25], v2 offset:40960
    ds_read_b64_tr_b16 v[26:27], v2 offset:41472
    buffer_load_dwordx4 v8, s[16:19], s43 offen offset:3072 lds
    v_mfma_f32_32x32x16_bf16 v[96:111], v[36:39], v[212:215], v[96:111]
    ds_read_b64_tr_b16 v[28:29], v2 offset:45056
    ds_read_b64_tr_b16 v[30:31], v2 offset:45568
    s_waitcnt lgkmcnt(8)
    v_mfma_f32_32x32x16_bf16 v[96:111], v[40:43], v[216:219], v[96:111]
    ds_read_b64_tr_b16 v[32:33], v3 offset:32768
    ds_read_b64_tr_b16 v[34:35], v3 offset:33280
    s_setprio 2
    v_mfma_f32_32x32x16_bf16 v[96:111], v[44:47], v[220:223], v[96:111]
    s_setprio 0
    ds_read_b64_tr_b16 v[36:37], v3 offset:36864
    ds_read_b64_tr_b16 v[38:39], v3 offset:37376
    s_waitcnt vmcnt(16)
    s_mov_b64 exec, 1
    ds_add_u32 v0, v0 offset:0
    s_mov_b64 exec, -1
    s_waitcnt lgkmcnt(9)
    v_mfma_f32_32x32x16_bf16 v[48:63], v[16:19], v[224:227], v[48:63]
    ds_read_b64_tr_b16 v[40:41], v3 offset:40960
    ds_read_b64_tr_b16 v[42:43], v3 offset:41472
    v_mfma_f32_32x32x16_bf16 v[48:63], v[20:23], v[228:231], v[48:63]
    ds_read_b64_tr_b16 v[44:45], v3 offset:45056
    ds_read_b64_tr_b16 v[46:47], v3 offset:45568
    s_waitcnt lgkmcnt(9)
    s_setprio 2
    v_mfma_f32_32x32x16_bf16 v[48:63], v[24:27], v[232:235], v[48:63]
    s_setprio 0
    ds_read_b64_tr_b16 v[16:17], v4 offset:32768
    ds_read_b64_tr_b16 v[18:19], v4 offset:33280
    v_mfma_f32_32x32x16_bf16 v[48:63], v[28:31], v[236:239], v[48:63]
    ds_read_b64_tr_b16 v[20:21], v4 offset:36864
    ds_read_b64_tr_b16 v[22:23], v4 offset:37376
    s_waitcnt lgkmcnt(9)
    v_mfma_f32_32x32x16_bf16 v[64:79], v[32:35], v[224:227], v[64:79]
    ds_read_b64_tr_b16 v[24:25], v4 offset:40960
    ds_read_b64_tr_b16 v[26:27], v4 offset:41472
    s_setprio 2
    v_mfma_f32_32x32x16_bf16 v[64:79], v[36:39], v[228:231], v[64:79]
    s_setprio 0
    ds_read_b64_tr_b16 v[28:29], v4 offset:45056
    ds_read_b64_tr_b16 v[30:31], v4 offset:45568
    s_waitcnt lgkmcnt(8)
    v_mfma_f32_32x32x16_bf16 v[64:79], v[40:43], v[232:235], v[64:79]
    ds_read_b32 v15, v0 offset:0
    ds_read_b64_tr_b16 v[32:33], v5 offset:32768
    ds_read_b64_tr_b16 v[34:35], v5 offset:33280
    v_mfma_f32_32x32x16_bf16 v[64:79], v[44:47], v[236:239], v[64:79]
    ds_read_b64_tr_b16 v[36:37], v5 offset:36864
    ds_read_b64_tr_b16 v[38:39], v5 offset:37376
    s_waitcnt lgkmcnt(9)
    s_setprio 2
    v_mfma_f32_32x32x16_bf16 v[80:95], v[16:19], v[224:227], v[80:95]
    s_setprio 0
    ds_read_b64_tr_b16 v[40:41], v5 offset:40960
    ds_read_b64_tr_b16 v[42:43], v5 offset:41472
    v_mfma_f32_32x32x16_bf16 v[80:95], v[20:23], v[228:231], v[80:95]
    s_setprio 2
    s_waitcnt lgkmcnt(6)
L_cg34:
    v_cmp_gt_u32 vcc, 544, v15
    s_cbranch_vccz L_cg34_ok
    s_add_u32 s3, s3, 1
    s_cmp_ge_u32 s3, 0x400000
    s_cbranch_scc1 L_cg34_ok
    ds_read_b32 v15, v0 offset:0
    s_waitcnt lgkmcnt(0)
    s_branch L_cg34
L_cg34_ok:
    s_setprio 0
    ds_read_b64_tr_b16 v[44:45], v5 offset:45056
    ds_read_b64_tr_b16 v[46:47], v5 offset:45568
    s_add_u32 m0, s45, 81920
    s_add_u32 s43, s68, s47
    buffer_load_dwordx4 v9, s[12:15], s43 offen offset:0 lds
    v_mfma_f32_32x32x16_bf16 v[80:95], v[24:27], v[232:235], v[80:95]
    s_setprio 2
    v_subrev_u32 v2, 65536, v2
    v_subrev_u32 v3, 65536, v3
    v_subrev_u32 v4, 65536, v4
    v_subrev_u32 v5, 65536, v5
    s_setprio 0
    ds_read_b64_tr_b16 v[16:17], v2 offset:0
    ds_read_b64_tr_b16 v[18:19], v2 offset:512
    buffer_load_dwordx4 v10, s[12:15], s43 offen offset:1024 lds
    s_setprio 2
    v_mfma_f32_32x32x16_bf16 v[80:95], v[28:31], v[236:239], v[80:95]
    s_setprio 0
    ds_read_b64_tr_b16 v[20:21], v2 offset:4096
    ds_read_b64_tr_b16 v[22:23], v2 offset:4608
    buffer_load_dwordx4 v7, s[16:19], s43 offen offset:2048 lds
    s_waitcnt lgkmcnt(8)
    v_mfma_f32_32x32x16_bf16 v[96:111], v[32:35], v[224:227], v[96:111]
    ds_read_b64_tr_b16 v[24:25], v2 offset:8192
    ds_read_b64_tr_b16 v[26:27], v2 offset:8704
    buffer_load_dwordx4 v8, s[16:19], s43 offen offset:3072 lds
    v_mfma_f32_32x32x16_bf16 v[96:111], v[36:39], v[228:231], v[96:111]
    ds_read_b64_tr_b16 v[28:29], v2 offset:12288
    ds_read_b64_tr_b16 v[30:31], v2 offset:12800
    s_waitcnt lgkmcnt(8)
    s_setprio 2
    v_mfma_f32_32x32x16_bf16 v[96:111], v[40:43], v[232:235], v[96:111]
    s_setprio 0
    ds_read_b64_tr_b16 v[32:33], v3 offset:0
    ds_read_b64_tr_b16 v[34:35], v3 offset:512
    v_mfma_f32_32x32x16_bf16 v[96:111], v[44:47], v[236:239], v[96:111]
    ds_read_b64_tr_b16 v[36:37], v3 offset:4096
    ds_read_b64_tr_b16 v[38:39], v3 offset:4608
    s_waitcnt vmcnt(16)
    s_mov_b64 exec, 1
    ds_add_u32 v0, v0 offset:0
    s_mov_b64 exec, -1
    s_waitcnt lgkmcnt(9)
    v_mfma_f32_32x32x16_bf16 v[48:63], v[16:19], v[240:243], v[48:63]
    ds_read_b64_tr_b16 v[40:41], v3 offset:8192
    ds_read_b64_tr_b16 v[42:43], v3 offset:8704
    s_setprio 2
    v_mfma_f32_32x32x16_bf16 v[48:63], v[20:23], v[244:247], v[48:63]
    s_setprio 0
    ds_read_b64_tr_b16 v[44:45], v3 offset:12288
    ds_read_b64_tr_b16 v[46:47], v3 offset:12800
    s_waitcnt lgkmcnt(9)
    v_mfma_f32_32x32x16_bf16 v[48:63], v[24:27], v[248:251], v[48:63]
    ds_read_b64_tr_b16 v[16:17], v4 offset:0
    ds_read_b64_tr_b16 v[18:19], v4 offset:512
    v_mfma_f32_32x32x16_bf16 v[48:63], v[28:31], v[252:255], v[48:63]
    ds_read_b64_tr_b16 v[20:21], v4 offset:4096
    ds_read_b64_tr_b16 v[22:23], v4 offset:4608
    s_waitcnt lgkmcnt(9)
    s_setprio 2
    v_mfma_f32_32x32x16_bf16 v[64:79], v[32:35], v[240:243], v[64:79]
    ds_read_b64_tr_b16 v[24:25], v4 offset:8192
    ds_read_b64_tr_b16 v[26:27], v4 offset:8704
    s_nop 4
    v_max_f32 v48, 0, v48
    v_max_f32 v49, 0, v49
    v_mfma_f32_32x32x16_bf16 v[64:79], v[36:39], v[244:247], v[64:79]
    ds_read_b64_tr_b16 v[28:29], v4 offset:12288
    ds_read_b64_tr_b16 v[30:31], v4 offset:12800
    v_max_f32 v50, 0, v50
    v_max_f32 v51, 0, v51
    s_waitcnt lgkmcnt(8)
    v_mfma_f32_32x32x16_bf16 v[64:79], v[40:43], v[248:251], v[64:79]
    ds_read_b32 v15, v0 offset:0
    ds_read_b64_tr_b16 v[32:33], v5 offset:0
    ds_read_b64_tr_b16 v[34:35], v5 offset:512
    v_max_f32 v52, 0, v52
    v_max_f32 v53, 0, v53
    v_mfma_f32_32x32x16_bf16 v[64:79], v[44:47], v[252:255], v[64:79]
    ds_read_b64_tr_b16 v[36:37], v5 offset:4096
    ds_read_b64_tr_b16 v[38:39], v5 offset:4608
    v_max_f32 v54, 0, v54
    v_max_f32 v55, 0, v55
    s_waitcnt lgkmcnt(9)
    v_mfma_f32_32x32x16_bf16 v[80:95], v[16:19], v[240:243], v[80:95]
    ds_read_b64_tr_b16 v[40:41], v5 offset:8192
    ds_read_b64_tr_b16 v[42:43], v5 offset:8704
    v_mul_f32 v48, v48, v56
    v_mul_f32 v49, v49, v57
    v_mfma_f32_32x32x16_bf16 v[80:95], v[20:23], v[244:247], v[80:95]
    s_waitcnt lgkmcnt(6)
L_cg35:
    v_cmp_gt_u32 vcc, 560, v15
    s_cbranch_vccz L_cg35_ok
    s_add_u32 s3, s3, 1
    s_cmp_ge_u32 s3, 0x400000
    s_cbranch_scc1 L_cg35_ok
    ds_read_b32 v15, v0 offset:0
    s_waitcnt lgkmcnt(0)
    s_branch L_cg35
L_cg35_ok:
    ds_read_b64_tr_b16 v[44:45], v5 offset:12288
    ds_read_b64_tr_b16 v[46:47], v5 offset:12800
    s_add_u32 m0, s45, 98304
    s_add_u32 s43, s69, s47
    buffer_load_dwordx4 v9, s[12:15], s43 offen offset:0 lds
    v_mul_f32 v50, v50, v58
    v_mul_f32 v51, v51, v59
    v_mfma_f32_32x32x16_bf16 v[80:95], v[24:27], v[248:251], v[80:95]
    ds_read_b64_tr_b16 v[16:17], v2 offset:16384
    ds_read_b64_tr_b16 v[18:19], v2 offset:16896
    buffer_load_dwordx4 v10, s[12:15], s43 offen offset:1024 lds
    v_mul_f32 v52, v52, v60
    v_mul_f32 v53, v53, v61
    v_mfma_f32_32x32x16_bf16 v[80:95], v[28:31], v[252:255], v[80:95]
    ds_read_b64_tr_b16 v[20:21], v2 offset:20480
    ds_read_b64_tr_b16 v[22:23], v2 offset:20992
    buffer_load_dwordx4 v7, s[16:19], s43 offen offset:2048 lds
    v_mul_f32 v54, v54, v62
    v_mul_f32 v55, v55, v63
    s_waitcnt lgkmcnt(8)
    v_mfma_f32_32x32x16_bf16 v[96:111], v[32:35], v[240:243], v[96:111]
    ds_read_b64_tr_b16 v[24:25], v2 offset:24576
    ds_read_b64_tr_b16 v[26:27], v2 offset:25088
    buffer_load_dwordx4 v8, s[16:19], s43 offen offset:3072 lds
    v_cvt_pk_bf16_f32 v56, v48, v49
    v_cvt_pk_bf16_f32 v57, v50, v51
    v_mfma_f32_32x32x16_bf16 v[96:111], v[36:39], v[244:247], v[96:111]
    ds_read_b64_tr_b16 v[28:29], v2 offset:28672
    ds_read_b64_tr_b16 v[30:31], v2 offset:29184
    v_cvt_pk_bf16_f32 v58, v52, v53
    v_cvt_pk_bf16_f32 v59, v54, v55
    s_waitcnt lgkmcnt(8)
    v_mfma_f32_32x32x16_bf16 v[96:111], v[40:43], v[248:251], v[96:111]
    ds_read_b64_tr_b16 v[32:33], v3 offset:16384
    ds_read_b64_tr_b16 v[34:35], v3 offset:16896
    s_add_u32 s52, s50, 10240
    buffer_store_dwordx4 v[56:59], v11, s[24:27], s52 offen sc1
    v_mfma_f32_32x32x16_bf16 v[96:111], v[44:47], v[252:255], v[96:111]
    ds_read_b64_tr_b16 v[36:37], v3 offset:20480
    ds_read_b64_tr_b16 v[38:39], v3 offset:20992
    v_max_f32 v64, 0, v64
    v_max_f32 v65, 0, v65
    s_waitcnt vmcnt(17)
    s_mov_b64 exec, 1
    ds_add_u32 v0, v0 offset:0
    s_mov_b64 exec, -1
    s_waitcnt lgkmcnt(9)
    v_mfma_f32_32x32x16_bf16 v[48:63], v[16:19], v[112:115], 0
    ds_read_b64_tr_b16 v[40:41], v3 offset:24576
    ds_read_b64_tr_b16 v[42:43], v3 offset:25088
    v_max_f32 v66, 0, v66
    v_max_f32 v67, 0, v67
    v_mfma_f32_32x32x16_bf16 v[48:63], v[20:23], v[116:119], v[48:63]
    ds_read_b64_tr_b16 v[44:45], v3 offset:28672
    ds_read_b64_tr_b16 v[46:47], v3 offset:29184
    v_max_f32 v68, 0, v68
    v_max_f32 v69, 0, v69
    s_waitcnt lgkmcnt(9)
    v_mfma_f32_32x32x16_bf16 v[48:63], v[24:27], v[120:123], v[48:63]
    ds_read_b64_tr_b16 v[16:17], v4 offset:16384
    ds_read_b64_tr_b16 v[18:19], v4 offset:16896
    v_max_f32 v70, 0, v70
    v_max_f32 v71, 0, v71
    v_mfma_f32_32x32x16_bf16 v[48:63], v[28:31], v[124:127], v[48:63]
    ds_read_b64_tr_b16 v[20:21], v4 offset:20480
    ds_read_b64_tr_b16 v[22:23], v4 offset:20992
    v_mul_f32 v64, v64, v72
    v_mul_f32 v65, v65, v73
    v_mul_f32 v66, v66, v74
    v_mul_f32 v67, v67, v75
    v_mul_f32 v68, v68, v76
    v_mul_f32 v69, v69, v77
    v_mul_f32 v70, v70, v78
    v_mul_f32 v71, v71, v79
    v_cvt_pk_bf16_f32 v72, v64, v65
    v_cvt_pk_bf16_f32 v73, v66, v67
    v_cvt_pk_bf16_f32 v74, v68, v69
    v_cvt_pk_bf16_f32 v75, v70, v71
    s_add_u32 s52, s50, 11264
    buffer_store_dwordx4 v[72:75], v11, s[24:27], s52 offen sc1
    s_waitcnt lgkmcnt(9)
    s_nop 0
    v_mfma_f32_32x32x16_bf16 v[64:79], v[32:35], v[112:115], 0
    ds_read_b64_tr_b16 v[24:25], v4 offset:24576
    ds_read_b64_tr_b16 v[26:27], v4 offset:25088
    v_max_f32 v80, 0, v80
    v_max_f32 v81, 0, v81
    v_mfma_f32_32x32x16_bf16 v[64:79], v[36:39], v[116:119], v[64:79]
    ds_read_b64_tr_b16 v[28:29], v4 offset:28672
    ds_read_b64_tr_b16 v[30:31], v4 offset:29184
    v_max_f32 v82, 0, v82
    v_max_f32 v83, 0, v83
    s_waitcnt lgkmcnt(8)
    v_mfma_f32_32x32x16_bf16 v[64:79], v[40:43], v[120:123], v[64:79]
    ds_read_b32 v15, v0 offset:0
    ds_read_b64_tr_b16 v[32:33], v5 offset:16384
    ds_read_b64_tr_b16 v[34:35], v5 offset:16896
    v_max_f32 v84, 0, v84
    v_max_f32 v85, 0, v85
    v_mfma_f32_32x32x16_bf16 v[64:79], v[44:47], v[124:127], v[64:79]
    ds_read_b64_tr_b16 v[36:37], v5 offset:20480
    ds_read_b64_tr_b16 v[38:39], v5 offset:20992
    v_max_f32 v86, 0, v86
    v_max_f32 v87, 0, v87
    v_mul_f32 v80, v80, v88
    v_mul_f32 v81, v81, v89
    v_mul_f32 v82, v82, v90
    v_mul_f32 v83, v83, v91
    v_mul_f32 v84, v84, v92
    v_mul_f32 v85, v85, v93
    v_mul_f32 v86, v86, v94
    v_mul_f32 v87, v87, v95
    v_cvt_pk_bf16_f32 v88, v80, v81
    v_cvt_pk_bf16_f32 v89, v82, v83
    v_cvt_pk_bf16_f32 v90, v84, v85
    v_cvt_pk_bf16_f32 v91, v86, v87
    s_add_u32 s52, s50, 12288
    buffer_store_dwordx4 v[88:91], v11, s[24:27], s52 offen sc1
    s_waitcnt lgkmcnt(9)
    s_nop 0
    v_mfma_f32_32x32x16_bf16 v[80:95], v[16:19], v[112:115], 0
    ds_read_b64_tr_b16 v[40:41], v5 offset:24576
    ds_read_b64_tr_b16 v[42:43], v5 offset:25088
    v_max_f32 v96, 0, v96
    v_max_f32 v97, 0, v97
    v_mfma_f32_32x32x16_bf16 v[80:95], v[20:23], v[116:119], v[80:95]
    s_waitcnt lgkmcnt(6)
L_cg36:
    v_cmp_gt_u32 vcc, 576, v15
    s_cbranch_vccz L_cg36_ok
    s_add_u32 s3, s3, 1
    s_cmp_ge_u32 s3, 0x400000
    s_cbranch_scc1 L_cg36_ok
    ds_read_b32 v15, v0 offset:0
    s_waitcnt lgkmcnt(0)
    s_branch L_cg36
L_cg36_ok:
    ds_read_b64_tr_b16 v[44:45], v5 offset:28672
    ds_read_b64_tr_b16 v[46:47], v5 offset:29184
    s_add_u32 m0, s45, 0
    s_add_u32 s43, s70, s47
    buffer_load_dwordx4 v9, s[12:15], s43 offen offset:0 lds
    v_max_f32 v98, 0, v98
    v_max_f32 v99, 0, v99
    v_mfma_f32_32x32x16_bf16 v[80:95], v[24:27], v[120:123], v[80:95]
    ds_read_b64_tr_b16 v[16:17], v2 offset:32768
    ds_read_b64_tr_b16 v[18:19], v2 offset:33280
    buffer_load_dwordx4 v10, s[12:15], s43 offen offset:1024 lds
    v_max_f32 v100, 0, v100
    v_max_f32 v101, 0, v101
    v_mfma_f32_32x32x16_bf16 v[80:95], v[28:31], v[124:127], v[80:95]
    ds_read_b64_tr_b16 v[20:21], v2 offset:36864
    ds_read_b64_tr_b16 v[22:23], v2 offset:37376
    buffer_load_dwordx4 v7, s[16:19], s43 offen offset:2048 lds
    v_max_f32 v102, 0, v102
    v_max_f32 v103, 0, v103
    v_mul_f32 v96, v96, v104
    v_mul_f32 v97, v97, v105
    v_mul_f32 v98, v98, v106
    v_mul_f32 v99, v99, v107
    v_mul_f32 v100, v100, v108
    v_mul_f32 v101, v101, v109
    v_mul_f32 v102, v102, v110
    v_mul_f32 v103, v103, v111
    v_cvt_pk_bf16_f32 v104, v96, v97
    v_cvt_pk_bf16_f32 v105, v98, v99
    v_cvt_pk_bf16_f32 v106, v100, v101
    v_cvt_pk_bf16_f32 v107, v102, v103
    s_add_u32 s52, s50, 13312
    buffer_store_dwordx4 v[104:107], v11, s[24:27], s52 offen sc1
    s_waitcnt lgkmcnt(8)
    s_nop 0
    v_mfma_f32_32x32x16_bf16 v[96:111], v[32:35], v[112:115], 0
    s_setprio 0
    ds_read_b64_tr_b16 v[24:25], v2 offset:40960
    ds_read_b64_tr_b16 v[26:27], v2 offset:41472
    buffer_load_dwordx4 v8, s[16:19], s43 offen offset:3072 lds
    v_mfma_f32_32x32x16_bf16 v[96:111], v[36:39], v[116:119], v[96:111]
    ds_read_b64_tr_b16 v[28:29], v2 offset:45056
    ds_read_b64_tr_b16 v[30:31], v2 offset:45568
    s_waitcnt lgkmcnt(8)
    v_mfma_f32_32x32x16_bf16 v[96:111], v[40:43], v[120:123], v[96:111]
    ds_read_b64_tr_b16 v[32:33], v3 offset:32768
    ds_read_b64_tr_b16 v[34:35], v3 offset:33280
    s_setprio 2
    v_mfma_f32_32x32x16_bf16 v[96:111], v[44:47], v[124:127], v[96:111]
    s_setprio 0
    ds_read_b64_tr_b16 v[36:37], v3 offset:36864
    ds_read_b64_tr_b16 v[38:39], v3 offset:37376
    s_waitcnt vmcnt(20)
    s_mov_b64 exec, 1
    ds_add_u32 v0, v0 offset:0
    s_mov_b64 exec, -1
    s_waitcnt lgkmcnt(9)
    v_mfma_f32_32x32x16_bf16 v[48:63], v[16:19], v[128:131], v[48:63]
    ds_read_b64_tr_b16 v[40:41], v3 offset:40960
    ds_read_b64_tr_b16 v[42:43], v3 offset:41472
    v_mfma_f32_32x32x16_bf16 v[48:63], v[20:23], v[132:135], v[48:63]
    ds_read_b64_tr_b16 v[44:45], v3 offset:45056
    ds_read_b64_tr_b16 v[46:47], v3 offset:45568
    s_waitcnt lgkmcnt(9)
    s_setprio 2
    v_mfma_f32_32x32x16_bf16 v[48:63], v[24:27], v[136:139], v[48:63]
    s_setprio 0
    ds_read_b64_tr_b16 v[16:17], v4 offset:32768
    ds_read_b64_tr_b16 v[18:19], v4 offset:33280
    v_mfma_f32_32x32x16_bf16 v[48:63], v[28:31], v[140:143], v[48:63]
    ds_read_b64_tr_b16 v[20:21], v4 offset:36864
    ds_read_b64_tr_b16 v[22:23], v4 offset:37376
    s_waitcnt lgkmcnt(9)
    v_mfma_f32_32x32x16_bf16 v[64:79], v[32:35], v[128:131], v[64:79]
    ds_read_b64_tr_b16 v[24:25], v4 offset:40960
    ds_read_b64_tr_b16 v[26:27], v4 offset:41472
    s_setprio 2
    v_mfma_f32_32x32x16_bf16 v[64:79], v[36:39], v[132:135], v[64:79]
    s_setprio 0
    ds_read_b64_tr_b16 v[28:29], v4 offset:45056
    ds_read_b64_tr_b16 v[30:31], v4 offset:45568
    s_waitcnt lgkmcnt(8)
    v_mfma_f32_32x32x16_bf16 v[64:79], v[40:43], v[136:139], v[64:79]
    ds_read_b32 v15, v0 offset:0
    ds_read_b64_tr_b16 v[32:33], v5 offset:32768
    ds_read_b64_tr_b16 v[34:35], v5 offset:33280
    v_mfma_f32_32x32x16_bf16 v[64:79], v[44:47], v[140:143], v[64:79]
    ds_read_b64_tr_b16 v[36:37], v5 offset:36864
    ds_read_b64_tr_b16 v[38:39], v5 offset:37376
    s_waitcnt lgkmcnt(9)
    s_setprio 2
    v_mfma_f32_32x32x16_bf16 v[80:95], v[16:19], v[128:131], v[80:95]
    s_setprio 0
    ds_read_b64_tr_b16 v[40:41], v5 offset:40960
    ds_read_b64_tr_b16 v[42:43], v5 offset:41472
    v_mfma_f32_32x32x16_bf16 v[80:95], v[20:23], v[132:135], v[80:95]
    s_setprio 2
    s_waitcnt lgkmcnt(6)
L_cg37:
    v_cmp_gt_u32 vcc, 592, v15
    s_cbranch_vccz L_cg37_ok
    s_add_u32 s3, s3, 1
    s_cmp_ge_u32 s3, 0x400000
    s_cbranch_scc1 L_cg37_ok
    ds_read_b32 v15, v0 offset:0
    s_waitcnt lgkmcnt(0)
    s_branch L_cg37
L_cg37_ok:
    s_setprio 0
    ds_read_b64_tr_b16 v[44:45], v5 offset:45056
    ds_read_b64_tr_b16 v[46:47], v5 offset:45568
    s_add_u32 m0, s45, 16384
    s_add_u32 s43, s71, s47
    buffer_load_dwordx4 v9, s[12:15], s43 offen offset:0 lds
    v_mfma_f32_32x32x16_bf16 v[80:95], v[24:27], v[136:139], v[80:95]
    ds_read_b64_tr_b16 v[16:17], v2 offset:49152
    ds_read_b64_tr_b16 v[18:19], v2 offset:49664
    buffer_load_dwordx4 v10, s[12:15], s43 offen offset:1024 lds
    s_setprio 2
    v_mfma_f32_32x32x16_bf16 v[80:95], v[28:31], v[140:143], v[80:95]
    s_setprio 0
    ds_read_b64_tr_b16 v[20:21], v2 offset:53248
    ds_read_b64_tr_b16 v[22:23], v2 offset:53760
    buffer_load_dwordx4 v7, s[16:19], s43 offen offset:2048 lds
    s_waitcnt lgkmcnt(8)
    v_mfma_f32_32x32x16_bf16 v[96:111], v[32:35], v[128:131], v[96:111]
    ds_read_b64_tr_b16 v[24:25], v2 offset:57344
    ds_read_b64_tr_b16 v[26:27], v2 offset:57856
    buffer_load_dwordx4 v8, s[16:19], s43 offen offset:3072 lds
    v_mfma_f32_32x32x16_bf16 v[96:111], v[36:39], v[132:135], v[96:111]
    ds_read_b64_tr_b16 v[28:29], v2 offset:61440
    ds_read_b64_tr_b16 v[30:31], v2 offset:61952
    s_waitcnt lgkmcnt(8)
    s_setprio 2
    v_mfma_f32_32x32x16_bf16 v[96:111], v[40:43], v[136:139], v[96:111]
    s_setprio 0
    ds_read_b64_tr_b16 v[32:33], v3 offset:49152
    ds_read_b64_tr_b16 v[34:35], v3 offset:49664
    v_mfma_f32_32x32x16_bf16 v[96:111], v[44:47], v[140:143], v[96:111]
    ds_read_b64_tr_b16 v[36:37], v3 offset:53248
    ds_read_b64_tr_b16 v[38:39], v3 offset:53760
    s_waitcnt vmcnt(20)
    s_mov_b64 exec, 1
    ds_add_u32 v0, v0 offset:0
    s_mov_b64 exec, -1
    s_waitcnt lgkmcnt(9)
    v_mfma_f32_32x32x16_bf16 v[48:63], v[16:19], v[144:147], v[48:63]
    ds_read_b64_tr_b16 v[40:41], v3 offset:57344
    ds_read_b64_tr_b16 v[42:43], v3 offset:57856
    s_setprio 2
    v_mfma_f32_32x32x16_bf16 v[48:63], v[20:23], v[148:151], v[48:63]
    s_setprio 0
    ds_read_b64_tr_b16 v[44:45], v3 offset:61440
    ds_read_b64_tr_b16 v[46:47], v3 offset:61952
    s_waitcnt lgkmcnt(9)
    v_mfma_f32_32x32x16_bf16 v[48:63], v[24:27], v[152:155], v[48:63]
    ds_read_b64_tr_b16 v[16:17], v4 offset:49152
    ds_read_b64_tr_b16 v[18:19], v4 offset:49664
    v_mfma_f32_32x32x16_bf16 v[48:63], v[28:31], v[156:159], v[48:63]
    ds_read_b64_tr_b16 v[20:21], v4 offset:53248
    ds_read_b64_tr_b16 v[22:23], v4 offset:53760
    s_waitcnt lgkmcnt(9)
    s_setprio 2
    v_mfma_f32_32x32x16_bf16 v[64:79], v[32:35], v[144:147], v[64:79]
    s_setprio 0
    ds_read_b64_tr_b16 v[24:25], v4 offset:57344
    ds_read_b64_tr_b16 v[26:27], v4 offset:57856
    v_mfma_f32_32x32x16_bf16 v[64:79], v[36:39], v[148:151], v[64:79]
    ds_read_b64_tr_b16 v[28:29], v4 offset:61440
    ds_read_b64_tr_b16 v[30:31], v4 offset:61952
    s_waitcnt lgkmcnt(8)
    v_mfma_f32_32x32x16_bf16 v[64:79], v[40:43], v[152:155], v[64:79]
    ds_read_b32 v15, v0 offset:0
    ds_read_b64_tr_b16 v[32:33], v5 offset:49152
    ds_read_b64_tr_b16 v[34:35], v5 offset:49664
    s_setprio 2
    v_mfma_f32_32x32x16_bf16 v[64:79], v[44:47], v[156:159], v[64:79]
    s_setprio 0
    ds_read_b64_tr_b16 v[36:37], v5 offset:53248
    ds_read_b64_tr_b16 v[38:39], v5 offset:53760
    s_waitcnt lgkmcnt(9)
    v_mfma_f32_32x32x16_bf16 v[80:95], v[16:19], v[144:147], v[80:95]
    ds_read_b64_tr_b16 v[40:41], v5 offset:57344
    ds_read_b64_tr_b16 v[42:43], v5 offset:57856
    v_mfma_f32_32x32x16_bf16 v[80:95], v[20:23], v[148:151], v[80:95]
    s_setprio 2
    s_waitcnt lgkmcnt(6)
L_cg38:
    v_cmp_gt_u32 vcc, 608, v15
    s_cbranch_vccz L_cg38_ok
    s_add_u32 s3, s3, 1
    s_cmp_ge_u32 s3, 0x400000
    s_cbranch_scc1 L_cg38_ok
    ds_read_b32 v15, v0 offset:0
    s_waitcnt lgkmcnt(0)
    s_branch L_cg38
L_cg38_ok:
    s_setprio 0
    ds_read_b64_tr_b16 v[44:45], v5 offset:61440
    ds_read_b64_tr_b16 v[46:47], v5 offset:61952
    s_add_u32 m0, s45, 32768
    s_add_u32 s43, s72, s47
    s_add_u32 s47, s47, 128
    buffer_load_dwordx4 v9, s[12:15], s43 offen offset:0 lds
    s_setprio 2
    v_mfma_f32_32x32x16_bf16 v[80:95], v[24:27], v[152:155], v[80:95]
    s_setprio 0
    s_setprio 2
    v_add_u32 v2, 65536, v2
    v_add_u32 v3, 65536, v3
    v_add_u32 v4, 65536, v4
    v_add_u32 v5, 65536, v5
    s_setprio 0
    ds_read_b64_tr_b16 v[16:17], v2 offset:0
    ds_read_b64_tr_b16 v[18:19], v2 offset:512
    buffer_load_dwordx4 v10, s[12:15], s43 offen offset:1024 lds
    v_mfma_f32_32x32x16_bf16 v[80:95], v[28:31], v[156:159], v[80:95]
    ds_read_b64_tr_b16 v[20:21], v2 offset:4096
    ds_read_b64_tr_b16 v[22:23], v2 offset:4608
    buffer_load_dwordx4 v7, s[16:19], s43 offen offset:2048 lds
    s_waitcnt lgkmcnt(8)
    v_mfma_f32_32x32x16_bf16 v[96:111], v[32:35], v[144:147], v[96:111]
    ds_read_b64_tr_b16 v[24:25], v2 offset:8192
    ds_read_b64_tr_b16 v[26:27], v2 offset:8704
    buffer_load_dwordx4 v8, s[16:19], s43 offen offset:3072 lds
    s_setprio 2
    v_mfma_f32_32x32x16_bf16 v[96:111], v[36:39], v[148:151], v[96:111]
    s_setprio 0
    ds_read_b64_tr_b16 v[28:29], v2 offset:12288
    ds_read_b64_tr_b16 v[30:31], v2 offset:12800
    s_waitcnt lgkmcnt(8)
    v_mfma_f32_32x32x16_bf16 v[96:111], v[40:43], v[152:155], v[96:111]
    ds_read_b64_tr_b16 v[32:33], v3 offset:0
    ds_read_b64_tr_b16 v[34:35], v3 offset:512
    v_mfma_f32_32x32x16_bf16 v[96:111], v[44:47], v[156:159], v[96:111]
    ds_read_b64_tr_b16 v[36:37], v3 offset:4096
    ds_read_b64_tr_b16 v[38:39], v3 offset:4608
    s_waitcnt vmcnt(20)
    s_waitcnt vmcnt(9)
    s_mov_b64 exec, 1
    ds_add_u32 v0, v0 offset:0
    s_mov_b64 exec, -1
    s_waitcnt lgkmcnt(9)
    s_setprio 2
    v_mfma_f32_32x32x16_bf16 v[48:63], v[16:19], v[160:163], v[48:63]
    s_setprio 0
    ds_read_b64_tr_b16 v[40:41], v3 offset:8192
    ds_read_b64_tr_b16 v[42:43], v3 offset:8704
    v_mfma_f32_32x32x16_bf16 v[48:63], v[20:23], v[164:167], v[48:63]
    ds_read_b64_tr_b16 v[44:45], v3 offset:12288
    ds_read_b64_tr_b16 v[46:47], v3 offset:12800
    s_waitcnt lgkmcnt(9)
    v_mfma_f32_32x32x16_bf16 v[48:63], v[24:27], v[168:171], v[48:63]
    ds_read_b64_tr_b16 v[16:17], v4 offset:0
    ds_read_b64_tr_b16 v[18:19], v4 offset:512
    s_setprio 2
    v_mfma_f32_32x32x16_bf16 v[48:63], v[28:31], v[172:175], v[48:63]
    s_setprio 0
    ds_read_b64_tr_b16 v[20:21], v4 offset:4096
    ds_read_b64_tr_b16 v[22:23], v4 offset:4608
    s_waitcnt lgkmcnt(9)
    v_mfma_f32_32x32x16_bf16 v[64:79], v[32:35], v[160:163], v[64:79]
    ds_read_b64_tr_b16 v[24:25], v4 offset:8192
    ds_read_b64_tr_b16 v[26:27], v4 offset:8704
    v_mfma_f32_32x32x16_bf16 v[64:79], v[36:39], v[164:167], v[64:79]
    ds_read_b64_tr_b16 v[28:29], v4 offset:12288
    ds_read_b64_tr_b16 v[30:31], v4 offset:12800
    s_waitcnt lgkmcnt(8)
    s_setprio 2
    v_mfma_f32_32x32x16_bf16 v[64:79], v[40:43], v[168:171], v[64:79]
    s_setprio 0
    ds_read_b32 v15, v0 offset:0
    ds_read_b64_tr_b16 v[32:33], v5 offset:0
    ds_read_b64_tr_b16 v[34:35], v5 offset:512
    v_mfma_f32_32x32x16_bf16 v[64:79], v[44:47], v[172:175], v[64:79]
    ds_read_b64_tr_b16 v[36:37], v5 offset:4096
    ds_read_b64_tr_b16 v[38:39], v5 offset:4608
    s_waitcnt lgkmcnt(9)
    v_mfma_f32_32x32x16_bf16 v[80:95], v[16:19], v[160:163], v[80:95]
    ds_read_b64_tr_b16 v[40:41], v5 offset:8192
    ds_read_b64_tr_b16 v[42:43], v5 offset:8704
    s_setprio 2
    v_mfma_f32_32x32x16_bf16 v[80:95], v[20:23], v[164:167], v[80:95]
    s_setprio 0
    s_setprio 2
    s_waitcnt lgkmcnt(6)
L_cg39:
    v_cmp_gt_u32 vcc, 624, v15
    s_cbranch_vccz L_cg39_ok
    s_add_u32 s3, s3, 1
    s_cmp_ge_u32 s3, 0x400000
    s_cbranch_scc1 L_cg39_ok
    ds_read_b32 v15, v0 offset:0
    s_waitcnt lgkmcnt(0)
    s_branch L_cg39
L_cg39_ok:
    s_setprio 0
    s_setprio 2
    s_cmp_lg_u32 s36, 0
    s_cbranch_scc1 L_g_nohp39
    v_mov_b32 v13, s61
    v_mov_b32 v14, s60
    v_cmp_gt_u32 vcc, 4, v1
    s_nop 1
    v_cndmask_b32 v14, v13, v14, vcc
    v_mul_u32_u24 v13, 128, v1
    s_mov_b64 exec, 0xf0
    v_subrev_u32 v13, 496, v13
    s_mov_b64 exec, 0xff
    buffer_store_dword v14, v13, s[28:31], s46 offen sc1
    s_mov_b64 exec, -1
L_g_nohp39:
    ds_read_b64_tr_b16 v[44:45], v5 offset:12288
    ds_read_b64_tr_b16 v[46:47], v5 offset:12800
    s_and_b32 s40, s36, 1
    s_mul_i32 s45, s40, 18432
    s_mul_i32 s42, s74, 288
    s_add_u32 s45, s45, s42
    s_mul_i32 s40, s40, 20736
    s_add_u32 s72, s75, 18432
    s_add_u32 s75, s75, s40
    s_setprio 0
    v_mfma_f32_32x32x16_bf16 v[80:95], v[24:27], v[168:171], v[80:95]
    ds_read_b64_tr_b16 v[16:17], v2 offset:16384
    ds_read_b64_tr_b16 v[18:19], v2 offset:16896
    s_add_u32 s40, s74, 0
    s_and_b32 s40, s40, 3
    s_lshl_b32 s41, s73, 2
    s_add_u32 s41, s41, s40
    s_mul_i32 s41, s41, 331776
    s_add_u32 s41, s41, s45
    s_nop 0
    s_bitcmp1_b32 s40, 0
    s_cselect_b32 s40, 0, 36864
    s_cselect_b32 s42, 0, 294912
    s_sub_u32 s64, s41, s40
    s_add_u32 s68, s41, s42
    v_mfma_f32_32x32x16_bf16 v[80:95], v[28:31], v[172:175], v[80:95]
    ds_read_b64_tr_b16 v[20:21], v2 offset:20480
    ds_read_b64_tr_b16 v[22:23], v2 offset:20992
    s_add_u32 s40, s74, 1
    s_and_b32 s40, s40, 3
    s_lshl_b32 s41, s73, 2
    s_add_u32 s41, s41, s40
    s_mul_i32 s41, s41, 331776
    s_add_u32 s41, s41, s45
    s_nop 0
    s_bitcmp1_b32 s40, 0
    s_cselect_b32 s40, 0, 36864
    s_cselect_b32 s42, 0, 294912
    s_sub_u32 s65, s41, s40
    s_add_u32 s69, s41, s42
    s_waitcnt lgkmcnt(8)
    s_setprio 2
    v_mfma_f32_32x32x16_bf16 v[96:111], v[32:35], v[160:163], v[96:111]
    s_setprio 0
    ds_read_b64_tr_b16 v[24:25], v2 offset:24576
    ds_read_b64_tr_b16 v[26:27], v2 offset:25088
    s_add_u32 s40, s74, 2
    s_and_b32 s40, s40, 3
    s_lshl_b32 s41, s73, 2
    s_add_u32 s41, s41, s40
    s_mul_i32 s41, s41, 331776
    s_add_u32 s41, s41, s45
    s_nop 0
    s_bitcmp1_b32 s40, 0
    s_cselect_b32 s40, 0, 36864
    s_cselect_b32 s42, 0, 294912
    s_sub_u32 s66, s41, s40
    s_add_u32 s70, s41, s42
    v_mfma_f32_32x32x16_bf16 v[96:111], v[36:39], v[164:167], v[96:111]
    ds_read_b64_tr_b16 v[28:29], v2 offset:28672
    ds_read_b64_tr_b16 v[30:31], v2 offset:29184
    s_add_u32 s40, s74, 3
    s_and_b32 s40, s40, 3
    s_lshl_b32 s41, s73, 2
    s_add_u32 s41, s41, s40
    s_mul_i32 s41, s41, 331776
    s_add_u32 s41, s41, s45
    s_nop 0
    s_bitcmp1_b32 s40, 0
    s_cselect_b32 s40, 0, 36864
    s_cselect_b32 s42, 0, 294912
    s_sub_u32 s67, s41, s40
    s_add_u32 s71, s41, s42
    s_waitcnt lgkmcnt(8)
    v_mfma_f32_32x32x16_bf16 v[96:111], v[40:43], v[168:171], v[96:111]
    ds_read_b64_tr_b16 v[32:33], v3 offset:16384
    ds_read_b64_tr_b16 v[34:35], v3 offset:16896
    s_mov_b32 s12, s82
    s_mov_b32 s13, s83
    s_mov_b32 s14, 2359296
    s_mov_b32 s15, 0x20000
    s_setprio 2
    v_mfma_f32_32x32x16_bf16 v[96:111], v[44:47], v[172:175], v[96:111]
    s_setprio 0
    ds_read_b64_tr_b16 v[36:37], v3 offset:20480
    ds_read_b64_tr_b16 v[38:39], v3 offset:20992
    s_mov_b32 s56, 4096
    s_mov_b32 s41, 13421773
    s_setprio 2
    v_add_u32 v13, 0, v11
    v_mul_hi_u32 v14, v13, s41
    v_mul_u32_u24 v6, 320, v14
    v_sub_u32 v13, v13, v6
    v_add_u32 v6, 224, v13
    v_lshrrev_b32 v6, 9, v6
    v_lshl_add_u32 v13, v6, 30, v13
    v_mul_u32_u24 v14, 1152, v14
    v_add3_u32 v6, v14, v13, s56
    s_setprio 0
    s_mov_b32 s56, 3072
    s_mov_b32 s41, 13421773
    s_setprio 2
    v_add_u32 v13, 1024, v11
    v_mul_hi_u32 v14, v13, s41
    v_mul_u32_u24 v7, 320, v14
    v_sub_u32 v13, v13, v7
    v_add_u32 v7, 224, v13
    v_lshrrev_b32 v7, 9, v7
    v_lshl_add_u32 v13, v7, 30, v13
    v_mul_u32_u24 v14, 1152, v14
    v_add3_u32 v7, v14, v13, s56
    s_setprio 0
    s_mov_b32 s56, 2048
    s_mov_b32 s41, 13421773
    s_setprio 2
    v_add_u32 v13, 2048, v11
    v_mul_hi_u32 v14, v13, s41
    v_mul_u32_u24 v8, 320, v14
    v_sub_u32 v13, v13, v8
    v_add_u32 v8, 224, v13
    v_lshrrev_b32 v8, 9, v8
    v_lshl_add_u32 v13, v8, 30, v13
    v_mul_u32_u24 v14, 1152, v14
    v_add3_u32 v8, v14, v13, s56
    s_setprio 0
    s_mov_b32 s56, 1024
    s_mov_b32 s41, 13421773
    s_setprio 2
    v_add_u32 v13, 3072, v11
    v_mul_hi_u32 v14, v13, s41
    v_mul_u32_u24 v9, 320, v14
    v_sub_u32 v13, v13, v9
    v_add_u32 v9, 224, v13
    v_lshrrev_b32 v9, 9, v9
    v_lshl_add_u32 v13, v9, 30, v13
    v_mul_u32_u24 v14, 1152, v14
    v_add3_u32 v9, v14, v13, s56
    s_setprio 0
    s_mov_b32 s56, 4096
    s_mov_b32 s41, 13421773
    s_setprio 2
    v_add_u32 v13, 4096, v11
    v_mul_hi_u32 v14, v13, s41
    v_mul_u32_u24 v10, 320, v14
    v_sub_u32 v13, v13, v10
    v_add_u32 v10, 224, v13
    v_lshrrev_b32 v10, 9, v10
    v_lshl_add_u32 v13, v10, 30, v13
    v_mul_u32_u24 v14, 1152, v14
    v_add3_u32 v10, v14, v13, s56
    s_setprio 0
    s_mov_b64 exec, 1
    ds_add_u32 v0, v0 offset:0
    s_mov_b64 exec, -1
    s_waitcnt lgkmcnt(9)
    v_mfma_f32_32x32x16_bf16 v[48:63], v[16:19], v[176:179], v[48:63]
    ds_read_b64_tr_b16 v[40:41], v3 offset:24576
    ds_read_b64_tr_b16 v[42:43], v3 offset:25088
    v_mfma_f32_32x32x16_bf16 v[48:63], v[20:23], v[180:183], v[48:63]
    ds_read_b64_tr_b16 v[44:45], v3 offset:28672
    ds_read_b64_tr_b16 v[46:47], v3 offset:29184
    s_waitcnt lgkmcnt(9)
    s_setprio 2
    v_mfma_f32_32x32x16_bf16 v[48:63], v[24:27], v[184:187], v[48:63]
    s_setprio 0
    ds_read_b64_tr_b16 v[16:17], v4 offset:16384
    ds_read_b64_tr_b16 v[18:19], v4 offset:16896
    v_mfma_f32_32x32x16_bf16 v[48:63], v[28:31], v[188:191], v[48:63]
    ds_read_b64_tr_b16 v[20:21], v4 offset:20480
    ds_read_b64_tr_b16 v[22:23], v4 offset:20992
    s_waitcnt lgkmcnt(9)
    v_mfma_f32_32x32x16_bf16 v[64:79], v[32:35], v[176:179], v[64:79]
    ds_read_b64_tr_b16 v[24:25], v4 offset:24576
    ds_read_b64_tr_b16 v[26:27], v4 offset:25088
    s_setprio 2
    v_mfma_f32_32x32x16_bf16 v[64:79], v[36:39], v[180:183], v[64:79]
    s_setprio 0
    ds_read_b64_tr_b16 v[28:29], v4 offset:28672
    ds_read_b64_tr_b16 v[30:31], v4 offset:29184
    s_waitcnt lgkmcnt(8)
    v_mfma_f32_32x32x16_bf16 v[64:79], v[40:43], v[184:187], v[64:79]
    ds_read_b32 v15, v0 offset:0
    ds_read_b64_tr_b16 v[32:33], v5 offset:16384
    ds_read_b64_tr_b16 v[34:35], v5 offset:16896
    v_mfma_f32_32x32x16_bf16 v[64:79], v[44:47], v[188:191], v[64:79]
    ds_read_b64_tr_b16 v[36:37], v5 offset:20480
    ds_read_b64_tr_b16 v[38:39], v5 offset:20992
    s_waitcnt lgkmcnt(9)
    s_setprio 2
    v_mfma_f32_32x32x16_bf16 v[80:95], v[16:19], v[176:179], v[80:95]
    s_setprio 0
    ds_read_b64_tr_b16 v[40:41], v5 offset:24576
    ds_read_b64_tr_b16 v[42:43], v5 offset:25088
    v_mfma_f32_32x32x16_bf16 v[80:95], v[20:23], v[180:183], v[80:95]
    s_setprio 2
    s_waitcnt lgkmcnt(6)
L_cg40:
    v_cmp_gt_u32 vcc, 640, v15
    s_cbranch_vccz L_cg40_ok
    s_add_u32 s3, s3, 1
    s_cmp_ge_u32 s3, 0x400000
    s_cbranch_scc1 L_cg40_ok
    ds_read_b32 v15, v0 offset:0
    s_waitcnt lgkmcnt(0)
    s_branch L_cg40
L_cg40_ok:
    s_setprio 0
    ds_read_b64_tr_b16 v[44:45], v5 offset:28672
    ds_read_b64_tr_b16 v[46:47], v5 offset:29184
    s_mov_b32 s42, s68
    s_add_u32 s43, s64, 36864
    s_cmp_lt_u32 s36, 2
    s_cselect_b32 s43, s42, s43
    s_add_u32 m0, s63, 49152
    s_nop 0
    buffer_load_dwordx4 v6, s[8:11], s43 offen offset:0 lds
    buffer_load_dwordx4 v7, s[8:11], s43 offen offset:1024 lds
    v_mfma_f32_32x32x16_bf16 v[80:95], v[24:27], v[184:187], v[80:95]
    ds_read_b64_tr_b16 v[16:17], v2 offset:32768
    ds_read_b64_tr_b16 v[18:19], v2 offset:33280
    buffer_load_dwordx4 v8, s[8:11], s43 offen offset:2048 lds
    buffer_load_dwordx4 v9, s[8:11], s43 offen offset:3072 lds
    s_add_u32 m0, s63, 53248
    s_nop 0
    buffer_load_dwordx4 v10, s[8:11], s43 offen offset:0 lds
    s_setprio 2
    v_mfma_f32_32x32x16_bf16 v[80:95], v[28:31], v[188:191], v[80:95]
    s_setprio 0
    ds_read_b64_tr_b16 v[20:21], v2 offset:36864
    ds_read_b64_tr_b16 v[22:23], v2 offset:37376
    s_add_u32 s42, s76, 0
    buffer_load_dwordx4 v[112:115], v11, s[24:27], s42 offen sc1
    buffer_load_dwordx4 v[116:119], v11, s[24:27], s42 offen offset:1024 sc1
    s_waitcnt lgkmcnt(8)
    v_mfma_f32_32x32x16_bf16 v[96:111], v[32:35], v[176:179], v[96:111]
    ds_read_b64_tr_b16 v[24:25], v2 offset:40960
    ds_read_b64_tr_b16 v[26:27], v2 offset:41472
    s_add_u32 s42, s76, 2048
    buffer_load_dwordx4 v[120:123], v11, s[24:27], s42 offen sc1
    buffer_load_dwordx4 v[124:127], v11, s[24:27], s42 offen offset:1024 sc1
    v_mfma_f32_32x32x16_bf16 v[96:111], v[36:39], v[180:183], v[96:111]
    ds_read_b64_tr_b16 v[28:29], v2 offset:45056
    ds_read_b64_tr_b16 v[30:31], v2 offset:45568
    s_add_u32 s42, s76, 4096
    buffer_load_dwordx4 v[128:131], v11, s[24:27], s42 offen sc1
    buffer_load_dwordx4 v[132:135], v11, s[24:27], s42 offen offset:1024 sc1
    s_waitcnt lgkmcnt(8)
    s_setprio 2
    v_mfma_f32_32x32x16_bf16 v[96:111], v[40:43], v[184:187], v[96:111]
    s_setprio 0
    ds_read_b64_tr_b16 v[32:33], v3 offset:32768
    ds_read_b64_tr_b16 v[34:35], v3 offset:33280
    v_mfma_f32_32x32x16_bf16 v[96:111], v[44:47], v[188:191], v[96:111]
    ds_read_b64_tr_b16 v[36:37], v3 offset:36864
    ds_read_b64_tr_b16 v[38:39], v3 offset:37376
    s_waitcnt vmcnt(19)
    s_mov_b64 exec, 1
    ds_add_u32 v0, v0 offset:0
    s_mov_b64 exec, -1
    s_waitcnt lgkmcnt(9)
    v_mfma_f32_32x32x16_bf16 v[48:63], v[16:19], v[192:195], v[48:63]
    ds_read_b64_tr_b16 v[40:41], v3 offset:40960
    ds_read_b64_tr_b16 v[42:43], v3 offset:41472
    s_setprio 2
    v_mfma_f32_32x32x16_bf16 v[48:63], v[20:23], v[196:199], v[48:63]
    s_setprio 0
    ds_read_b64_tr_b16 v[44:45], v3 offset:45056
    ds_read_b64_tr_b16 v[46:47], v3 offset:45568
    s_waitcnt lgkmcnt(9)
    v_mfma_f32_32x32x16_bf16 v[48:63], v[24:27], v[200:203], v[48:63]
    ds_read_b64_tr_b16 v[16:17], v4 offset:32768
    ds_read_b64_tr_b16 v[18:19], v4 offset:33280
    v_mfma_f32_32x32x16_bf16 v[48:63], v[28:31], v[204:207], v[48:63]
    ds_read_b64_tr_b16 v[20:21], v4 offset:36864
    ds_read_b64_tr_b16 v[22:23], v4 offset:37376
    s_waitcnt lgkmcnt(9)
    s_setprio 2
    v_mfma_f32_32x32x16_bf16 v[64:79], v[32:35], v[192:195], v[64:79]
    s_setprio 0
    ds_read_b64_tr_b16 v[24:25], v4 offset:40960
    ds_read_b64_tr_b16 v[26:27], v4 offset:41472
    v_mfma_f32_32x32x16_bf16 v[64:79], v[36:39], v[196:199], v[64:79]
    ds_read_b64_tr_b16 v[28:29], v4 offset:45056
    ds_read_b64_tr_b16 v[30:31], v4 offset:45568
    s_waitcnt lgkmcnt(8)
    v_mfma_f32_32x32x16_bf16 v[64:79], v[40:43], v[200:203], v[64:79]
    ds_read_b32 v15, v0 offset:0
    ds_read_b64_tr_b16 v[32:33], v5 offset:32768
    ds_read_b64_tr_b16 v[34:35], v5 offset:33280
    s_setprio 2
    v_mfma_f32_32x32x16_bf16 v[64:79], v[44:47], v[204:207], v[64:79]
    s_setprio 0
    ds_read_b64_tr_b16 v[36:37], v5 offset:36864
    ds_read_b64_tr_b16 v[38:39], v5 offset:37376
    s_waitcnt lgkmcnt(9)
    v_mfma_f32_32x32x16_bf16 v[80:95], v[16:19], v[192:195], v[80:95]
    ds_read_b64_tr_b16 v[40:41], v5 offset:40960
    ds_read_b64_tr_b16 v[42:43], v5 offset:41472
    v_mfma_f32_32x32x16_bf16 v[80:95], v[20:23], v[196:199], v[80:95]
    s_setprio 2
    s_waitcnt lgkmcnt(6)
L_cg41:
    v_cmp_gt_u32 vcc, 656, v15
    s_cbranch_vccz L_cg41_ok
    s_add_u32 s3, s3, 1
    s_cmp_ge_u32 s3, 0x400000
    s_cbranch_scc1 L_cg41_ok
    ds_read_b32 v15, v0 offset:0
    s_waitcnt lgkmcnt(0)
    s_branch L_cg41
L_cg41_ok:
    s_setprio 0
    ds_read_b64_tr_b16 v[44:45], v5 offset:45056
    ds_read_b64_tr_b16 v[46:47], v5 offset:45568
    s_add_u32 s42, s64, 73728
    s_add_u32 s43, s64, 110592
    s_cmp_lt_u32 s36, 2
    s_cselect_b32 s43, s42, s43
    s_add_u32 m0, s63, 69632
    s_nop 0
    buffer_load_dwordx4 v6, s[8:11], s43 offen offset:0 lds
    buffer_load_dwordx4 v7, s[8:11], s43 offen offset:1024 lds
    s_setprio 2
    v_mfma_f32_32x32x16_bf16 v[80:95], v[24:27], v[200:203], v[80:95]
    s_setprio 0
    s_setprio 2
    v_subrev_u32 v2, 65536, v2
    v_subrev_u32 v3, 65536, v3
    v_subrev_u32 v4, 65536, v4
    v_subrev_u32 v5, 65536, v5
    s_setprio 0
    ds_read_b64_tr_b16 v[16:17], v2 offset:0
    ds_read_b64_tr_b16 v[18:19], v2 offset:512
    buffer_load_dwordx4 v8, s[8:11], s43 offen offset:2048 lds
    buffer_load_dwordx4 v9, s[8:11], s43 offen offset:3072 lds
    s_add_u32 m0, s63, 73728
    s_nop 0
    buffer_load_dwordx4 v10, s[8:11], s43 offen offset:0 lds
    v_mfma_f32_32x32x16_bf16 v[80:95], v[28:31], v[204:207], v[80:95]
    ds_read_b64_tr_b16 v[20:21], v2 offset:4096
    ds_read_b64_tr_b16 v[22:23], v2 offset:4608
    s_add_u32 s42, s76, 6144
    buffer_load_dwordx4 v[136:139], v11, s[24:27], s42 offen sc1
    buffer_load_dwordx4 v[140:143], v11, s[24:27], s42 offen offset:1024 sc1
    s_waitcnt lgkmcnt(8)
    v_mfma_f32_32x32x16_bf16 v[96:111], v[32:35], v[192:195], v[96:111]
    ds_read_b64_tr_b16 v[24:25], v2 offset:8192
    ds_read_b64_tr_b16 v[26:27], v2 offset:8704
    s_add_u32 s42, s76, 8192
    buffer_load_dwordx4 v[144:147], v11, s[24:27], s42 offen sc1
    buffer_load_dwordx4 v[148:151], v11, s[24:27], s42 offen offset:1024 sc1
    s_setprio 2
    v_mfma_f32_32x32x16_bf16 v[96:111], v[36:39], v[196:199], v[96:111]
    s_setprio 0
    ds_read_b64_tr_b16 v[28:29], v2 offset:12288
    ds_read_b64_tr_b16 v[30:31], v2 offset:12800
    s_waitcnt lgkmcnt(8)
    v_mfma_f32_32x32x16_bf16 v[96:111], v[40:43], v[200:203], v[96:111]
    ds_read_b64_tr_b16 v[32:33], v3 offset:0
    ds_read_b64_tr_b16 v[34:35], v3 offset:512
    v_mfma_f32_32x32x16_bf16 v[96:111], v[44:47], v[204:207], v[96:111]
    ds_read_b64_tr_b16 v[36:37], v3 offset:4096
    ds_read_b64_tr_b16 v[38:39], v3 offset:4608
    s_waitcnt vmcnt(24)
    s_mov_b64 exec, 1
    ds_add_u32 v0, v0 offset:0
    s_mov_b64 exec, -1
    s_waitcnt lgkmcnt(9)
    s_setprio 2
    v_mfma_f32_32x32x16_bf16 v[48:63], v[16:19], v[208:211], v[48:63]
    s_setprio 0
    ds_read_b64_tr_b16 v[40:41], v3 offset:8192
    ds_read_b64_tr_b16 v[42:43], v3 offset:8704
    v_mfma_f32_32x32x16_bf16 v[48:63], v[20:23], v[212:215], v[48:63]
    ds_read_b64_tr_b16 v[44:45], v3 offset:12288
    ds_read_b64_tr_b16 v[46:47], v3 offset:12800
    s_waitcnt lgkmcnt(9)
    v_mfma_f32_32x32x16_bf16 v[48:63], v[24:27], v[216:219], v[48:63]
    ds_read_b64_tr_b16 v[16:17], v4 offset:0
    ds_read_b64_tr_b16 v[18:19], v4 offset:512
    s_setprio 2
    v_mfma_f32_32x32x16_bf16 v[48:63], v[28:31], v[220:223], v[48:63]
    s_setprio 0
    ds_read_b64_tr_b16 v[20:21], v4 offset:4096
    ds_read_b64_tr_b16 v[22:23], v4 offset:4608
    s_waitcnt lgkmcnt(9)
    v_mfma_f32_32x32x16_bf16 v[64:79], v[32:35], v[208:211], v[64:79]
    ds_read_b64_tr_b16 v[24:25], v4 offset:8192
    ds_read_b64_tr_b16 v[26:27], v4 offset:8704
    v_mfma_f32_32x32x16_bf16 v[64:79], v[36:39], v[212:215], v[64:79]
    ds_read_b64_tr_b16 v[28:29], v4 offset:12288
    ds_read_b64_tr_b16 v[30:31], v4 offset:12800
    s_waitcnt lgkmcnt(8)
    s_setprio 2
    v_mfma_f32_32x32x16_bf16 v[64:79], v[40:43], v[216:219], v[64:79]
    s_setprio 0
    ds_read_b32 v15, v0 offset:0
    ds_read_b64_tr_b16 v[32:33], v5 offset:0
    ds_read_b64_tr_b16 v[34:35], v5 offset:512
    v_mfma_f32_32x32x16_bf16 v[64:79], v[44:47], v[220:223], v[64:79]
    ds_read_b64_tr_b16 v[36:37], v5 offset:4096
    ds_read_b64_tr_b16 v[38:39], v5 offset:4608
    s_waitcnt lgkmcnt(9)
    v_mfma_f32_32x32x16_bf16 v[80:95], v[16:19], v[208:211], v[80:95]
    ds_read_b64_tr_b16 v[40:41], v5 offset:8192
    ds_read_b64_tr_b16 v[42:43], v5 offset:8704
    s_setprio 2
    v_mfma_f32_32x32x16_bf16 v[80:95], v[20:23], v[212:215], v[80:95]
    s_setprio 0
    s_setprio 2
    s_waitcnt lgkmcnt(6)
L_cg42:
    v_cmp_gt_u32 vcc, 672, v15
    s_cbranch_vccz L_cg42_ok
    s_add_u32 s3, s3, 1
    s_cmp_ge_u32 s3, 0x400000
    s_cbranch_scc1 L_cg42_ok
    ds_read_b32 v15, v0 offset:0
    s_waitcnt lgkmcnt(0)
    s_branch L_cg42
L_cg42_ok:
    s_setprio 0
    ds_read_b64_tr_b16 v[44:45], v5 offset:12288
    ds_read_b64_tr_b16 v[46:47], v5 offset:12800
    s_add_u32 s42, s64, 147456
    s_add_u32 s43, s64, 184320
    s_cmp_lt_u32 s36, 2
    s_cselect_b32 s43, s42, s43
    s_add_u32 m0, s63, 90112
    s_nop 0
    buffer_load_dwordx4 v6, s[8:11], s43 offen offset:0 lds
    buffer_load_dwordx4 v7, s[8:11], s43 offen offset:1024 lds
    v_mfma_f32_32x32x16_bf16 v[80:95], v[24:27], v[216:219], v[80:95]
    ds_read_b64_tr_b16 v[16:17], v2 offset:16384
    ds_read_b64_tr_b16 v[18:19], v2 offset:16896
    buffer_load_dwordx4 v8, s[8:11], s43 offen offset:2048 lds
    buffer_load_dwordx4 v9, s[8:11], s43 offen offset:3072 lds
    s_add_u32 m0, s63, 94208
    s_nop 0
    buffer_load_dwordx4 v10, s[8:11], s43 offen offset:0 lds
    v_mfma_f32_32x32x16_bf16 v[80:95], v[28:31], v[220:223], v[80:95]
    ds_read_b64_tr_b16 v[20:21], v2 offset:20480
    ds_read_b64_tr_b16 v[22:23], v2 offset:20992
    s_add_u32 s42, s76, 10240
    buffer_load_dwordx4 v[152:155], v11, s[24:27], s42 offen sc1
    buffer_load_dwordx4 v[156:159], v11, s[24:27], s42 offen offset:1024 sc1
    s_waitcnt lgkmcnt(8)
    s_setprio 2
    v_mfma_f32_32x32x16_bf16 v[96:111], v[32:35], v[208:211], v[96:111]
    s_setprio 0
    ds_read_b64_tr_b16 v[24:25], v2 offset:24576
    ds_read_b64_tr_b16 v[26:27], v2 offset:25088
    s_add_u32 s42, s76, 12288
    buffer_load_dwordx4 v[160:163], v11, s[24:27], s42 offen sc1
    buffer_load_dwordx4 v[164:167], v11, s[24:27], s42 offen offset:1024 sc1
    v_mfma_f32_32x32x16_bf16 v[96:111], v[36:39], v[212:215], v[96:111]
    ds_read_b64_tr_b16 v[28:29], v2 offset:28672
    ds_read_b64_tr_b16 v[30:31], v2 offset:29184
    s_waitcnt lgkmcnt(8)
    v_mfma_f32_32x32x16_bf16 v[96:111], v[40:43], v[216:219], v[96:111]
    ds_read_b64_tr_b16 v[32:33], v3 offset:16384
    ds_read_b64_tr_b16 v[34:35], v3 offset:16896
    s_setprio 2
    v_mfma_f32_32x32x16_bf16 v[96:111], v[44:47], v[220:223], v[96:111]
    s_setprio 0
    ds_read_b64_tr_b16 v[36:37], v3 offset:20480
    ds_read_b64_tr_b16 v[38:39], v3 offset:20992
    s_waitcnt vmcnt(29)
    s_mov_b64 exec, 1
    ds_add_u32 v0, v0 offset:0
    s_mov_b64 exec, -1
    s_waitcnt lgkmcnt(9)
    v_mfma_f32_32x32x16_bf16 v[48:63], v[16:19], v[224:227], v[48:63]
    ds_read_b64_tr_b16 v[40:41], v3 offset:24576
    ds_read_b64_tr_b16 v[42:43], v3 offset:25088
    v_mfma_f32_32x32x16_bf16 v[48:63], v[20:23], v[228:231], v[48:63]
    ds_read_b64_tr_b16 v[44:45], v3 offset:28672
    ds_read_b64_tr_b16 v[46:47], v3 offset:29184
    s_waitcnt lgkmcnt(9)
    s_setprio 2
    v_mfma_f32_32x32x16_bf16 v[48:63], v[24:27], v[232:235], v[48:63]
    s_setprio 0
    ds_read_b64_tr_b16 v[16:17], v4 offset:16384
    ds_read_b64_tr_b16 v[18:19], v4 offset:16896
    v_mfma_f32_32x32x16_bf16 v[48:63], v[28:31], v[236:239], v[48:63]
    ds_read_b64_tr_b16 v[20:21], v4 offset:20480
    ds_read_b64_tr_b16 v[22:23], v4 offset:20992
    s_waitcnt lgkmcnt(9)
    v_mfma_f32_32x32x16_bf16 v[64:79], v[32:35], v[224:227], v[64:79]
    ds_read_b64_tr_b16 v[24:25], v4 offset:24576
    ds_read_b64_tr_b16 v[26:27], v4 offset:25088
    s_setprio 2
    v_mfma_f32_32x32x16_bf16 v[64:79], v[36:39], v[228:231], v[64:79]
    s_setprio 0
    ds_read_b64_tr_b16 v[28:29], v4 offset:28672
    ds_read_b64_tr_b16 v[30:31], v4 offset:29184
    s_waitcnt lgkmcnt(8)
    v_mfma_f32_32x32x16_bf16 v[64:79], v[40:43], v[232:235], v[64:79]
    ds_read_b32 v15, v0 offset:0
    ds_read_b64_tr_b16 v[32:33], v5 offset:16384
    ds_read_b64_tr_b16 v[34:35], v5 offset:16896
    v_mfma_f32_32x32x16_bf16 v[64:79], v[44:47], v[236:239], v[64:79]
    ds_read_b64_tr_b16 v[36:37], v5 offset:20480
    ds_read_b64_tr_b16 v[38:39], v5 offset:20992
    s_waitcnt lgkmcnt(9)
    s_setprio 2
    v_mfma_f32_32x32x16_bf16 v[80:95], v[16:19], v[224:227], v[80:95]
    s_setprio 0
    ds_read_b64_tr_b16 v[40:41], v5 offset:24576
    ds_read_b64_tr_b16 v[42:43], v5 offset:25088
    v_mfma_f32_32x32x16_bf16 v[80:95], v[20:23], v[228:231], v[80:95]
    s_setprio 2
    s_waitcnt lgkmcnt(6)
L_cg43:
    v_cmp_gt_u32 vcc, 688, v15
    s_cbranch_vccz L_cg43_ok
    s_add_u32 s3, s3, 1
    s_cmp_ge_u32 s3, 0x400000
    s_cbranch_scc1 L_cg43_ok
    ds_read_b32 v15, v0 offset:0
    s_waitcnt lgkmcnt(0)
    s_branch L_cg43
L_cg43_ok:
    s_setprio 0
    ds_read_b64_tr_b16 v[44:45], v5 offset:28672
    ds_read_b64_tr_b16 v[46:47], v5 offset:29184
    v_mfma_f32_32x32x16_bf16 v[80:95], v[24:27], v[232:235], v[80:95]
    ds_read_b64_tr_b16 v[16:17], v2 offset:32768
    ds_read_b64_tr_b16 v[18:19], v2 offset:33280
    s_setprio 2
    v_mfma_f32_32x32x16_bf16 v[80:95], v[28:31], v[236:239], v[80:95]
    s_setprio 0
    ds_read_b64_tr_b16 v[20:21], v2 offset:36864
    ds_read_b64_tr_b16 v[22:23], v2 offset:37376
    s_waitcnt lgkmcnt(8)
    v_mfma_f32_32x32x16_bf16 v[96:111], v[32:35], v[224:227], v[96:111]
    ds_read_b64_tr_b16 v[24:25], v2 offset:40960
    ds_read_b64_tr_b16 v[26:27], v2 offset:41472
    v_mfma_f32_32x32x16_bf16 v[96:111], v[36:39], v[228:231], v[96:111]
    ds_read_b64_tr_b16 v[28:29], v2 offset:45056
    ds_read_b64_tr_b16 v[30:31], v2 offset:45568
    s_waitcnt lgkmcnt(8)
    s_setprio 2
    v_mfma_f32_32x32x16_bf16 v[96:111], v[40:43], v[232:235], v[96:111]
    s_setprio 0
    ds_read_b64_tr_b16 v[32:33], v3 offset:32768
    ds_read_b64_tr_b16 v[34:35], v3 offset:33280
    v_mfma_f32_32x32x16_bf16 v[96:111], v[44:47], v[236:239], v[96:111]
    ds_read_b64_tr_b16 v[36:37], v3 offset:36864
    ds_read_b64_tr_b16 v[38:39], v3 offset:37376
    s_waitcnt vmcnt(24)
    s_mov_b64 exec, 1
    ds_add_u32 v0, v0 offset:0
    s_mov_b64 exec, -1
    s_waitcnt lgkmcnt(9)
    v_mfma_f32_32x32x16_bf16 v[48:63], v[16:19], v[240:243], v[48:63]
    ds_read_b64_tr_b16 v[40:41], v3 offset:40960
    ds_read_b64_tr_b16 v[42:43], v3 offset:41472
    s_setprio 2
    v_mfma_f32_32x32x16_bf16 v[48:63], v[20:23], v[244:247], v[48:63]
    s_setprio 0
    ds_read_b64_tr_b16 v[44:45], v3 offset:45056
    ds_read_b64_tr_b16 v[46:47], v3 offset:45568
    s_waitcnt lgkmcnt(9)
    v_mfma_f32_32x32x16_bf16 v[48:63], v[24:27], v[248:251], v[48:63]
    ds_read_b64_tr_b16 v[16:17], v4 offset:32768
    ds_read_b64_tr_b16 v[18:19], v4 offset:33280
    v_mfma_f32_32x32x16_bf16 v[48:63], v[28:31], v[252:255], v[48:63]
    ds_read_b64_tr_b16 v[20:21], v4 offset:36864
    ds_read_b64_tr_b16 v[22:23], v4 offset:37376
    s_waitcnt lgkmcnt(9)
    s_setprio 2
    v_mfma_f32_32x32x16_bf16 v[64:79], v[32:35], v[240:243], v[64:79]
    ds_read_b64_tr_b16 v[24:25], v4 offset:40960
    ds_read_b64_tr_b16 v[26:27], v4 offset:41472
    s_nop 4
    v_max_f32 v48, 0, v48
    v_max_f32 v49, 0, v49
    v_mfma_f32_32x32x16_bf16 v[64:79], v[36:39], v[244:247], v[64:79]
    ds_read_b64_tr_b16 v[28:29], v4 offset:45056
    ds_read_b64_tr_b16 v[30:31], v4 offset:45568
    v_max_f32 v50, 0, v50
    v_max_f32 v51, 0, v51
    s_waitcnt lgkmcnt(8)
    v_mfma_f32_32x32x16_bf16 v[64:79], v[40:43], v[248:251], v[64:79]
    ds_read_b32 v15, v0 offset:0
    ds_read_b64_tr_b16 v[32:33], v5 offset:32768
    ds_read_b64_tr_b16 v[34:35], v5 offset:33280
    v_max_f32 v52, 0, v52
    v_max_f32 v53, 0, v53
    v_mfma_f32_32x32x16_bf16 v[64:79], v[44:47], v[252:255], v[64:79]
    ds_read_b64_tr_b16 v[36:37], v5 offset:36864
    ds_read_b64_tr_b16 v[38:39], v5 offset:37376
    v_max_f32 v54, 0, v54
    v_max_f32 v55, 0, v55
    s_waitcnt lgkmcnt(9)
    v_mfma_f32_32x32x16_bf16 v[80:95], v[16:19], v[240:243], v[80:95]
    ds_read_b64_tr_b16 v[40:41], v5 offset:40960
    ds_read_b64_tr_b16 v[42:43], v5 offset:41472
    v_mul_f32 v48, v48, v56
    v_mul_f32 v49, v49, v57
    v_mfma_f32_32x32x16_bf16 v[80:95], v[20:23], v[244:247], v[80:95]
    s_waitcnt lgkmcnt(6)
L_cg44:
    v_cmp_gt_u32 vcc, 704, v15
    s_cbranch_vccz L_cg44_ok
    s_add_u32 s3, s3, 1
    s_cmp_ge_u32 s3, 0x400000
    s_cbranch_scc1 L_cg44_ok
    ds_read_b32 v15, v0 offset:0
    s_waitcnt lgkmcnt(0)
    s_branch L_cg44
L_cg44_ok:
    ds_read_b64_tr_b16 v[44:45], v5 offset:45056
    ds_read_b64_tr_b16 v[46:47], v5 offset:45568
    s_add_u32 s42, s64, 221184
    s_mov_b32 s43, s69
    s_cmp_lt_u32 s36, 2
    s_cselect_b32 s43, s42, s43
    s_add_u32 m0, s63, 0
    s_nop 0
    buffer_load_dwordx4 v6, s[8:11], s43 offen offset:0 lds
    buffer_load_dwordx4 v7, s[8:11], s43 offen offset:1024 lds
    v_mul_f32 v50, v50, v58
    v_mul_f32 v51, v51, v59
    v_mfma_f32_32x32x16_bf16 v[80:95], v[24:27], v[248:251], v[80:95]
    v_lshrrev_b32 v4, 5, v1
    v_bfe_u32 v5, v1, 2, 2
    v_lshl_add_u32 v4, v4, 2, v5
    v_mul_u32_u24 v4, 320, v4
    v_and_b32 v5, 3, v1
    v_lshl_add_u32 v4, v5, 3, v4
    v_bfe_u32 v5, v1, 4, 1
    v_lshl_add_u32 v4, v5, 5, v4
    v_add_u32 v2, 1024, v4
    v_add_u32 v3, 50176, v4
    ds_read_b64_tr_b16 v[16:17], v3 offset:0
    ds_read_b64_tr_b16 v[18:19], v3 offset:2560
    buffer_load_dwordx4 v8, s[8:11], s43 offen offset:2048 lds
    buffer_load_dwordx4 v9, s[8:11], s43 offen offset:3072 lds
    s_add_u32 m0, s63, 4096
    s_nop 0
    buffer_load_dwordx4 v10, s[8:11], s43 offen offset:0 lds
    v_mul_f32 v52, v52, v60
    v_mul_f32 v53, v53, v61
    v_mfma_f32_32x32x16_bf16 v[80:95], v[28:31], v[252:255], v[80:95]
    ds_read_b64_tr_b16 v[20:21], v3 offset:64
    ds_read_b64_tr_b16 v[22:23], v3 offset:2624
    v_and_b32 v14, 7, v1
    v_lshlrev_b32 v14, 2, v14
    buffer_load_dword v13, v14, s[28:31], s44 offen offset:0 sc1
    v_mul_f32 v54, v54, v62
    v_mul_f32 v55, v55, v63
    s_waitcnt lgkmcnt(8)
    v_mfma_f32_32x32x16_bf16 v[96:111], v[32:35], v[240:243], v[96:111]
    ds_read_b64_tr_b16 v[24:25], v3 offset:128
    ds_read_b64_tr_b16 v[26:27], v3 offset:2688
    v_cvt_pk_bf16_f32 v56, v48, v49
    v_cvt_pk_bf16_f32 v57, v50, v51
    v_mfma_f32_32x32x16_bf16 v[96:111], v[36:39], v[244:247], v[96:111]
    ds_read_b64_tr_b16 v[28:29], v3 offset:192
    ds_read_b64_tr_b16 v[30:31], v3 offset:2752
    v_cvt_pk_bf16_f32 v58, v52, v53
    v_cvt_pk_bf16_f32 v59, v54, v55
    s_waitcnt lgkmcnt(8)
    v_mfma_f32_32x32x16_bf16 v[96:111], v[40:43], v[248:251], v[96:111]
    ds_read_b64_tr_b16 v[32:33], v3 offset:256
    ds_read_b64_tr_b16 v[34:35], v3 offset:2816
    s_add_u32 s52, s50, 14336
    buffer_store_dwordx4 v[56:59], v11, s[24:27], s52 offen sc1
    v_mfma_f32_32x32x16_bf16 v[96:111], v[44:47], v[252:255], v[96:111]
    ds_read_b64_tr_b16 v[36:37], v3 offset:5120
    ds_read_b64_tr_b16 v[38:39], v3 offset:7680
    v_max_f32 v64, 0, v64
    v_max_f32 v65, 0, v65
    s_waitcnt vmcnt(20)
    s_mov_b64 exec, 1
    ds_add_u32 v0, v0 offset:0
    s_mov_b64 exec, -1
    s_waitcnt lgkmcnt(9)
    v_mfma_f32_32x32x16_bf16 v[176:191], v[16:19], v[112:115], 0
    ds_read_b64_tr_b16 v[40:41], v3 offset:5184
    ds_read_b64_tr_b16 v[42:43], v3 offset:7744
    v_max_f32 v66, 0, v66
    v_max_f32 v67, 0, v67
    v_max_f32 v68, 0, v68
    v_mfma_f32_32x32x16_bf16 v[192:207], v[20:23], v[112:115], 0
    ds_read_b64_tr_b16 v[44:45], v3 offset:5248
    ds_read_b64_tr_b16 v[46:47], v3 offset:7808
    v_max_f32 v69, 0, v69
    v_max_f32 v70, 0, v70
    v_max_f32 v71, 0, v71
    s_waitcnt lgkmcnt(9)
    v_mfma_f32_32x32x16_bf16 v[208:223], v[24:27], v[112:115], 0
    ds_read_b64_tr_b16 v[16:17], v3 offset:5312
    ds_read_b64_tr_b16 v[18:19], v3 offset:7872
    v_mul_f32 v64, v64, v72
    v_mul_f32 v65, v65, v73
    v_mul_f32 v66, v66, v74
    v_mfma_f32_32x32x16_bf16 v[224:239], v[28:31], v[112:115], 0
    ds_read_b64_tr_b16 v[20:21], v3 offset:5376
    ds_read_b64_tr_b16 v[22:23], v3 offset:7936
    v_mul_f32 v67, v67, v75
    v_mul_f32 v68, v68, v76
    v_mul_f32 v69, v69, v77
    s_waitcnt lgkmcnt(9)
    v_mfma_f32_32x32x16_bf16 v[240:255], v[32:35], v[112:115], 0
    ds_read_b64_tr_b16 v[24:25], v3 offset:10240
    ds_read_b64_tr_b16 v[26:27], v3 offset:12800
    v_mul_f32 v70, v70, v78
    v_mul_f32 v71, v71, v79
    v_cvt_pk_bf16_f32 v72, v64, v65
    v_mfma_f32_32x32x16_bf16 v[176:191], v[36:39], v[116:119], v[176:191]
    ds_read_b64_tr_b16 v[28:29], v3 offset:10304
    ds_read_b64_tr_b16 v[30:31], v3 offset:12864
    v_cvt_pk_bf16_f32 v73, v66, v67
    v_cvt_pk_bf16_f32 v74, v68, v69
    v_cvt_pk_bf16_f32 v75, v70, v71
    s_waitcnt lgkmcnt(8)
    v_mfma_f32_32x32x16_bf16 v[192:207], v[40:43], v[116:119], v[192:207]
    ds_read_b64_tr_b16 v[32:33], v3 offset:10368
    ds_read_b64_tr_b16 v[34:35], v3 offset:12928
    s_add_u32 s52, s50, 15360
    buffer_store_dwordx4 v[72:75], v11, s[24:27], s52 offen sc1
    v_max_f32 v80, 0, v80
    v_mfma_f32_32x32x16_bf16 v[208:223], v[44:47], v[116:119], v[208:223]
    ds_read_b64_tr_b16 v[36:37], v3 offset:10432
    ds_read_b64_tr_b16 v[38:39], v3 offset:12992
    v_max_f32 v81, 0, v81
    v_max_f32 v82, 0, v82
    v_max_f32 v83, 0, v83
    s_waitcnt lgkmcnt(8)
    v_mfma_f32_32x32x16_bf16 v[224:239], v[16:19], v[116:119], v[224:239]
    ds_read_b64_tr_b16 v[40:41], v3 offset:10496
    ds_read_b64_tr_b16 v[42:43], v3 offset:13056
    v_max_f32 v84, 0, v84
    v_max_f32 v85, 0, v85
    v_max_f32 v86, 0, v86
    v_mfma_f32_32x32x16_bf16 v[240:255], v[20:23], v[116:119], v[240:255]
    ds_read_b64_tr_b16 v[44:45], v3 offset:15360
    ds_read_b64_tr_b16 v[46:47], v3 offset:17920
    v_max_f32 v87, 0, v87
    v_mul_f32 v80, v80, v88
    v_mul_f32 v81, v81, v89
    s_waitcnt lgkmcnt(8)
    v_mfma_f32_32x32x16_bf16 v[176:191], v[24:27], v[120:123], v[176:191]
    ds_read_b32 v15, v0 offset:0
    ds_read_b64_tr_b16 v[16:17], v3 offset:15424
    ds_read_b64_tr_b16 v[18:19], v3 offset:17984
    v_mul_f32 v82, v82, v90
    v_mul_f32 v83, v83, v91
    v_mul_f32 v84, v84, v92
    v_mfma_f32_32x32x16_bf16 v[192:207], v[28:31], v[120:123], v[192:207]
    ds_read_b64_tr_b16 v[20:21], v3 offset:15488
    ds_read_b64_tr_b16 v[22:23], v3 offset:18048
    v_mul_f32 v85, v85, v93
    v_mul_f32 v86, v86, v94
    v_mul_f32 v87, v87, v95
    s_waitcnt lgkmcnt(9)
    v_mfma_f32_32x32x16_bf16 v[208:223], v[32:35], v[120:123], v[208:223]
    ds_read_b64_tr_b16 v[24:25], v3 offset:15552
    ds_read_b64_tr_b16 v[26:27], v3 offset:18112
    v_cvt_pk_bf16_f32 v88, v80, v81
    v_cvt_pk_bf16_f32 v89, v82, v83
    v_cvt_pk_bf16_f32 v90, v84, v85
    v_mfma_f32_32x32x16_bf16 v[224:239], v[36:39], v[120:123], v[224:239]
    s_waitcnt lgkmcnt(6)
L_cg45:
    v_cmp_gt_u32 vcc, 720, v15
    s_cbranch_vccz L_cg45_ok
    s_add_u32 s3, s3, 1
    s_cmp_ge_u32 s3, 0x400000
    s_cbranch_scc1 L_cg45_ok
    ds_read_b32 v15, v0 offset:0
    s_waitcnt lgkmcnt(0)
    s_branch L_cg45
L_cg45_ok:
    ds_read_b64_tr_b16 v[28:29], v3 offset:15616
    ds_read_b64_tr_b16 v[30:31], v3 offset:18176
    v_cvt_pk_bf16_f32 v91, v86, v87
    s_add_u32 s52, s50, 16384
    buffer_store_dwordx4 v[88:91], v11, s[24:27], s52 offen sc1
    v_mfma_f32_32x32x16_bf16 v[240:255], v[40:43], v[120:123], v[240:255]
    ds_read_b64_tr_b16 v[32:33], v3 offset:20480
    ds_read_b64_tr_b16 v[34:35], v3 offset:23040
    v_max_f32 v96, 0, v96
    v_max_f32 v97, 0, v97
    v_max_f32 v98, 0, v98
    v_mfma_f32_32x32x16_bf16 v[176:191], v[44:47], v[124:127], v[176:191]
    ds_read_b64_tr_b16 v[36:37], v3 offset:20544
    ds_read_b64_tr_b16 v[38:39], v3 offset:23104
    v_max_f32 v99, 0, v99
    v_max_f32 v100, 0, v100
    v_max_f32 v101, 0, v101
    s_waitcnt lgkmcnt(8)
    v_mfma_f32_32x32x16_bf16 v[192:207], v[16:19], v[124:127], v[192:207]
    ds_read_b64_tr_b16 v[40:41], v3 offset:20608
    ds_read_b64_tr_b16 v[42:43], v3 offset:23168
    v_max_f32 v102, 0, v102
    v_max_f32 v103, 0, v103
    v_mul_f32 v96, v96, v104
    v_mfma_f32_32x32x16_bf16 v[208:223], v[20:23], v[124:127], v[208:223]
    ds_read_b64_tr_b16 v[44:45], v3 offset:20672
    ds_read_b64_tr_b16 v[46:47], v3 offset:23232
    v_mul_f32 v97, v97, v105
    v_mul_f32 v98, v98, v106
    v_mul_f32 v99, v99, v107
    s_waitcnt lgkmcnt(8)
    v_mfma_f32_32x32x16_bf16 v[224:239], v[24:27], v[124:127], v[224:239]
    ds_read_b64_tr_b16 v[16:17], v3 offset:20736
    ds_read_b64_tr_b16 v[18:19], v3 offset:23296
    v_mul_f32 v100, v100, v108
    v_mul_f32 v101, v101, v109
    v_mul_f32 v102, v102, v110
    v_mfma_f32_32x32x16_bf16 v[240:255], v[28:31], v[124:127], v[240:255]
    ds_read_b64_tr_b16 v[20:21], v3 offset:25600
    ds_read_b64_tr_b16 v[22:23], v3 offset:28160
    v_mul_f32 v103, v103, v111
    v_cvt_pk_bf16_f32 v104, v96, v97
    v_cvt_pk_bf16_f32 v105, v98, v99
    s_add_u32 s42, s65, 36864
    s_add_u32 s43, s65, 73728
    s_cmp_lt_u32 s36, 2
    s_cselect_b32 s43, s42, s43
    s_add_u32 m0, s63, 20480
    s_nop 0
    buffer_load_dwordx4 v6, s[8:11], s43 offen offset:0 lds
    buffer_load_dwordx4 v7, s[8:11], s43 offen offset:1024 lds
    buffer_load_dwordx4 v8, s[8:11], s43 offen offset:2048 lds
    buffer_load_dwordx4 v9, s[8:11], s43 offen offset:3072 lds
    s_add_u32 m0, s63, 24576
    s_nop 0
    buffer_load_dwordx4 v10, s[8:11], s43 offen offset:0 lds
    s_waitcnt vmcnt(18)
    s_waitcnt vmcnt(8)
    s_cmp_lg_u32 s36, 0
    s_cbranch_scc1 L_h_ok
L_h_chk:
    v_cmp_ne_u32 s[40:41], s60, v13
    v_cmp_ne_u32 vcc, s61, v13
    s_nop 0
    s_and_b32 s40, s40, 0x0f
    s_and_b32 s41, vcc_lo, 0xf0
    s_or_b32 s40, s40, s41
    s_cbranch_scc0 L_h_ok
    s_add_u32 s3, s3, 16
    s_cmp_ge_u32 s3, 0x400000
    s_cbranch_scc1 L_h_ok
    s_sleep 4
    buffer_load_dword v13, v14, s[28:31], s44 offen offset:0 sc1
    s_waitcnt vmcnt(0)
    s_branch L_h_chk
L_h_ok:
    s_mov_b64 exec, 1
    ds_add_u32 v0, v0 offset:0
    s_mov_b64 exec, -1
    s_waitcnt lgkmcnt(9)
    v_mfma_f32_32x32x16_bf16 v[176:191], v[32:35], v[128:131], v[176:191]
    ds_read_b64_tr_b16 v[24:25], v3 offset:25664
    ds_read_b64_tr_b16 v[26:27], v3 offset:28224
    v_cvt_pk_bf16_f32 v106, v100, v101
    v_cvt_pk_bf16_f32 v107, v102, v103
    s_add_u32 s52, s50, 17408
    v_mfma_f32_32x32x16_bf16 v[192:207], v[36:39], v[128:131], v[192:207]
    ds_read_b64_tr_b16 v[28:29], v3 offset:25728
    ds_read_b64_tr_b16 v[30:31], v3 offset:28288
    buffer_store_dwordx4 v[104:107], v11, s[24:27], s52 offen sc1
    s_waitcnt lgkmcnt(9)
    s_setprio 0
    v_mfma_f32_32x32x16_bf16 v[208:223], v[40:43], v[128:131], v[208:223]
    ds_read_b64_tr_b16 v[32:33], v3 offset:25792
    ds_read_b64_tr_b16 v[34:35], v3 offset:28352
    v_mfma_f32_32x32x16_bf16 v[224:239], v[44:47], v[128:131], v[224:239]
    ds_read_b64_tr_b16 v[36:37], v3 offset:25856
    ds_read_b64_tr_b16 v[38:39], v3 offset:28416
    s_waitcnt lgkmcnt(9)
    s_setprio 2
    v_mfma_f32_32x32x16_bf16 v[240:255], v[16:19], v[128:131], v[240:255]
    s_setprio 0
    ds_read_b64_tr_b16 v[40:41], v3 offset:30720
    ds_read_b64_tr_b16 v[42:43], v3 offset:33280
    v_mfma_f32_32x32x16_bf16 v[176:191], v[20:23], v[132:135], v[176:191]
    ds_read_b64_tr_b16 v[44:45], v3 offset:30784
    ds_read_b64_tr_b16 v[46:47], v3 offset:33344
    s_waitcnt lgkmcnt(8)
    v_mfma_f32_32x32x16_bf16 v[192:207], v[24:27], v[132:135], v[192:207]
    ds_read_b64_tr_b16 v[16:17], v3 offset:30848
    ds_read_b64_tr_b16 v[18:19], v3 offset:33408
    s_setprio 2
    v_mfma_f32_32x32x16_bf16 v[208:223], v[28:31], v[132:135], v[208:223]
    s_setprio 0
    ds_read_b64_tr_b16 v[20:21], v3 offset:30912
    ds_read_b64_tr_b16 v[22:23], v3 offset:33472
    s_waitcnt lgkmcnt(8)
    v_mfma_f32_32x32x16_bf16 v[224:239], v[32:35], v[132:135], v[224:239]
    ds_read_b64_tr_b16 v[24:25], v3 offset:30976
    ds_read_b64_tr_b16 v[26:27], v3 offset:33536
    v_mfma_f32_32x32x16_bf16 v[240:255], v[36:39], v[132:135], v[240:255]
    ds_read_b64_tr_b16 v[28:29], v3 offset:35840
    ds_read_b64_tr_b16 v[30:31], v3 offset:38400
    s_waitcnt lgkmcnt(8)
    s_setprio 2
    v_mfma_f32_32x32x16_bf16 v[176:191], v[40:43], v[136:139], v[176:191]
    s_setprio 0
    ds_read_b32 v15, v0 offset:0
    ds_read_b64_tr_b16 v[32:33], v3 offset:35904
    ds_read_b64_tr_b16 v[34:35], v3 offset:38464
    v_mfma_f32_32x32x16_bf16 v[192:207], v[44:47], v[136:139], v[192:207]
    ds_read_b64_tr_b16 v[36:37], v3 offset:35968
    ds_read_b64_tr_b16 v[38:39], v3 offset:38528
    s_waitcnt lgkmcnt(9)
    v_mfma_f32_32x32x16_bf16 v[208:223], v[16:19], v[136:139], v[208:223]
    ds_read_b64_tr_b16 v[40:41], v3 offset:36032
    ds_read_b64_tr_b16 v[42:43], v3 offset:38592
    s_setprio 2
    v_mfma_f32_32x32x16_bf16 v[224:239], v[20:23], v[136:139], v[224:239]
    s_setprio 0
    s_setprio 2
    s_waitcnt lgkmcnt(6)
L_cg46:
    v_cmp_gt_u32 vcc, 736, v15
    s_cbranch_vccz L_cg46_ok
    s_add_u32 s3, s3, 1
    s_cmp_ge_u32 s3, 0x400000
    s_cbranch_scc1 L_cg46_ok
    ds_read_b32 v15, v0 offset:0
    s_waitcnt lgkmcnt(0)
    s_branch L_cg46
L_cg46_ok:
    s_setprio 0
    ds_read_b64_tr_b16 v[44:45], v3 offset:36096
    ds_read_b64_tr_b16 v[46:47], v3 offset:38656
    s_add_u32 s42, s65, 110592
    s_add_u32 s43, s65, 147456
    s_cmp_lt_u32 s36, 2
    s_cselect_b32 s43, s42, s43
    s_add_u32 m0, s63, 49152
    s_nop 0
    buffer_load_dwordx4 v6, s[8:11], s43 offen offset:0 lds
    buffer_load_dwordx4 v7, s[8:11], s43 offen offset:1024 lds
    v_mfma_f32_32x32x16_bf16 v[240:255], v[24:27], v[136:139], v[240:255]
    ds_read_b64_tr_b16 v[16:17], v3 offset:40960
    ds_read_b64_tr_b16 v[18:19], v3 offset:43520
    buffer_load_dwordx4 v8, s[8:11], s43 offen offset:2048 lds
    buffer_load_dwordx4 v9, s[8:11], s43 offen offset:3072 lds
    s_add_u32 m0, s63, 53248
    s_nop 0
    buffer_load_dwordx4 v10, s[8:11], s43 offen offset:0 lds
    v_mfma_f32_32x32x16_bf16 v[176:191], v[28:31], v[140:143], v[176:191]
    ds_read_b64_tr_b16 v[20:21], v3 offset:41024
    ds_read_b64_tr_b16 v[22:23], v3 offset:43584
    s_add_u32 s42, s77, 0
    buffer_load_dwordx4 v[168:171], v11, s[24:27], s42 offen sc1
    buffer_load_dwordx4 v[172:175], v11, s[24:27], s42 offen offset:1024 sc1
    s_waitcnt lgkmcnt(8)
    s_setprio 2
    v_mfma_f32_32x32x16_bf16 v[192:207], v[32:35], v[140:143], v[192:207]
    s_setprio 0
    ds_read_b64_tr_b16 v[24:25], v3 offset:41088
    ds_read_b64_tr_b16 v[26:27], v3 offset:43648
    s_add_u32 s42, s77, 2048
    buffer_load_dwordx4 v[112:115], v11, s[24:27], s42 offen sc1
    buffer_load_dwordx4 v[116:119], v11, s[24:27], s42 offen offset:1024 sc1
    v_mfma_f32_32x32x16_bf16 v[208:223], v[36:39], v[140:143], v[208:223]
    ds_read_b64_tr_b16 v[28:29], v3 offset:41152
    ds_read_b64_tr_b16 v[30:31], v3 offset:43712
    s_add_u32 s42, s77, 4096
    buffer_load_dwordx4 v[120:123], v11, s[24:27], s42 offen sc1
    buffer_load_dwordx4 v[124:127], v11, s[24:27], s42 offen offset:1024 sc1
    s_waitcnt lgkmcnt(8)
    v_mfma_f32_32x32x16_bf16 v[224:239], v[40:43], v[140:143], v[224:239]
    ds_read_b64_tr_b16 v[32:33], v3 offset:41216
    ds_read_b64_tr_b16 v[34:35], v3 offset:43776
    s_add_u32 s42, s77, 6144
    buffer_load_dwordx4 v[128:131], v11, s[24:27], s42 offen sc1
    buffer_load_dwordx4 v[132:135], v11, s[24:27], s42 offen offset:1024 sc1
    s_setprio 2
    v_mfma_f32_32x32x16_bf16 v[240:255], v[44:47], v[140:143], v[240:255]
    s_setprio 0
    ds_read_b64_tr_b16 v[36:37], v3 offset:46080
    ds_read_b64_tr_b16 v[38:39], v3 offset:48640
    v_mov_b32 v48, -1
    v_mov_b32 v49, -1
    v_mov_b32 v50, -1
    v_mov_b32 v51, -1
    buffer_store_dwordx4 v[48:51], v11, s[28:31], s57 offen sc1
    s_add_u32 s57, s57, 1024
    s_mov_b64 exec, 1
    ds_add_u32 v0, v0 offset:0
    s_mov_b64 exec, -1
    s_waitcnt lgkmcnt(9)
    v_mfma_f32_32x32x16_bf16 v[176:191], v[16:19], v[144:147], v[176:191]
    ds_read_b64_tr_b16 v[40:41], v3 offset:46144
    ds_read_b64_tr_b16 v[42:43], v3 offset:48704
    s_add_u32 s42, s77, 8192
    buffer_load_dwordx4 v[136:139], v11, s[24:27], s42 offen sc1
    buffer_load_dwordx4 v[140:143], v11, s[24:27], s42 offen offset:1024 sc1
    v_mfma_f32_32x32x16_bf16 v[192:207], v[20:23], v[144:147], v[192:207]
    ds_read_b64_tr_b16 v[44:45], v3 offset:46208
    ds_read_b64_tr_b16 v[46:47], v3 offset:48768
    s_waitcnt lgkmcnt(9)
    s_setprio 2
    v_mfma_f32_32x32x16_bf16 v[208:223], v[24:27], v[144:147], v[208:223]
    s_setprio 0
    ds_read_b64_tr_b16 v[16:17], v3 offset:46272
    ds_read_b64_tr_b16 v[18:19], v3 offset:48832
    v_mfma_f32_32x32x16_bf16 v[224:239], v[28:31], v[144:147], v[224:239]
    ds_read_b64_tr_b16 v[20:21], v3 offset:46336
    ds_read_b64_tr_b16 v[22:23], v3 offset:48896
    s_waitcnt lgkmcnt(9)
    v_mfma_f32_32x32x16_bf16 v[240:255], v[32:35], v[144:147], v[240:255]
    ds_read_b64_tr_b16 v[24:25], v3 offset:51200
    ds_read_b64_tr_b16 v[26:27], v3 offset:53760
    s_setprio 2
    v_mfma_f32_32x32x16_bf16 v[176:191], v[36:39], v[148:151], v[176:191]
    s_setprio 0
    ds_read_b64_tr_b16 v[28:29], v3 offset:51264
    ds_read_b64_tr_b16 v[30:31], v3 offset:53824
    s_waitcnt lgkmcnt(8)
    v_mfma_f32_32x32x16_bf16 v[192:207], v[40:43], v[148:151], v[192:207]
    ds_read_b64_tr_b16 v[32:33], v3 offset:51328
    ds_read_b64_tr_b16 v[34:35], v3 offset:53888
    v_mfma_f32_32x32x16_bf16 v[208:223], v[44:47], v[148:151], v[208:223]
    ds_read_b64_tr_b16 v[36:37], v3 offset:51392
    ds_read_b64_tr_b16 v[38:39], v3 offset:53952
    s_waitcnt lgkmcnt(8)
    s_setprio 2
    v_mfma_f32_32x32x16_bf16 v[224:239], v[16:19], v[148:151], v[224:239]
    s_setprio 0
    ds_read_b64_tr_b16 v[40:41], v3 offset:51456
    ds_read_b64_tr_b16 v[42:43], v3 offset:54016
    v_mfma_f32_32x32x16_bf16 v[240:255], v[20:23], v[148:151], v[240:255]
    ds_read_b64_tr_b16 v[44:45], v3 offset:56320
    ds_read_b64_tr_b16 v[46:47], v3 offset:58880
    s_waitcnt lgkmcnt(8)
    v_mfma_f32_32x32x16_bf16 v[176:191], v[24:27], v[152:155], v[176:191]
    ds_read_b32 v15, v0 offset:0
    ds_read_b64_tr_b16 v[16:17], v3 offset:56384
    ds_read_b64_tr_b16 v[18:19], v3 offset:58944
    s_add_u32 s42, s77, 10240
    buffer_load_dwordx4 v[144:147], v11, s[24:27], s42 offen sc1
    buffer_load_dwordx4 v[148:151], v11, s[24:27], s42 offen offset:1024 sc1
    s_setprio 2
    v_mfma_f32_32x32x16_bf16 v[192:207], v[28:31], v[152:155], v[192:207]
    s_setprio 0
    ds_read_b64_tr_b16 v[20:21], v3 offset:56448
    ds_read_b64_tr_b16 v[22:23], v3 offset:59008
    s_waitcnt lgkmcnt(9)
    v_mfma_f32_32x32x16_bf16 v[208:223], v[32:35], v[152:155], v[208:223]
    ds_read_b64_tr_b16 v[24:25], v3 offset:56512
    ds_read_b64_tr_b16 v[26:27], v3 offset:59072
    v_mfma_f32_32x32x16_bf16 v[224:239], v[36:39], v[152:155], v[224:239]
    s_setprio 2
    s_waitcnt lgkmcnt(6)
L_cg47:
    v_cmp_gt_u32 vcc, 752, v15
    s_cbranch_vccz L_cg47_ok
    s_add_u32 s3, s3, 1
    s_cmp_ge_u32 s3, 0x400000
    s_cbranch_scc1 L_cg47_ok
    ds_read_b32 v15, v0 offset:0
    s_waitcnt lgkmcnt(0)
    s_branch L_cg47
L_cg47_ok:
    s_setprio 0
    ds_read_b64_tr_b16 v[28:29], v3 offset:56576
    ds_read_b64_tr_b16 v[30:31], v3 offset:59136
    s_add_u32 s42, s65, 184320
    s_add_u32 s43, s65, 221184
    s_cmp_lt_u32 s36, 2
    s_cselect_b32 s43, s42, s43
    s_add_u32 m0, s63, 69632
    s_nop 0
    buffer_load_dwordx4 v6, s[8:11], s43 offen offset:0 lds
    buffer_load_dwordx4 v7, s[8:11], s43 offen offset:1024 lds
    s_setprio 2
    v_mfma_f32_32x32x16_bf16 v[240:255], v[40:43], v[152:155], v[240:255]
    s_setprio 0
    ds_read_b64_tr_b16 v[32:33], v2 offset:0
    ds_read_b64_tr_b16 v[34:35], v2 offset:2560
    buffer_load_dwordx4 v8, s[8:11], s43 offen offset:2048 lds
    buffer_load_dwordx4 v9, s[8:11], s43 offen offset:3072 lds
    s_add_u32 m0, s63, 73728
    s_nop 0
    buffer_load_dwordx4 v10, s[8:11], s43 offen offset:0 lds
    v_mfma_f32_32x32x16_bf16 v[176:191], v[44:47], v[156:159], v[176:191]
    ds_read_b64_tr_b16 v[36:37], v2 offset:64
    ds_read_b64_tr_b16 v[38:39], v2 offset:2624
    buffer_store_dwordx4 v[48:51], v11, s[28:31], s57 offen sc1
    s_add_u32 s57, s57, 1024
    s_waitcnt lgkmcnt(8)
    v_mfma_f32_32x32x16_bf16 v[192:207], v[16:19], v[156:159], v[192:207]
    ds_read_b64_tr_b16 v[40:41], v2 offset:128
    ds_read_b64_tr_b16 v[42:43], v2 offset:2688
    s_setprio 2
    v_mfma_f32_32x32x16_bf16 v[208:223], v[20:23], v[156:159], v[208:223]
    s_setprio 0
    ds_read_b64_tr_b16 v[44:45], v2 offset:192
    ds_read_b64_tr_b16 v[46:47], v2 offset:2752
    s_waitcnt lgkmcnt(8)
    v_mfma_f32_32x32x16_bf16 v[224:239], v[24:27], v[156:159], v[224:239]
    ds_read_b64_tr_b16 v[16:17], v2 offset:256
    ds_read_b64_tr_b16 v[18:19], v2 offset:2816
    v_mfma_f32_32x32x16_bf16 v[240:255], v[28:31], v[156:159], v[240:255]
    ds_read_b64_tr_b16 v[20:21], v2 offset:5120
    ds_read_b64_tr_b16 v[22:23], v2 offset:7680
    s_waitcnt vmcnt(25)
    s_mov_b64 exec, 1
    ds_add_u32 v0, v0 offset:0
    s_mov_b64 exec, -1
    s_waitcnt lgkmcnt(9)
    s_setprio 2
    v_mfma_f32_32x32x16_bf16 v[176:191], v[32:35], v[160:163], v[176:191]
    s_setprio 0
    ds_read_b64_tr_b16 v[24:25], v2 offset:5184
    ds_read_b64_tr_b16 v[26:27], v2 offset:7744
    s_add_u32 s42, s77, 12288
    buffer_load_dwordx4 v[152:155], v11, s[24:27], s42 offen sc1
    buffer_load_dwordx4 v[156:159], v11, s[24:27], s42 offen offset:1024 sc1
    v_mfma_f32_32x32x16_bf16 v[192:207], v[36:39], v[160:163], v[192:207]
    ds_read_b64_tr_b16 v[28:29], v2 offset:5248
    ds_read_b64_tr_b16 v[30:31], v2 offset:7808
    s_waitcnt lgkmcnt(9)
    v_mfma_f32_32x32x16_bf16 v[208:223], v[40:43], v[160:163], v[208:223]
    ds_read_b64_tr_b16 v[32:33], v2 offset:5312
    ds_read_b64_tr_b16 v[34:35], v2 offset:7872
    s_setprio 2
    v_mfma_f32_32x32x16_bf16 v[224:239], v[44:47], v[160:163], v[224:239]
    s_setprio 0
    ds_read_b64_tr_b16 v[36:37], v2 offset:5376
    ds_read_b64_tr_b16 v[38:39], v2 offset:7936
    s_waitcnt lgkmcnt(9)
    v_mfma_f32_32x32x16_bf16 v[240:255], v[16:19], v[160:163], v[240:255]
    ds_read_b64_tr_b16 v[40:41], v2 offset:10240
    ds_read_b64_tr_b16 v[42:43], v2 offset:12800
    v_mfma_f32_32x32x16_bf16 v[176:191], v[20:23], v[164:167], v[176:191]
    ds_read_b64_tr_b16 v[44:45], v2 offset:10304
    ds_read_b64_tr_b16 v[46:47], v2 offset:12864
    s_waitcnt lgkmcnt(8)
    s_setprio 2
    v_mfma_f32_32x32x16_bf16 v[192:207], v[24:27], v[164:167], v[192:207]
    s_setprio 0
    ds_read_b64_tr_b16 v[16:17], v2 offset:10368
    ds_read_b64_tr_b16 v[18:19], v2 offset:12928
    v_mfma_f32_32x32x16_bf16 v[208:223], v[28:31], v[164:167], v[208:223]
    ds_read_b64_tr_b16 v[20:21], v2 offset:10432
    ds_read_b64_tr_b16 v[22:23], v2 offset:12992
    s_waitcnt lgkmcnt(8)
    v_mfma_f32_32x32x16_bf16 v[224:239], v[32:35], v[164:167], v[224:239]
    ds_read_b64_tr_b16 v[24:25], v2 offset:10496
    ds_read_b64_tr_b16 v[26:27], v2 offset:13056
    s_setprio 2
    v_mfma_f32_32x32x16_bf16 v[240:255], v[36:39], v[164:167], v[240:255]
    s_setprio 0
    ds_read_b64_tr_b16 v[28:29], v2 offset:15360
    ds_read_b64_tr_b16 v[30:31], v2 offset:17920
    s_waitcnt vmcnt(19)
    s_waitcnt lgkmcnt(8)
    v_mfma_f32_32x32x16_bf16 v[176:191], v[40:43], v[168:171], v[176:191]
    ds_read_b32 v15, v0 offset:0
    ds_read_b64_tr_b16 v[32:33], v2 offset:15424
    ds_read_b64_tr_b16 v[34:35], v2 offset:17984
    s_add_u32 s42, s78, 0
    buffer_load_dwordx4 v[160:163], v11, s[24:27], s42 offen sc1
    buffer_load_dwordx4 v[164:167], v11, s[24:27], s42 offen offset:1024 sc1
    v_mfma_f32_32x32x16_bf16 v[192:207], v[44:47], v[168:171], v[192:207]
    ds_read_b64_tr_b16 v[36:37], v2 offset:15488
    ds_read_b64_tr_b16 v[38:39], v2 offset:18048
    s_waitcnt lgkmcnt(9)
    s_setprio 2
    v_mfma_f32_32x32x16_bf16 v[208:223], v[16:19], v[168:171], v[208:223]
    s_setprio 0
    ds_read_b64_tr_b16 v[40:41], v2 offset:15552
    ds_read_b64_tr_b16 v[42:43], v2 offset:18112
    v_mfma_f32_32x32x16_bf16 v[224:239], v[20:23], v[168:171], v[224:239]
    s_setprio 2
    s_waitcnt lgkmcnt(6)
L_cg48:
    v_cmp_gt_u32 vcc, 768, v15
    s_cbranch_vccz L_cg48_ok
    s_add_u32 s3, s3, 1
    s_cmp_ge_u32 s3, 0x400000
    s_cbranch_scc1 L_cg48_ok
    ds_read_b32 v15, v0 offset:0
    s_waitcnt lgkmcnt(0)
    s_branch L_cg48
L_cg48_ok:
    s_setprio 0
    ds_read_b64_tr_b16 v[44:45], v2 offset:15616
    ds_read_b64_tr_b16 v[46:47], v2 offset:18176
    s_mov_b32 s42, s70
    s_add_u32 s43, s66, 36864
    s_cmp_lt_u32 s36, 2
    s_cselect_b32 s43, s42, s43
    s_add_u32 m0, s63, 90112
    s_nop 0
    buffer_load_dwordx4 v6, s[8:11], s43 offen offset:0 lds
    buffer_load_dwordx4 v7, s[8:11], s43 offen offset:1024 lds
    v_mfma_f32_32x32x16_bf16 v[240:255], v[24:27], v[168:171], v[240:255]
    ds_read_b64_tr_b16 v[16:17], v2 offset:20480
    ds_read_b64_tr_b16 v[18:19], v2 offset:23040
    buffer_load_dwordx4 v8, s[8:11], s43 offen offset:2048 lds
    buffer_load_dwordx4 v9, s[8:11], s43 offen offset:3072 lds
    s_add_u32 m0, s63, 94208
    s_nop 0
    buffer_load_dwordx4 v10, s[8:11], s43 offen offset:0 lds
    s_setprio 2
    v_mfma_f32_32x32x16_bf16 v[176:191], v[28:31], v[172:175], v[176:191]
    s_setprio 0
    ds_read_b64_tr_b16 v[20:21], v2 offset:20544
    ds_read_b64_tr_b16 v[22:23], v2 offset:23104
    buffer_store_dwordx4 v[48:51], v11, s[28:31], s57 offen sc1
    s_add_u32 s57, s57, 1024
    s_waitcnt lgkmcnt(8)
    v_mfma_f32_32x32x16_bf16 v[192:207], v[32:35], v[172:175], v[192:207]
    ds_read_b64_tr_b16 v[24:25], v2 offset:20608
    ds_read_b64_tr_b16 v[26:27], v2 offset:23168
    v_mfma_f32_32x32x16_bf16 v[208:223], v[36:39], v[172:175], v[208:223]
    ds_read_b64_tr_b16 v[28:29], v2 offset:20672
    ds_read_b64_tr_b16 v[30:31], v2 offset:23232
    s_waitcnt lgkmcnt(8)
    s_setprio 2
    v_mfma_f32_32x32x16_bf16 v[224:239], v[40:43], v[172:175], v[224:239]
    s_setprio 0
    ds_read_b64_tr_b16 v[32:33], v2 offset:20736
    ds_read_b64_tr_b16 v[34:35], v2 offset:23296
    v_mfma_f32_32x32x16_bf16 v[240:255], v[44:47], v[172:175], v[240:255]
    ds_read_b64_tr_b16 v[36:37], v2 offset:25600
    ds_read_b64_tr_b16 v[38:39], v2 offset:28160
    s_mov_b64 exec, 1
    ds_add_u32 v0, v0 offset:0
    s_mov_b64 exec, -1
    s_waitcnt vmcnt(25)
    s_waitcnt lgkmcnt(9)
    v_mfma_f32_32x32x16_bf16 v[176:191], v[16:19], v[112:115], v[176:191]
    ds_read_b64_tr_b16 v[40:41], v2 offset:25664
    ds_read_b64_tr_b16 v[42:43], v2 offset:28224
    s_add_u32 s42, s78, 2048
    buffer_load_dwordx4 v[168:171], v11, s[24:27], s42 offen sc1
    buffer_load_dwordx4 v[172:175], v11, s[24:27], s42 offen offset:1024 sc1
    s_setprio 2
    v_mfma_f32_32x32x16_bf16 v[192:207], v[20:23], v[112:115], v[192:207]
    s_setprio 0
    ds_read_b64_tr_b16 v[44:45], v2 offset:25728
    ds_read_b64_tr_b16 v[46:47], v2 offset:28288
    s_waitcnt lgkmcnt(9)
    v_mfma_f32_32x32x16_bf16 v[208:223], v[24:27], v[112:115], v[208:223]
    ds_read_b64_tr_b16 v[16:17], v2 offset:25792
    ds_read_b64_tr_b16 v[18:19], v2 offset:28352
    v_mfma_f32_32x32x16_bf16 v[224:239], v[28:31], v[112:115], v[224:239]
    ds_read_b64_tr_b16 v[20:21], v2 offset:25856
    ds_read_b64_tr_b16 v[22:23], v2 offset:28416
    s_waitcnt lgkmcnt(9)
    s_setprio 2
    v_mfma_f32_32x32x16_bf16 v[240:255], v[32:35], v[112:115], v[240:255]
    s_setprio 0
    ds_read_b64_tr_b16 v[24:25], v2 offset:30720
    ds_read_b64_tr_b16 v[26:27], v2 offset:33280
    v_mfma_f32_32x32x16_bf16 v[176:191], v[36:39], v[116:119], v[176:191]
    ds_read_b64_tr_b16 v[28:29], v2 offset:30784
    ds_read_b64_tr_b16 v[30:31], v2 offset:33344
    s_waitcnt lgkmcnt(8)
    v_mfma_f32_32x32x16_bf16 v[192:207], v[40:43], v[116:119], v[192:207]
    ds_read_b64_tr_b16 v[32:33], v2 offset:30848
    ds_read_b64_tr_b16 v[34:35], v2 offset:33408
    s_setprio 2
    v_mfma_f32_32x32x16_bf16 v[208:223], v[44:47], v[116:119], v[208:223]
    s_setprio 0
    ds_read_b64_tr_b16 v[36:37], v2 offset:30912
    ds_read_b64_tr_b16 v[38:39], v2 offset:33472
    s_waitcnt lgkmcnt(8)
    v_mfma_f32_32x32x16_bf16 v[224:239], v[16:19], v[116:119], v[224:239]
    ds_read_b64_tr_b16 v[40:41], v2 offset:30976
    ds_read_b64_tr_b16 v[42:43], v2 offset:33536
    v_mfma_f32_32x32x16_bf16 v[240:255], v[20:23], v[116:119], v[240:255]
    ds_read_b64_tr_b16 v[44:45], v2 offset:35840
    ds_read_b64_tr_b16 v[46:47], v2 offset:38400
    s_waitcnt vmcnt(25)
    s_waitcnt lgkmcnt(8)
    s_setprio 2
    v_mfma_f32_32x32x16_bf16 v[176:191], v[24:27], v[120:123], v[176:191]
    s_setprio 0
    ds_read_b32 v15, v0 offset:0
    ds_read_b64_tr_b16 v[16:17], v2 offset:35904
    ds_read_b64_tr_b16 v[18:19], v2 offset:38464
    s_add_u32 s42, s78, 4096
    buffer_load_dwordx4 v[112:115], v11, s[24:27], s42 offen sc1
    buffer_load_dwordx4 v[116:119], v11, s[24:27], s42 offen offset:1024 sc1
    v_mfma_f32_32x32x16_bf16 v[192:207], v[28:31], v[120:123], v[192:207]
    ds_read_b64_tr_b16 v[20:21], v2 offset:35968
    ds_read_b64_tr_b16 v[22:23], v2 offset:38528
    s_waitcnt lgkmcnt(9)
    v_mfma_f32_32x32x16_bf16 v[208:223], v[32:35], v[120:123], v[208:223]
    ds_read_b64_tr_b16 v[24:25], v2 offset:36032
    ds_read_b64_tr_b16 v[26:27], v2 offset:38592
    s_setprio 2
    v_mfma_f32_32x32x16_bf16 v[224:239], v[36:39], v[120:123], v[224:239]
    s_setprio 0
    s_setprio 2
    s_waitcnt lgkmcnt(6)
L_cg49:
    v_cmp_gt_u32 vcc, 784, v15
    s_cbranch_vccz L_cg49_ok
    s_add_u32 s3, s3, 1
    s_cmp_ge_u32 s3, 0x400000
    s_cbranch_scc1 L_cg49_ok
    ds_read_b32 v15, v0 offset:0
    s_waitcnt lgkmcnt(0)
    s_branch L_cg49
L_cg49_ok:
    s_setprio 0
    s_setprio 2
    s_cmp_lg_u32 s36, 0
    s_cbranch_scc1 L_g_nohp49
    s_add_u32 s46, s46, 32
    v_mov_b32 v13, s61
    v_mov_b32 v14, s60
    v_cmp_gt_u32 vcc, 4, v1
    s_nop 1
    v_cndmask_b32 v14, v13, v14, vcc
    v_mul_u32_u24 v13, 128, v1
    s_mov_b64 exec, 0xf0
    v_subrev_u32 v13, 496, v13
    s_mov_b64 exec, 0xff
    buffer_store_dword v14, v13, s[28:31], s46 offen sc1
    s_mov_b64 exec, -1
L_g_nohp49:
    ds_read_b64_tr_b16 v[28:29], v2 offset:36096
    ds_read_b64_tr_b16 v[30:31], v2 offset:38656
    s_add_u32 s42, s66, 73728
    s_add_u32 s43, s66, 110592
    s_cmp_lt_u32 s36, 2
    s_cselect_b32 s43, s42, s43
    s_add_u32 m0, s63, 0
    s_nop 0
    buffer_load_dwordx4 v6, s[8:11], s43 offen offset:0 lds
    buffer_load_dwordx4 v7, s[8:11], s43 offen offset:1024 lds
    s_setprio 0
    v_mfma_f32_32x32x16_bf16 v[240:255], v[40:43], v[120:123], v[240:255]
    ds_read_b64_tr_b16 v[32:33], v3 offset:0
    ds_read_b64_tr_b16 v[34:35], v3 offset:2560
    buffer_load_dwordx4 v8, s[8:11], s43 offen offset:2048 lds
    buffer_load_dwordx4 v9, s[8:11], s43 offen offset:3072 lds
    s_add_u32 m0, s63, 4096
    s_nop 0
    buffer_load_dwordx4 v10, s[8:11], s43 offen offset:0 lds
    v_mfma_f32_32x32x16_bf16 v[176:191], v[44:47], v[124:127], v[176:191]
    ds_read_b64_tr_b16 v[36:37], v3 offset:64
    ds_read_b64_tr_b16 v[38:39], v3 offset:2624
    buffer_store_dwordx4 v[48:51], v11, s[28:31], s57 offen sc1
    s_add_u32 s57, s57, 1024
    s_waitcnt lgkmcnt(8)
    s_setprio 2
    v_mfma_f32_32x32x16_bf16 v[192:207], v[16:19], v[124:127], v[192:207]
    s_setprio 0
    ds_read_b64_tr_b16 v[40:41], v3 offset:128
    ds_read_b64_tr_b16 v[42:43], v3 offset:2688
    v_mfma_f32_32x32x16_bf16 v[208:223], v[20:23], v[124:127], v[208:223]
    ds_read_b64_tr_b16 v[44:45], v3 offset:192
    ds_read_b64_tr_b16 v[46:47], v3 offset:2752
    s_waitcnt lgkmcnt(8)
    v_mfma_f32_32x32x16_bf16 v[224:239], v[24:27], v[124:127], v[224:239]
    ds_read_b64_tr_b16 v[16:17], v3 offset:256
    ds_read_b64_tr_b16 v[18:19], v3 offset:2816
    s_setprio 2
    v_mfma_f32_32x32x16_bf16 v[240:255], v[28:31], v[124:127], v[240:255]
    s_setprio 0
    ds_read_b64_tr_b16 v[20:21], v3 offset:5120
    ds_read_b64_tr_b16 v[22:23], v3 offset:7680
    s_waitcnt vmcnt(21)
    s_mov_b64 exec, 1
    ds_add_u32 v0, v0 offset:0
    s_mov_b64 exec, -1
    s_waitcnt lgkmcnt(9)
    v_mfma_f32_32x32x16_bf16 v[176:191], v[32:35], v[128:131], v[176:191]
    ds_read_b64_tr_b16 v[24:25], v3 offset:5184
    ds_read_b64_tr_b16 v[26:27], v3 offset:7744
    s_add_u32 s42, s78, 6144
    buffer_load_dwordx4 v[120:123], v11, s[24:27], s42 offen sc1
    buffer_load_dwordx4 v[124:127], v11, s[24:27], s42 offen offset:1024 sc1
    v_mfma_f32_32x32x16_bf16 v[192:207], v[36:39], v[128:131], v[192:207]
    ds_read_b64_tr_b16 v[28:29], v3 offset:5248
    ds_read_b64_tr_b16 v[30:31], v3 offset:7808
    s_waitcnt lgkmcnt(9)
    s_setprio 2
    v_mfma_f32_32x32x16_bf16 v[208:223], v[40:43], v[128:131], v[208:223]
    s_setprio 0
    ds_read_b64_tr_b16 v[32:33], v3 offset:5312
    ds_read_b64_tr_b16 v[34:35], v3 offset:7872
    v_mfma_f32_32x32x16_bf16 v[224:239], v[44:47], v[128:131], v[224:239]
    ds_read_b64_tr_b16 v[36:37], v3 offset:5376
    ds_read_b64_tr_b16 v[38:39], v3 offset:7936
    s_waitcnt lgkmcnt(9)
    v_mfma_f32_32x32x16_bf16 v[240:255], v[16:19], v[128:131], v[240:255]
    ds_read_b64_tr_b16 v[40:41], v3 offset:10240
    ds_read_b64_tr_b16 v[42:43], v3 offset:12800
    s_setprio 2
    v_mfma_f32_32x32x16_bf16 v[176:191], v[20:23], v[132:135], v[176:191]
    s_setprio 0
    ds_read_b64_tr_b16 v[44:45], v3 offset:10304
    ds_read_b64_tr_b16 v[46:47], v3 offset:12864
    s_waitcnt lgkmcnt(8)
    v_mfma_f32_32x32x16_bf16 v[192:207], v[24:27], v[132:135], v[192:207]
    ds_read_b64_tr_b16 v[16:17], v3 offset:10368
    ds_read_b64_tr_b16 v[18:19], v3 offset:12928
    v_mfma_f32_32x32x16_bf16 v[208:223], v[28:31], v[132:135], v[208:223]
    ds_read_b64_tr_b16 v[20:21], v3 offset:10432
    ds_read_b64_tr_b16 v[22:23], v3 offset:12992
    s_waitcnt lgkmcnt(8)
    s_setprio 2
    v_mfma_f32_32x32x16_bf16 v[224:239], v[32:35], v[132:135], v[224:239]
    s_setprio 0
    ds_read_b64_tr_b16 v[24:25], v3 offset:10496
    ds_read_b64_tr_b16 v[26:27], v3 offset:13056
    v_mfma_f32_32x32x16_bf16 v[240:255], v[36:39], v[132:135], v[240:255]
    ds_read_b64_tr_b16 v[28:29], v3 offset:15360
    ds_read_b64_tr_b16 v[30:31], v3 offset:17920
    s_waitcnt lgkmcnt(8)
    v_mfma_f32_32x32x16_bf16 v[176:191], v[40:43], v[136:139], v[176:191]
    ds_read_b32 v15, v0 offset:0
    ds_read_b64_tr_b16 v[32:33], v3 offset:15424
    ds_read_b64_tr_b16 v[34:35], v3 offset:17984
    s_add_u32 s42, s78, 8192
    buffer_load_dwordx4 v[128:131], v11, s[24:27], s42 offen sc1
    buffer_load_dwordx4 v[132:135], v11, s[24:27], s42 offen offset:1024 sc1
    s_setprio 2
    v_mfma_f32_32x32x16_bf16 v[192:207], v[44:47], v[136:139], v[192:207]
    s_setprio 0
    ds_read_b64_tr_b16 v[36:37], v3 offset:15488
    ds_read_b64_tr_b16 v[38:39], v3 offset:18048
    s_waitcnt lgkmcnt(9)
    v_mfma_f32_32x32x16_bf16 v[208:223], v[16:19], v[136:139], v[208:223]
    ds_read_b64_tr_b16 v[40:41], v3 offset:15552
    ds_read_b64_tr_b16 v[42:43], v3 offset:18112
    v_mfma_f32_32x32x16_bf16 v[224:239], v[20:23], v[136:139], v[224:239]
    s_setprio 2
    s_waitcnt lgkmcnt(6)
L_cg50:
    v_cmp_gt_u32 vcc, 800, v15
    s_cbranch_vccz L_cg50_ok
    s_add_u32 s3, s3, 1
    s_cmp_ge_u32 s3, 0x400000
    s_cbranch_scc1 L_cg50_ok
    ds_read_b32 v15, v0 offset:0
    s_waitcnt lgkmcnt(0)
    s_branch L_cg50
L_cg50_ok:
    s_setprio 0
    ds_read_b64_tr_b16 v[44:45], v3 offset:15616
    ds_read_b64_tr_b16 v[46:47], v3 offset:18176
    s_add_u32 s42, s66, 147456
    s_add_u32 s43, s66, 184320
    s_cmp_lt_u32 s36, 2
    s_cselect_b32 s43, s42, s43
    s_add_u32 m0, s63, 20480
    s_nop 0
    buffer_load_dwordx4 v6, s[8:11], s43 offen offset:0 lds
    buffer_load_dwordx4 v7, s[8:11], s43 offen offset:1024 lds
    s_setprio 2
    v_mfma_f32_32x32x16_bf16 v[240:255], v[24:27], v[136:139], v[240:255]
    s_setprio 0
    ds_read_b64_tr_b16 v[16:17], v3 offset:20480
    ds_read_b64_tr_b16 v[18:19], v3 offset:23040
    buffer_load_dwordx4 v8, s[8:11], s43 offen offset:2048 lds
    buffer_load_dwordx4 v9, s[8:11], s43 offen offset:3072 lds
    s_add_u32 m0, s63, 24576
    s_nop 0
    buffer_load_dwordx4 v10, s[8:11], s43 offen offset:0 lds
    v_mfma_f32_32x32x16_bf16 v[176:191], v[28:31], v[140:143], v[176:191]
    ds_read_b64_tr_b16 v[20:21], v3 offset:20544
    ds_read_b64_tr_b16 v[22:23], v3 offset:23104
    buffer_store_dwordx4 v[48:51], v11, s[28:31], s57 offen sc1
    s_add_u32 s57, s57, 1024
    s_waitcnt lgkmcnt(8)
    v_mfma_f32_32x32x16_bf16 v[192:207], v[32:35], v[140:143], v[192:207]
    ds_read_b64_tr_b16 v[24:25], v3 offset:20608
    ds_read_b64_tr_b16 v[26:27], v3 offset:23168
    s_setprio 2
    v_mfma_f32_32x32x16_bf16 v[208:223], v[36:39], v[140:143], v[208:223]
    s_setprio 0
    ds_read_b64_tr_b16 v[28:29], v3 offset:20672
    ds_read_b64_tr_b16 v[30:31], v3 offset:23232
    s_waitcnt lgkmcnt(8)
    v_mfma_f32_32x32x16_bf16 v[224:239], v[40:43], v[140:143], v[224:239]
    ds_read_b64_tr_b16 v[32:33], v3 offset:20736
    ds_read_b64_tr_b16 v[34:35], v3 offset:23296
    v_mfma_f32_32x32x16_bf16 v[240:255], v[44:47], v[140:143], v[240:255]
    ds_read_b64_tr_b16 v[36:37], v3 offset:25600
    ds_read_b64_tr_b16 v[38:39], v3 offset:28160
    s_waitcnt vmcnt(21)
    s_mov_b64 exec, 1
    ds_add_u32 v0, v0 offset:0
    s_mov_b64 exec, -1
    s_waitcnt lgkmcnt(9)
    s_setprio 2
    v_mfma_f32_32x32x16_bf16 v[176:191], v[16:19], v[144:147], v[176:191]
    s_setprio 0
    ds_read_b64_tr_b16 v[40:41], v3 offset:25664
    ds_read_b64_tr_b16 v[42:43], v3 offset:28224
    s_add_u32 s42, s78, 10240
    buffer_load_dwordx4 v[136:139], v11, s[24:27], s42 offen sc1
    buffer_load_dwordx4 v[140:143], v11, s[24:27], s42 offen offset:1024 sc1
    v_mfma_f32_32x32x16_bf16 v[192:207], v[20:23], v[144:147], v[192:207]
    ds_read_b64_tr_b16 v[44:45], v3 offset:25728
    ds_read_b64_tr_b16 v[46:47], v3 offset:28288
    s_waitcnt lgkmcnt(9)
    v_mfma_f32_32x32x16_bf16 v[208:223], v[24:27], v[144:147], v[208:223]
    ds_read_b64_tr_b16 v[16:17], v3 offset:25792
    ds_read_b64_tr_b16 v[18:19], v3 offset:28352
    s_setprio 2
    v_mfma_f32_32x32x16_bf16 v[224:239], v[28:31], v[144:147], v[224:239]
    s_setprio 0
    ds_read_b64_tr_b16 v[20:21], v3 offset:25856
    ds_read_b64_tr_b16 v[22:23], v3 offset:28416
    s_waitcnt lgkmcnt(9)
    v_mfma_f32_32x32x16_bf16 v[240:255], v[32:35], v[144:147], v[240:255]
    ds_read_b64_tr_b16 v[24:25], v3 offset:30720
    ds_read_b64_tr_b16 v[26:27], v3 offset:33280
    v_mfma_f32_32x32x16_bf16 v[176:191], v[36:39], v[148:151], v[176:191]
    ds_read_b64_tr_b16 v[28:29], v3 offset:30784
    ds_read_b64_tr_b16 v[30:31], v3 offset:33344
    s_waitcnt lgkmcnt(8)
    s_setprio 2
    v_mfma_f32_32x32x16_bf16 v[192:207], v[40:43], v[148:151], v[192:207]
    s_setprio 0
    ds_read_b64_tr_b16 v[32:33], v3 offset:30848
    ds_read_b64_tr_b16 v[34:35], v3 offset:33408
    v_mfma_f32_32x32x16_bf16 v[208:223], v[44:47], v[148:151], v[208:223]
    ds_read_b64_tr_b16 v[36:37], v3 offset:30912
    ds_read_b64_tr_b16 v[38:39], v3 offset:33472
    s_waitcnt lgkmcnt(8)
    v_mfma_f32_32x32x16_bf16 v[224:239], v[16:19], v[148:151], v[224:239]
    ds_read_b64_tr_b16 v[40:41], v3 offset:30976
    ds_read_b64_tr_b16 v[42:43], v3 offset:33536
    s_setprio 2
    v_mfma_f32_32x32x16_bf16 v[240:255], v[20:23], v[148:151], v[240:255]
    s_setprio 0
    ds_read_b64_tr_b16 v[44:45], v3 offset:35840
    ds_read_b64_tr_b16 v[46:47], v3 offset:38400
    s_waitcnt lgkmcnt(8)
    v_mfma_f32_32x32x16_bf16 v[176:191], v[24:27], v[152:155], v[176:191]
    ds_read_b32 v15, v0 offset:0
    ds_read_b64_tr_b16 v[16:17], v3 offset:35904
    ds_read_b64_tr_b16 v[18:19], v3 offset:38464
    s_add_u32 s42, s78, 12288
    buffer_load_dwordx4 v[144:147], v11, s[24:27], s42 offen sc1
    buffer_load_dwordx4 v[148:151], v11, s[24:27], s42 offen offset:1024 sc1
    v_mfma_f32_32x32x16_bf16 v[192:207], v[28:31], v[152:155], v[192:207]
    ds_read_b64_tr_b16 v[20:21], v3 offset:35968
    ds_read_b64_tr_b16 v[22:23], v3 offset:38528
    s_waitcnt lgkmcnt(9)
    s_setprio 2
    v_mfma_f32_32x32x16_bf16 v[208:223], v[32:35], v[152:155], v[208:223]
    s_setprio 0
    ds_read_b64_tr_b16 v[24:25], v3 offset:36032
    ds_read_b64_tr_b16 v[26:27], v3 offset:38592
    v_mfma_f32_32x32x16_bf16 v[224:239], v[36:39], v[152:155], v[224:239]
    s_setprio 2
    s_waitcnt lgkmcnt(6)
L_cg51:
    v_cmp_gt_u32 vcc, 816, v15
    s_cbranch_vccz L_cg51_ok
    s_add_u32 s3, s3, 1
    s_cmp_ge_u32 s3, 0x400000
    s_cbranch_scc1 L_cg51_ok
    ds_read_b32 v15, v0 offset:0
    s_waitcnt lgkmcnt(0)
    s_branch L_cg51
L_cg51_ok:
    s_setprio 0
    ds_read_b64_tr_b16 v[28:29], v3 offset:36096
    ds_read_b64_tr_b16 v[30:31], v3 offset:38656
    s_add_u32 s42, s66, 221184
    s_mov_b32 s43, s71
    s_cmp_lt_u32 s36, 2
    s_cselect_b32 s43, s42, s43
    s_add_u32 m0, s63, 49152
    s_nop 0
    buffer_load_dwordx4 v6, s[8:11], s43 offen offset:0 lds
    buffer_load_dwordx4 v7, s[8:11], s43 offen offset:1024 lds
    v_mfma_f32_32x32x16_bf16 v[240:255], v[40:43], v[152:155], v[240:255]
    ds_read_b64_tr_b16 v[32:33], v3 offset:40960
    ds_read_b64_tr_b16 v[34:35], v3 offset:43520
    buffer_load_dwordx4 v8, s[8:11], s43 offen offset:2048 lds
    buffer_load_dwordx4 v9, s[8:11], s43 offen offset:3072 lds
    s_add_u32 m0, s63, 53248
    s_nop 0
    buffer_load_dwordx4 v10, s[8:11], s43 offen offset:0 lds
    s_setprio 2
    v_mfma_f32_32x32x16_bf16 v[176:191], v[44:47], v[156:159], v[176:191]
    s_setprio 0
    ds_read_b64_tr_b16 v[36:37], v3 offset:41024
    ds_read_b64_tr_b16 v[38:39], v3 offset:43584
    buffer_store_dwordx4 v[48:51], v11, s[28:31], s57 offen sc1
    s_add_u32 s57, s57, 1024
    s_waitcnt lgkmcnt(8)
    v_mfma_f32_32x32x16_bf16 v[192:207], v[16:19], v[156:159], v[192:207]
    ds_read_b64_tr_b16 v[40:41], v3 offset:41088
    ds_read_b64_tr_b16 v[42:43], v3 offset:43648
    v_mfma_f32_32x32x16_bf16 v[208:223], v[20:23], v[156:159], v[208:223]
    ds_read_b64_tr_b16 v[44:45], v3 offset:41152
    ds_read_b64_tr_b16 v[46:47], v3 offset:43712
    s_waitcnt lgkmcnt(8)
    s_setprio 2
    v_mfma_f32_32x32x16_bf16 v[224:239], v[24:27], v[156:159], v[224:239]
    s_setprio 0
    ds_read_b64_tr_b16 v[16:17], v3 offset:41216
    ds_read_b64_tr_b16 v[18:19], v3 offset:43776
    v_mfma_f32_32x32x16_bf16 v[240:255], v[28:31], v[156:159], v[240:255]
    ds_read_b64_tr_b16 v[20:21], v3 offset:46080
    ds_read_b64_tr_b16 v[22:23], v3 offset:48640
    s_waitcnt vmcnt(21)
    s_mov_b64 exec, 1
    ds_add_u32 v0, v0 offset:0
    s_mov_b64 exec, -1
    s_waitcnt lgkmcnt(9)
    v_mfma_f32_32x32x16_bf16 v[176:191], v[32:35], v[160:163], v[176:191]
    ds_read_b64_tr_b16 v[24:25], v3 offset:46144
    ds_read_b64_tr_b16 v[26:27], v3 offset:48704
    s_add_u32 s42, s79, 0
    buffer_load_dwordx4 v[152:155], v11, s[24:27], s42 offen sc1
    buffer_load_dwordx4 v[156:159], v11, s[24:27], s42 offen offset:1024 sc1
    s_setprio 2
    v_mfma_f32_32x32x16_bf16 v[192:207], v[36:39], v[160:163], v[192:207]
    s_setprio 0
    ds_read_b64_tr_b16 v[28:29], v3 offset:46208
    ds_read_b64_tr_b16 v[30:31], v3 offset:48768
    s_waitcnt lgkmcnt(9)
    v_mfma_f32_32x32x16_bf16 v[208:223], v[40:43], v[160:163], v[208:223]
    ds_read_b64_tr_b16 v[32:33], v3 offset:46272
    ds_read_b64_tr_b16 v[34:35], v3 offset:48832
    v_mfma_f32_32x32x16_bf16 v[224:239], v[44:47], v[160:163], v[224:239]
    ds_read_b64_tr_b16 v[36:37], v3 offset:46336
    ds_read_b64_tr_b16 v[38:39], v3 offset:48896
    s_waitcnt lgkmcnt(9)
    s_setprio 2
    v_mfma_f32_32x32x16_bf16 v[240:255], v[16:19], v[160:163], v[240:255]
    s_setprio 0
    ds_read_b64_tr_b16 v[40:41], v3 offset:51200
    ds_read_b64_tr_b16 v[42:43], v3 offset:53760
    v_mfma_f32_32x32x16_bf16 v[176:191], v[20:23], v[164:167], v[176:191]
    ds_read_b64_tr_b16 v[44:45], v3 offset:51264
    ds_read_b64_tr_b16 v[46:47], v3 offset:53824
    s_waitcnt lgkmcnt(8)
    v_mfma_f32_32x32x16_bf16 v[192:207], v[24:27], v[164:167], v[192:207]
    ds_read_b64_tr_b16 v[16:17], v3 offset:51328
    ds_read_b64_tr_b16 v[18:19], v3 offset:53888
    s_setprio 2
    v_mfma_f32_32x32x16_bf16 v[208:223], v[28:31], v[164:167], v[208:223]
    s_setprio 0
    ds_read_b64_tr_b16 v[20:21], v3 offset:51392
    ds_read_b64_tr_b16 v[22:23], v3 offset:53952
    s_waitcnt lgkmcnt(8)
    v_mfma_f32_32x32x16_bf16 v[224:239], v[32:35], v[164:167], v[224:239]
    ds_read_b64_tr_b16 v[24:25], v3 offset:51456
    ds_read_b64_tr_b16 v[26:27], v3 offset:54016
    v_mfma_f32_32x32x16_bf16 v[240:255], v[36:39], v[164:167], v[240:255]
    ds_read_b64_tr_b16 v[28:29], v3 offset:56320
    ds_read_b64_tr_b16 v[30:31], v3 offset:58880
    s_waitcnt lgkmcnt(8)
    s_setprio 2
    v_mfma_f32_32x32x16_bf16 v[176:191], v[40:43], v[168:171], v[176:191]
    s_setprio 0
    ds_read_b32 v15, v0 offset:0
    ds_read_b64_tr_b16 v[32:33], v3 offset:56384
    ds_read_b64_tr_b16 v[34:35], v3 offset:58944
    s_add_u32 s42, s79, 2048
    buffer_load_dwordx4 v[160:163], v11, s[24:27], s42 offen sc1
    buffer_load_dwordx4 v[164:167], v11, s[24:27], s42 offen offset:1024 sc1
    v_mfma_f32_32x32x16_bf16 v[192:207], v[44:47], v[168:171], v[192:207]
    ds_read_b64_tr_b16 v[36:37], v3 offset:56448
    ds_read_b64_tr_b16 v[38:39], v3 offset:59008
    s_waitcnt lgkmcnt(9)
    v_mfma_f32_32x32x16_bf16 v[208:223], v[16:19], v[168:171], v[208:223]
    ds_read_b64_tr_b16 v[40:41], v3 offset:56512
    ds_read_b64_tr_b16 v[42:43], v3 offset:59072
    s_setprio 2
    v_mfma_f32_32x32x16_bf16 v[224:239], v[20:23], v[168:171], v[224:239]
    s_setprio 0
    s_setprio 2
    s_waitcnt lgkmcnt(6)
L_cg52:
    v_cmp_gt_u32 vcc, 832, v15
    s_cbranch_vccz L_cg52_ok
    s_add_u32 s3, s3, 1
    s_cmp_ge_u32 s3, 0x400000
    s_cbranch_scc1 L_cg52_ok
    ds_read_b32 v15, v0 offset:0
    s_waitcnt lgkmcnt(0)
    s_branch L_cg52
L_cg52_ok:
    s_setprio 0
    ds_read_b64_tr_b16 v[44:45], v3 offset:56576
    ds_read_b64_tr_b16 v[46:47], v3 offset:59136
    s_add_u32 s42, s67, 36864
    s_add_u32 s43, s67, 73728
    s_cmp_lt_u32 s36, 2
    s_cselect_b32 s43, s42, s43
    s_add_u32 m0, s63, 69632
    s_nop 0
    buffer_load_dwordx4 v6, s[8:11], s43 offen offset:0 lds
    buffer_load_dwordx4 v7, s[8:11], s43 offen offset:1024 lds
    v_mfma_f32_32x32x16_bf16 v[240:255], v[24:27], v[168:171], v[240:255]
    ds_read_b64_tr_b16 v[16:17], v2 offset:0
    ds_read_b64_tr_b16 v[18:19], v2 offset:2560
    buffer_load_dwordx4 v8, s[8:11], s43 offen offset:2048 lds
    buffer_load_dwordx4 v9, s[8:11], s43 offen offset:3072 lds
    s_add_u32 m0, s63, 73728
    s_nop 0
    buffer_load_dwordx4 v10, s[8:11], s43 offen offset:0 lds
    v_mfma_f32_32x32x16_bf16 v[176:191], v[28:31], v[172:175], v[176:191]
    ds_read_b64_tr_b16 v[20:21], v2 offset:64
    ds_read_b64_tr_b16 v[22:23], v2 offset:2624
    buffer_store_dwordx4 v[48:51], v11, s[28:31], s57 offen sc1
    s_add_u32 s57, s57, 1024
    s_waitcnt lgkmcnt(8)
    s_setprio 2
    v_mfma_f32_32x32x16_bf16 v[192:207], v[32:35], v[172:175], v[192:207]
    s_setprio 0
    ds_read_b64_tr_b16 v[24:25], v2 offset:128
    ds_read_b64_tr_b16 v[26:27], v2 offset:2688
    v_mfma_f32_32x32x16_bf16 v[208:223], v[36:39], v[172:175], v[208:223]
    ds_read_b64_tr_b16 v[28:29], v2 offset:192
    ds_read_b64_tr_b16 v[30:31], v2 offset:2752
    s_waitcnt lgkmcnt(8)
    v_mfma_f32_32x32x16_bf16 v[224:239], v[40:43], v[172:175], v[224:239]
    ds_read_b64_tr_b16 v[32:33], v2 offset:256
    ds_read_b64_tr_b16 v[34:35], v2 offset:2816
    s_setprio 2
    v_mfma_f32_32x32x16_bf16 v[240:255], v[44:47], v[172:175], v[240:255]
    s_setprio 0
    ds_read_b64_tr_b16 v[36:37], v2 offset:5120
    ds_read_b64_tr_b16 v[38:39], v2 offset:7680
    s_waitcnt vmcnt(21)
    s_mov_b64 exec, 1
    ds_add_u32 v0, v0 offset:0
    s_mov_b64 exec, -1
    s_waitcnt lgkmcnt(9)
    v_mfma_f32_32x32x16_bf16 v[176:191], v[16:19], v[112:115], v[176:191]
    ds_read_b64_tr_b16 v[40:41], v2 offset:5184
    ds_read_b64_tr_b16 v[42:43], v2 offset:7744
    s_add_u32 s42, s79, 4096
    buffer_load_dwordx4 v[168:171], v11, s[24:27], s42 offen sc1
    buffer_load_dwordx4 v[172:175], v11, s[24:27], s42 offen offset:1024 sc1
    v_mfma_f32_32x32x16_bf16 v[192:207], v[20:23], v[112:115], v[192:207]
    ds_read_b64_tr_b16 v[44:45], v2 offset:5248
    ds_read_b64_tr_b16 v[46:47], v2 offset:7808
    s_waitcnt lgkmcnt(9)
    s_setprio 2
    v_mfma_f32_32x32x16_bf16 v[208:223], v[24:27], v[112:115], v[208:223]
    s_setprio 0
    ds_read_b64_tr_b16 v[16:17], v2 offset:5312
    ds_read_b64_tr_b16 v[18:19], v2 offset:7872
    v_mfma_f32_32x32x16_bf16 v[224:239], v[28:31], v[112:115], v[224:239]
    ds_read_b64_tr_b16 v[20:21], v2 offset:5376
    ds_read_b64_tr_b16 v[22:23], v2 offset:7936
    s_waitcnt lgkmcnt(9)
    v_mfma_f32_32x32x16_bf16 v[240:255], v[32:35], v[112:115], v[240:255]
    ds_read_b64_tr_b16 v[24:25], v2 offset:10240
    ds_read_b64_tr_b16 v[26:27], v2 offset:12800
    s_setprio 2
    v_mfma_f32_32x32x16_bf16 v[176:191], v[36:39], v[116:119], v[176:191]
    s_setprio 0
    ds_read_b64_tr_b16 v[28:29], v2 offset:10304
    ds_read_b64_tr_b16 v[30:31], v2 offset:12864
    s_waitcnt lgkmcnt(8)
    v_mfma_f32_32x32x16_bf16 v[192:207], v[40:43], v[116:119], v[192:207]
    ds_read_b64_tr_b16 v[32:33], v2 offset:10368
    ds_read_b64_tr_b16 v[34:35], v2 offset:12928
    v_mfma_f32_32x32x16_bf16 v[208:223], v[44:47], v[116:119], v[208:223]
    ds_read_b64_tr_b16 v[36:37], v2 offset:10432
    ds_read_b64_tr_b16 v[38:39], v2 offset:12992
    s_waitcnt lgkmcnt(8)
    s_setprio 2
    v_mfma_f32_32x32x16_bf16 v[224:239], v[16:19], v[116:119], v[224:239]
    s_setprio 0
    ds_read_b64_tr_b16 v[40:41], v2 offset:10496
    ds_read_b64_tr_b16 v[42:43], v2 offset:13056
    v_mfma_f32_32x32x16_bf16 v[240:255], v[20:23], v[116:119], v[240:255]
    ds_read_b64_tr_b16 v[44:45], v2 offset:15360
    ds_read_b64_tr_b16 v[46:47], v2 offset:17920
    s_waitcnt lgkmcnt(8)
    v_mfma_f32_32x32x16_bf16 v[176:191], v[24:27], v[120:123], v[176:191]
    ds_read_b32 v15, v0 offset:0
    ds_read_b64_tr_b16 v[16:17], v2 offset:15424
    ds_read_b64_tr_b16 v[18:19], v2 offset:17984
    s_add_u32 s42, s79, 6144
    buffer_load_dwordx4 v[112:115], v11, s[24:27], s42 offen sc1
    buffer_load_dwordx4 v[116:119], v11, s[24:27], s42 offen offset:1024 sc1
    s_setprio 2
    v_mfma_f32_32x32x16_bf16 v[192:207], v[28:31], v[120:123], v[192:207]
    s_setprio 0
    ds_read_b64_tr_b16 v[20:21], v2 offset:15488
    ds_read_b64_tr_b16 v[22:23], v2 offset:18048
    s_waitcnt lgkmcnt(9)
    v_mfma_f32_32x32x16_bf16 v[208:223], v[32:35], v[120:123], v[208:223]
    ds_read_b64_tr_b16 v[24:25], v2 offset:15552
    ds_read_b64_tr_b16 v[26:27], v2 offset:18112
    v_mfma_f32_32x32x16_bf16 v[224:239], v[36:39], v[120:123], v[224:239]
    s_setprio 2
    s_waitcnt lgkmcnt(6)
L_cg53:
    v_cmp_gt_u32 vcc, 848, v15
    s_cbranch_vccz L_cg53_ok
    s_add_u32 s3, s3, 1
    s_cmp_ge_u32 s3, 0x400000
    s_cbranch_scc1 L_cg53_ok
    ds_read_b32 v15, v0 offset:0
    s_waitcnt lgkmcnt(0)
    s_branch L_cg53
L_cg53_ok:
    s_setprio 0
    ds_read_b64_tr_b16 v[28:29], v2 offset:15616
    ds_read_b64_tr_b16 v[30:31], v2 offset:18176
    s_add_u32 s42, s67, 110592
    s_add_u32 s43, s67, 147456
    s_cmp_lt_u32 s36, 2
    s_cselect_b32 s43, s42, s43
    s_add_u32 m0, s63, 90112
    s_nop 0
    buffer_load_dwordx4 v6, s[8:11], s43 offen offset:0 lds
    buffer_load_dwordx4 v7, s[8:11], s43 offen offset:1024 lds
    s_setprio 2
    v_mfma_f32_32x32x16_bf16 v[240:255], v[40:43], v[120:123], v[240:255]
    s_setprio 0
    ds_read_b64_tr_b16 v[32:33], v2 offset:20480
    ds_read_b64_tr_b16 v[34:35], v2 offset:23040
    buffer_load_dwordx4 v8, s[8:11], s43 offen offset:2048 lds
    buffer_load_dwordx4 v9, s[8:11], s43 offen offset:3072 lds
    s_add_u32 m0, s63, 94208
    s_nop 0
    buffer_load_dwordx4 v10, s[8:11], s43 offen offset:0 lds
    v_mfma_f32_32x32x16_bf16 v[176:191], v[44:47], v[124:127], v[176:191]
    ds_read_b64_tr_b16 v[36:37], v2 offset:20544
    ds_read_b64_tr_b16 v[38:39], v2 offset:23104
    buffer_store_dwordx4 v[48:51], v11, s[28:31], s57 offen sc1
    s_add_u32 s57, s57, 1024
    s_waitcnt lgkmcnt(8)
    v_mfma_f32_32x32x16_bf16 v[192:207], v[16:19], v[124:127], v[192:207]
    ds_read_b64_tr_b16 v[40:41], v2 offset:20608
    ds_read_b64_tr_b16 v[42:43], v2 offset:23168
    s_setprio 2
    v_mfma_f32_32x32x16_bf16 v[208:223], v[20:23], v[124:127], v[208:223]
    s_setprio 0
    ds_read_b64_tr_b16 v[44:45], v2 offset:20672
    ds_read_b64_tr_b16 v[46:47], v2 offset:23232
    s_waitcnt lgkmcnt(8)
    v_mfma_f32_32x32x16_bf16 v[224:239], v[24:27], v[124:127], v[224:239]
    ds_read_b64_tr_b16 v[16:17], v2 offset:20736
    ds_read_b64_tr_b16 v[18:19], v2 offset:23296
    v_mfma_f32_32x32x16_bf16 v[240:255], v[28:31], v[124:127], v[240:255]
    ds_read_b64_tr_b16 v[20:21], v2 offset:25600
    ds_read_b64_tr_b16 v[22:23], v2 offset:28160
    s_waitcnt vmcnt(21)
    s_mov_b64 exec, 1
    ds_add_u32 v0, v0 offset:0
    s_mov_b64 exec, -1
    s_waitcnt lgkmcnt(9)
    s_setprio 2
    v_mfma_f32_32x32x16_bf16 v[176:191], v[32:35], v[128:131], v[176:191]
    s_setprio 0
    ds_read_b64_tr_b16 v[24:25], v2 offset:25664
    ds_read_b64_tr_b16 v[26:27], v2 offset:28224
    s_add_u32 s42, s79, 8192
    buffer_load_dwordx4 v[120:123], v11, s[24:27], s42 offen sc1
    buffer_load_dwordx4 v[124:127], v11, s[24:27], s42 offen offset:1024 sc1
    v_mfma_f32_32x32x16_bf16 v[192:207], v[36:39], v[128:131], v[192:207]
    ds_read_b64_tr_b16 v[28:29], v2 offset:25728
    ds_read_b64_tr_b16 v[30:31], v2 offset:28288
    s_waitcnt lgkmcnt(9)
    v_mfma_f32_32x32x16_bf16 v[208:223], v[40:43], v[128:131], v[208:223]
    ds_read_b64_tr_b16 v[32:33], v2 offset:25792
    ds_read_b64_tr_b16 v[34:35], v2 offset:28352
    s_setprio 2
    v_mfma_f32_32x32x16_bf16 v[224:239], v[44:47], v[128:131], v[224:239]
    s_setprio 0
    ds_read_b64_tr_b16 v[36:37], v2 offset:25856
    ds_read_b64_tr_b16 v[38:39], v2 offset:28416
    s_waitcnt lgkmcnt(9)
    v_mfma_f32_32x32x16_bf16 v[240:255], v[16:19], v[128:131], v[240:255]
    ds_read_b64_tr_b16 v[40:41], v2 offset:30720
    ds_read_b64_tr_b16 v[42:43], v2 offset:33280
    v_mfma_f32_32x32x16_bf16 v[176:191], v[20:23], v[132:135], v[176:191]
    ds_read_b64_tr_b16 v[44:45], v2 offset:30784
    ds_read_b64_tr_b16 v[46:47], v2 offset:33344
    s_waitcnt lgkmcnt(8)
    s_setprio 2
    v_mfma_f32_32x32x16_bf16 v[192:207], v[24:27], v[132:135], v[192:207]
    s_setprio 0
    ds_read_b64_tr_b16 v[16:17], v2 offset:30848
    ds_read_b64_tr_b16 v[18:19], v2 offset:33408
    v_mfma_f32_32x32x16_bf16 v[208:223], v[28:31], v[132:135], v[208:223]
    ds_read_b64_tr_b16 v[20:21], v2 offset:30912
    ds_read_b64_tr_b16 v[22:23], v2 offset:33472
    s_waitcnt lgkmcnt(8)
    v_mfma_f32_32x32x16_bf16 v[224:239], v[32:35], v[132:135], v[224:239]
    ds_read_b64_tr_b16 v[24:25], v2 offset:30976
    ds_read_b64_tr_b16 v[26:27], v2 offset:33536
    s_setprio 2
    v_mfma_f32_32x32x16_bf16 v[240:255], v[36:39], v[132:135], v[240:255]
    s_setprio 0
    ds_read_b64_tr_b16 v[28:29], v2 offset:35840
    ds_read_b64_tr_b16 v[30:31], v2 offset:38400
    s_waitcnt lgkmcnt(8)
    v_mfma_f32_32x32x16_bf16 v[176:191], v[40:43], v[136:139], v[176:191]
    ds_read_b32 v15, v0 offset:0
    ds_read_b64_tr_b16 v[32:33], v2 offset:35904
    ds_read_b64_tr_b16 v[34:35], v2 offset:38464
    s_add_u32 s42, s79, 10240
    buffer_load_dwordx4 v[128:131], v11, s[24:27], s42 offen sc1
    buffer_load_dwordx4 v[132:135], v11, s[24:27], s42 offen offset:1024 sc1
    v_mfma_f32_32x32x16_bf16 v[192:207], v[44:47], v[136:139], v[192:207]
    ds_read_b64_tr_b16 v[36:37], v2 offset:35968
    ds_read_b64_tr_b16 v[38:39], v2 offset:38528
    s_waitcnt lgkmcnt(9)
    s_setprio 2
    v_mfma_f32_32x32x16_bf16 v[208:223], v[16:19], v[136:139], v[208:223]
    s_setprio 0
    ds_read_b64_tr_b16 v[40:41], v2 offset:36032
    ds_read_b64_tr_b16 v[42:43], v2 offset:38592
    v_mfma_f32_32x32x16_bf16 v[224:239], v[20:23], v[136:139], v[224:239]
    s_setprio 2
    s_waitcnt lgkmcnt(6)
L_cg54:
    v_cmp_gt_u32 vcc, 864, v15
    s_cbranch_vccz L_cg54_ok
    s_add_u32 s3, s3, 1
    s_cmp_ge_u32 s3, 0x400000
    s_cbranch_scc1 L_cg54_ok
    ds_read_b32 v15, v0 offset:0
    s_waitcnt lgkmcnt(0)
    s_branch L_cg54
L_cg54_ok:
    s_setprio 0
    ds_read_b64_tr_b16 v[44:45], v2 offset:36096
    ds_read_b64_tr_b16 v[46:47], v2 offset:38656
    s_add_u32 s42, s67, 184320
    s_add_u32 s43, s67, 221184
    s_cmp_lt_u32 s36, 2
    s_cselect_b32 s43, s42, s43
    s_add_u32 m0, s63, 0
    s_nop 0
    buffer_load_dwordx4 v6, s[8:11], s43 offen offset:0 lds
    buffer_load_dwordx4 v7, s[8:11], s43 offen offset:1024 lds
    v_mfma_f32_32x32x16_bf16 v[240:255], v[24:27], v[136:139], v[240:255]
    ds_read_b64_tr_b16 v[16:17], v3 offset:0
    ds_read_b64_tr_b16 v[18:19], v3 offset:2560
    buffer_load_dwordx4 v8, s[8:11], s43 offen offset:2048 lds
    buffer_load_dwordx4 v9, s[8:11], s43 offen offset:3072 lds
    s_add_u32 m0, s63, 4096
    s_nop 0
    buffer_load_dwordx4 v10, s[8:11], s43 offen offset:0 lds
    s_setprio 2
    v_mfma_f32_32x32x16_bf16 v[176:191], v[28:31], v[140:143], v[176:191]
    s_setprio 0
    ds_read_b64_tr_b16 v[20:21], v3 offset:64
    ds_read_b64_tr_b16 v[22:23], v3 offset:2624
    buffer_store_dwordx4 v[48:51], v11, s[28:31], s57 offen sc1
    s_add_u32 s57, s57, 1024
    s_waitcnt lgkmcnt(8)
    v_mfma_f32_32x32x16_bf16 v[192:207], v[32:35], v[140:143], v[192:207]
    ds_read_b64_tr_b16 v[24:25], v3 offset:128
    ds_read_b64_tr_b16 v[26:27], v3 offset:2688
    s_setprio 2
    v_and_b32 v14, 7, v1
    v_lshlrev_b32 v14, 2, v14
    s_setprio 0
    buffer_load_dword v13, v14, s[28:31], s44 offen offset:32 sc1
    v_mfma_f32_32x32x16_bf16 v[208:223], v[36:39], v[140:143], v[208:223]
    ds_read_b64_tr_b16 v[28:29], v3 offset:192
    ds_read_b64_tr_b16 v[30:31], v3 offset:2752
    s_waitcnt lgkmcnt(8)
    s_setprio 2
    v_mfma_f32_32x32x16_bf16 v[224:239], v[40:43], v[140:143], v[224:239]
    s_setprio 0
    ds_read_b64_tr_b16 v[32:33], v3 offset:256
    ds_read_b64_tr_b16 v[34:35], v3 offset:2816
    v_mfma_f32_32x32x16_bf16 v[240:255], v[44:47], v[140:143], v[240:255]
    ds_read_b64_tr_b16 v[36:37], v3 offset:5120
    ds_read_b64_tr_b16 v[38:39], v3 offset:7680
    s_waitcnt vmcnt(22)
    s_mov_b64 exec, 1
    ds_add_u32 v0, v0 offset:0
    s_mov_b64 exec, -1
    s_waitcnt lgkmcnt(9)
    v_mfma_f32_32x32x16_bf16 v[176:191], v[16:19], v[144:147], v[176:191]
    ds_read_b64_tr_b16 v[40:41], v3 offset:5184
    ds_read_b64_tr_b16 v[42:43], v3 offset:7744
    s_add_u32 s42, s79, 12288
    buffer_load_dwordx4 v[136:139], v11, s[24:27], s42 offen sc1
    buffer_load_dwordx4 v[140:143], v11, s[24:27], s42 offen offset:1024 sc1
    s_setprio 2
    v_mfma_f32_32x32x16_bf16 v[192:207], v[20:23], v[144:147], v[192:207]
    s_setprio 0
    ds_read_b64_tr_b16 v[44:45], v3 offset:5248
    ds_read_b64_tr_b16 v[46:47], v3 offset:7808
    s_waitcnt lgkmcnt(9)
    v_mfma_f32_32x32x16_bf16 v[208:223], v[24:27], v[144:147], v[208:223]
    ds_read_b64_tr_b16 v[16:17], v3 offset:5312
    ds_read_b64_tr_b16 v[18:19], v3 offset:7872
    v_mfma_f32_32x32x16_bf16 v[224:239], v[28:31], v[144:147], v[224:239]
    ds_read_b64_tr_b16 v[20:21], v3 offset:5376
    ds_read_b64_tr_b16 v[22:23], v3 offset:7936
    s_waitcnt lgkmcnt(9)
    s_setprio 2
    v_mfma_f32_32x32x16_bf16 v[240:255], v[32:35], v[144:147], v[240:255]
    s_setprio 0
    ds_read_b64_tr_b16 v[24:25], v3 offset:10240
    ds_read_b64_tr_b16 v[26:27], v3 offset:12800
    v_mfma_f32_32x32x16_bf16 v[176:191], v[36:39], v[148:151], v[176:191]
    ds_read_b64_tr_b16 v[28:29], v3 offset:10304
    ds_read_b64_tr_b16 v[30:31], v3 offset:12864
    s_waitcnt lgkmcnt(8)
    v_mfma_f32_32x32x16_bf16 v[192:207], v[40:43], v[148:151], v[192:207]
    ds_read_b64_tr_b16 v[32:33], v3 offset:10368
    ds_read_b64_tr_b16 v[34:35], v3 offset:12928
    s_setprio 2
    v_mfma_f32_32x32x16_bf16 v[208:223], v[44:47], v[148:151], v[208:223]
    s_setprio 0
    ds_read_b64_tr_b16 v[36:37], v3 offset:10432
    ds_read_b64_tr_b16 v[38:39], v3 offset:12992
    s_waitcnt lgkmcnt(8)
    v_mfma_f32_32x32x16_bf16 v[224:239], v[16:19], v[148:151], v[224:239]
    ds_read_b64_tr_b16 v[40:41], v3 offset:10496
    ds_read_b64_tr_b16 v[42:43], v3 offset:13056
    v_mfma_f32_32x32x16_bf16 v[240:255], v[20:23], v[148:151], v[240:255]
    ds_read_b64_tr_b16 v[44:45], v3 offset:15360
    ds_read_b64_tr_b16 v[46:47], v3 offset:17920
    s_waitcnt lgkmcnt(8)
    s_setprio 2
    v_mfma_f32_32x32x16_bf16 v[176:191], v[24:27], v[152:155], v[176:191]
    s_setprio 0
    ds_read_b32 v15, v0 offset:0
    ds_read_b64_tr_b16 v[16:17], v3 offset:15424
    ds_read_b64_tr_b16 v[18:19], v3 offset:17984
    v_mfma_f32_32x32x16_bf16 v[192:207], v[28:31], v[152:155], v[192:207]
    ds_read_b64_tr_b16 v[20:21], v3 offset:15488
    ds_read_b64_tr_b16 v[22:23], v3 offset:18048
    s_waitcnt lgkmcnt(9)
    v_mfma_f32_32x32x16_bf16 v[208:223], v[32:35], v[152:155], v[208:223]
    ds_read_b64_tr_b16 v[24:25], v3 offset:15552
    ds_read_b64_tr_b16 v[26:27], v3 offset:18112
    s_setprio 2
    v_mfma_f32_32x32x16_bf16 v[224:239], v[36:39], v[152:155], v[224:239]
    s_setprio 0
    s_setprio 2
    s_waitcnt lgkmcnt(6)
L_cg55:
    v_cmp_gt_u32 vcc, 880, v15
    s_cbranch_vccz L_cg55_ok
    s_add_u32 s3, s3, 1
    s_cmp_ge_u32 s3, 0x400000
    s_cbranch_scc1 L_cg55_ok
    ds_read_b32 v15, v0 offset:0
    s_waitcnt lgkmcnt(0)
    s_branch L_cg55
L_cg55_ok:
    s_setprio 0
    ds_read_b64_tr_b16 v[28:29], v3 offset:15616
    ds_read_b64_tr_b16 v[30:31], v3 offset:18176
    s_add_u32 s42, s64, 258048
    s_add_u32 s43, s64, 294912
    s_cmp_lt_u32 s36, 2
    s_cselect_b32 s43, s42, s43
    s_add_u32 m0, s63, 20480
    s_nop 0
    buffer_load_dwordx4 v6, s[8:11], s43 offen offset:0 lds
    buffer_load_dwordx4 v7, s[8:11], s43 offen offset:1024 lds
    v_mfma_f32_32x32x16_bf16 v[240:255], v[40:43], v[152:155], v[240:255]
    ds_read_b64_tr_b16 v[32:33], v3 offset:20480
    ds_read_b64_tr_b16 v[34:35], v3 offset:23040
    buffer_load_dwordx4 v8, s[8:11], s43 offen offset:2048 lds
    buffer_load_dwordx4 v9, s[8:11], s43 offen offset:3072 lds
    s_add_u32 m0, s63, 24576
    s_nop 0
    buffer_load_dwordx4 v10, s[8:11], s43 offen offset:0 lds
    v_mfma_f32_32x32x16_bf16 v[176:191], v[44:47], v[156:159], v[176:191]
    ds_read_b64_tr_b16 v[36:37], v3 offset:20544
    ds_read_b64_tr_b16 v[38:39], v3 offset:23104
    s_waitcnt lgkmcnt(8)
    s_setprio 2
    v_mfma_f32_32x32x16_bf16 v[192:207], v[16:19], v[156:159], v[192:207]
    s_setprio 0
    ds_read_b64_tr_b16 v[40:41], v3 offset:20608
    ds_read_b64_tr_b16 v[42:43], v3 offset:23168
    v_mfma_f32_32x32x16_bf16 v[208:223], v[20:23], v[156:159], v[208:223]
    ds_read_b64_tr_b16 v[44:45], v3 offset:20672
    ds_read_b64_tr_b16 v[46:47], v3 offset:23232
    s_waitcnt lgkmcnt(8)
    v_mfma_f32_32x32x16_bf16 v[224:239], v[24:27], v[156:159], v[224:239]
    ds_read_b64_tr_b16 v[16:17], v3 offset:20736
    ds_read_b64_tr_b16 v[18:19], v3 offset:23296
    s_setprio 2
    v_mfma_f32_32x32x16_bf16 v[240:255], v[28:31], v[156:159], v[240:255]
    s_setprio 0
    ds_read_b64_tr_b16 v[20:21], v3 offset:25600
    ds_read_b64_tr_b16 v[22:23], v3 offset:28160
    s_waitcnt vmcnt(19)
    s_setprio 2
    s_waitcnt vmcnt(7)
    s_cmp_lg_u32 s36, 0
    s_cbranch_scc1 L_hl_ok
L_hl_chk:
    v_cmp_ne_u32 s[40:41], s60, v13
    v_cmp_ne_u32 vcc, s61, v13
    s_nop 0
    s_and_b32 s40, s40, 0x0f
    s_and_b32 s41, vcc_lo, 0xf0
    s_or_b32 s40, s40, s41
    s_cbranch_scc0 L_hl_ok
    s_add_u32 s3, s3, 16
    s_cmp_ge_u32 s3, 0x400000
    s_cbranch_scc1 L_hl_ok
    s_sleep 4
    buffer_load_dword v13, v14, s[28:31], s44 offen offset:32 sc1
    s_waitcnt vmcnt(0)
    s_branch L_hl_chk
L_hl_ok:
    s_mov_b64 exec, 1
    ds_add_u32 v0, v0 offset:0
    s_mov_b64 exec, -1
    s_waitcnt lgkmcnt(9)
    s_setprio 0
    v_mfma_f32_32x32x16_bf16 v[176:191], v[32:35], v[160:163], v[176:191]
    ds_read_b64_tr_b16 v[24:25], v3 offset:25664
    ds_read_b64_tr_b16 v[26:27], v3 offset:28224
    v_mfma_f32_32x32x16_bf16 v[192:207], v[36:39], v[160:163], v[192:207]
    ds_read_b64_tr_b16 v[28:29], v3 offset:25728
    ds_read_b64_tr_b16 v[30:31], v3 offset:28288
    s_waitcnt lgkmcnt(9)
    s_setprio 2
    v_mfma_f32_32x32x16_bf16 v[208:223], v[40:43], v[160:163], v[208:223]
    s_setprio 0
    ds_read_b64_tr_b16 v[32:33], v3 offset:25792
    ds_read_b64_tr_b16 v[34:35], v3 offset:28352
    v_mfma_f32_32x32x16_bf16 v[224:239], v[44:47], v[160:163], v[224:239]
    ds_read_b64_tr_b16 v[36:37], v3 offset:25856
    ds_read_b64_tr_b16 v[38:39], v3 offset:28416
    s_waitcnt lgkmcnt(9)
    v_mfma_f32_32x32x16_bf16 v[240:255], v[16:19], v[160:163], v[240:255]
    ds_read_b64_tr_b16 v[40:41], v3 offset:30720
    ds_read_b64_tr_b16 v[42:43], v3 offset:33280
    s_setprio 2
    v_mfma_f32_32x32x16_bf16 v[176:191], v[20:23], v[164:167], v[176:191]
    s_setprio 0
    ds_read_b64_tr_b16 v[44:45], v3 offset:30784
    ds_read_b64_tr_b16 v[46:47], v3 offset:33344
    s_waitcnt lgkmcnt(8)
    v_mfma_f32_32x32x16_bf16 v[192:207], v[24:27], v[164:167], v[192:207]
    ds_read_b64_tr_b16 v[16:17], v3 offset:30848
    ds_read_b64_tr_b16 v[18:19], v3 offset:33408
    v_mfma_f32_32x32x16_bf16 v[208:223], v[28:31], v[164:167], v[208:223]
    ds_read_b64_tr_b16 v[20:21], v3 offset:30912
    ds_read_b64_tr_b16 v[22:23], v3 offset:33472
    s_waitcnt lgkmcnt(8)
    s_setprio 2
    v_mfma_f32_32x32x16_bf16 v[224:239], v[32:35], v[164:167], v[224:239]
    s_setprio 0
    ds_read_b64_tr_b16 v[24:25], v3 offset:30976
    ds_read_b64_tr_b16 v[26:27], v3 offset:33536
    v_mfma_f32_32x32x16_bf16 v[240:255], v[36:39], v[164:167], v[240:255]
    ds_read_b64_tr_b16 v[28:29], v3 offset:35840
    ds_read_b64_tr_b16 v[30:31], v3 offset:38400
    s_waitcnt lgkmcnt(8)
    v_mfma_f32_32x32x16_bf16 v[176:191], v[40:43], v[168:171], v[176:191]
    ds_read_b32 v15, v0 offset:0
    ds_read_b64_tr_b16 v[32:33], v3 offset:35904
    ds_read_b64_tr_b16 v[34:35], v3 offset:38464
    s_setprio 2
    v_mfma_f32_32x32x16_bf16 v[192:207], v[44:47], v[168:171], v[192:207]
    s_setprio 0
    ds_read_b64_tr_b16 v[36:37], v3 offset:35968
    ds_read_b64_tr_b16 v[38:39], v3 offset:38528
    s_waitcnt lgkmcnt(9)
    v_mfma_f32_32x32x16_bf16 v[208:223], v[16:19], v[168:171], v[208:223]
    ds_read_b64_tr_b16 v[40:41], v3 offset:36032
    ds_read_b64_tr_b16 v[42:43], v3 offset:38592
    v_mfma_f32_32x32x16_bf16 v[224:239], v[20:23], v[168:171], v[224:239]
    s_setprio 2
    s_waitcnt lgkmcnt(6)
L_cg56:
    v_cmp_gt_u32 vcc, 896, v15
    s_cbranch_vccz L_cg56_ok
    s_add_u32 s3, s3, 1
    s_cmp_ge_u32 s3, 0x400000
    s_cbranch_scc1 L_cg56_ok
    ds_read_b32 v15, v0 offset:0
    s_waitcnt lgkmcnt(0)
    s_branch L_cg56
L_cg56_ok:
    s_setprio 0
    ds_read_b64_tr_b16 v[44:45], v3 offset:36096
    ds_read_b64_tr_b16 v[46:47], v3 offset:38656
    s_add_u32 s42, s65, 258048
    s_add_u32 s43, s65, 294912
    s_cmp_lt_u32 s36, 2
    s_cselect_b32 s43, s42, s43
    s_add_u32 m0, s63, 49152
    s_nop 0
    buffer_load_dwordx4 v6, s[8:11], s43 offen offset:0 lds
    buffer_load_dwordx4 v7, s[8:11], s43 offen offset:1024 lds
    s_setprio 2
    v_mfma_f32_32x32x16_bf16 v[240:255], v[24:27], v[168:171], v[240:255]
    s_setprio 0
    ds_read_b64_tr_b16 v[16:17], v3 offset:40960
    ds_read_b64_tr_b16 v[18:19], v3 offset:43520
    buffer_load_dwordx4 v8, s[8:11], s43 offen offset:2048 lds
    buffer_load_dwordx4 v9, s[8:11], s43 offen offset:3072 lds
    s_add_u32 m0, s63, 53248
    s_nop 0
    buffer_load_dwordx4 v10, s[8:11], s43 offen offset:0 lds
    v_mfma_f32_32x32x16_bf16 v[176:191], v[28:31], v[172:175], v[176:191]
    ds_read_b64_tr_b16 v[20:21], v3 offset:41024
    ds_read_b64_tr_b16 v[22:23], v3 offset:43584
    s_waitcnt lgkmcnt(8)
    v_mfma_f32_32x32x16_bf16 v[192:207], v[32:35], v[172:175], v[192:207]
    ds_read_b64_tr_b16 v[24:25], v3 offset:41088
    ds_read_b64_tr_b16 v[26:27], v3 offset:43648
    s_setprio 2
    v_mfma_f32_32x32x16_bf16 v[208:223], v[36:39], v[172:175], v[208:223]
    s_setprio 0
    ds_read_b64_tr_b16 v[28:29], v3 offset:41152
    ds_read_b64_tr_b16 v[30:31], v3 offset:43712
    s_waitcnt lgkmcnt(8)
    v_mfma_f32_32x32x16_bf16 v[224:239], v[40:43], v[172:175], v[224:239]
    ds_read_b64_tr_b16 v[32:33], v3 offset:41216
    ds_read_b64_tr_b16 v[34:35], v3 offset:43776
    v_mfma_f32_32x32x16_bf16 v[240:255], v[44:47], v[172:175], v[240:255]
    ds_read_b64_tr_b16 v[36:37], v3 offset:46080
    ds_read_b64_tr_b16 v[38:39], v3 offset:48640
    s_mov_b64 exec, 1
    ds_add_u32 v0, v0 offset:0
    s_mov_b64 exec, -1
    s_waitcnt lgkmcnt(9)
    s_setprio 2
    v_mfma_f32_32x32x16_bf16 v[176:191], v[16:19], v[112:115], v[176:191]
    s_setprio 0
    ds_read_b64_tr_b16 v[40:41], v3 offset:46144
    ds_read_b64_tr_b16 v[42:43], v3 offset:48704
    s_add_u32 s42, s76, 14336
    buffer_load_dwordx4 v[144:147], v11, s[24:27], s42 offen sc1
    buffer_load_dwordx4 v[148:151], v11, s[24:27], s42 offen offset:1024 sc1
    v_mfma_f32_32x32x16_bf16 v[192:207], v[20:23], v[112:115], v[192:207]
    ds_read_b64_tr_b16 v[44:45], v3 offset:46208
    ds_read_b64_tr_b16 v[46:47], v3 offset:48768
    s_add_u32 s42, s76, 16384
    buffer_load_dwordx4 v[152:155], v11, s[24:27], s42 offen sc1
    buffer_load_dwordx4 v[156:159], v11, s[24:27], s42 offen offset:1024 sc1
    s_waitcnt lgkmcnt(9)
    v_mfma_f32_32x32x16_bf16 v[208:223], v[24:27], v[112:115], v[208:223]
    ds_read_b64_tr_b16 v[16:17], v3 offset:46272
    ds_read_b64_tr_b16 v[18:19], v3 offset:48832
    s_add_u32 s42, s77, 14336
    buffer_load_dwordx4 v[160:163], v11, s[24:27], s42 offen sc1
    buffer_load_dwordx4 v[164:167], v11, s[24:27], s42 offen offset:1024 sc1
    s_setprio 2
    v_mfma_f32_32x32x16_bf16 v[224:239], v[28:31], v[112:115], v[224:239]
    s_setprio 0
    ds_read_b64_tr_b16 v[20:21], v3 offset:46336
    ds_read_b64_tr_b16 v[22:23], v3 offset:48896
    s_add_u32 s42, s77, 16384
    buffer_load_dwordx4 v[168:171], v11, s[24:27], s42 offen sc1
    buffer_load_dwordx4 v[172:175], v11, s[24:27], s42 offen offset:1024 sc1
    s_waitcnt lgkmcnt(9)
    v_mfma_f32_32x32x16_bf16 v[240:255], v[32:35], v[112:115], v[240:255]
    ds_read_b64_tr_b16 v[24:25], v3 offset:51200
    ds_read_b64_tr_b16 v[26:27], v3 offset:53760
    v_mfma_f32_32x32x16_bf16 v[176:191], v[36:39], v[116:119], v[176:191]
    ds_read_b64_tr_b16 v[28:29], v3 offset:51264
    ds_read_b64_tr_b16 v[30:31], v3 offset:53824
    s_waitcnt lgkmcnt(8)
    s_setprio 2
    v_mfma_f32_32x32x16_bf16 v[192:207], v[40:43], v[116:119], v[192:207]
    s_setprio 0
    ds_read_b64_tr_b16 v[32:33], v3 offset:51328
    ds_read_b64_tr_b16 v[34:35], v3 offset:53888
    v_mfma_f32_32x32x16_bf16 v[208:223], v[44:47], v[116:119], v[208:223]
    ds_read_b64_tr_b16 v[36:37], v3 offset:51392
    ds_read_b64_tr_b16 v[38:39], v3 offset:53952
    s_waitcnt lgkmcnt(8)
    v_mfma_f32_32x32x16_bf16 v[224:239], v[16:19], v[116:119], v[224:239]
    ds_read_b64_tr_b16 v[40:41], v3 offset:51456
    ds_read_b64_tr_b16 v[42:43], v3 offset:54016
    s_setprio 2
    v_mfma_f32_32x32x16_bf16 v[240:255], v[20:23], v[116:119], v[240:255]
    s_setprio 0
    ds_read_b64_tr_b16 v[44:45], v3 offset:56320
    ds_read_b64_tr_b16 v[46:47], v3 offset:58880
    s_waitcnt lgkmcnt(8)
    v_mfma_f32_32x32x16_bf16 v[176:191], v[24:27], v[120:123], v[176:191]
    ds_read_b32 v15, v0 offset:0
    ds_read_b64_tr_b16 v[16:17], v3 offset:56384
    ds_read_b64_tr_b16 v[18:19], v3 offset:58944
    s_add_u32 s42, s78, 14336
    buffer_load_dwordx4 v[112:115], v11, s[24:27], s42 offen sc1
    buffer_load_dwordx4 v[116:119], v11, s[24:27], s42 offen offset:1024 sc1
    v_mfma_f32_32x32x16_bf16 v[192:207], v[28:31], v[120:123], v[192:207]
    ds_read_b64_tr_b16 v[20:21], v3 offset:56448
    ds_read_b64_tr_b16 v[22:23], v3 offset:59008
    s_waitcnt lgkmcnt(9)
    s_setprio 2
    v_mfma_f32_32x32x16_bf16 v[208:223], v[32:35], v[120:123], v[208:223]
    s_setprio 0
    ds_read_b64_tr_b16 v[24:25], v3 offset:56512
    ds_read_b64_tr_b16 v[26:27], v3 offset:59072
    v_mfma_f32_32x32x16_bf16 v[224:239], v[36:39], v[120:123], v[224:239]
    s_setprio 2
    s_waitcnt lgkmcnt(6)
L_cg57:
    v_cmp_gt_u32 vcc, 912, v15
    s_cbranch_vccz L_cg57_ok
    s_add_u32 s3, s3, 1
    s_cmp_ge_u32 s3, 0x400000
    s_cbranch_scc1 L_cg57_ok
    ds_read_b32 v15, v0 offset:0
    s_waitcnt lgkmcnt(0)
    s_branch L_cg57
L_cg57_ok:
    s_setprio 0
    ds_read_b64_tr_b16 v[28:29], v3 offset:56576
    ds_read_b64_tr_b16 v[30:31], v3 offset:59136
    s_add_u32 s42, s66, 258048
    s_add_u32 s43, s66, 294912
    s_cmp_lt_u32 s36, 2
    s_cselect_b32 s43, s42, s43
    s_add_u32 m0, s63, 69632
    s_nop 0
    buffer_load_dwordx4 v6, s[8:11], s43 offen offset:0 lds
    buffer_load_dwordx4 v7, s[8:11], s43 offen offset:1024 lds
    v_mfma_f32_32x32x16_bf16 v[240:255], v[40:43], v[120:123], v[240:255]
    ds_read_b64_tr_b16 v[32:33], v2 offset:0
    ds_read_b64_tr_b16 v[34:35], v2 offset:2560
    buffer_load_dwordx4 v8, s[8:11], s43 offen offset:2048 lds
    buffer_load_dwordx4 v9, s[8:11], s43 offen offset:3072 lds
    s_add_u32 m0, s63, 73728
    s_nop 0
    buffer_load_dwordx4 v10, s[8:11], s43 offen offset:0 lds
    s_setprio 2
    v_mfma_f32_32x32x16_bf16 v[176:191], v[44:47], v[124:127], v[176:191]
    s_setprio 0
    ds_read_b64_tr_b16 v[36:37], v2 offset:64
    ds_read_b64_tr_b16 v[38:39], v2 offset:2624
    s_waitcnt lgkmcnt(8)
    v_mfma_f32_32x32x16_bf16 v[192:207], v[16:19], v[124:127], v[192:207]
    ds_read_b64_tr_b16 v[40:41], v2 offset:128
    ds_read_b64_tr_b16 v[42:43], v2 offset:2688
    v_mfma_f32_32x32x16_bf16 v[208:223], v[20:23], v[124:127], v[208:223]
    ds_read_b64_tr_b16 v[44:45], v2 offset:192
    ds_read_b64_tr_b16 v[46:47], v2 offset:2752
    s_waitcnt lgkmcnt(8)
    s_setprio 2
    v_mfma_f32_32x32x16_bf16 v[224:239], v[24:27], v[124:127], v[224:239]
    s_setprio 0
    ds_read_b64_tr_b16 v[16:17], v2 offset:256
    ds_read_b64_tr_b16 v[18:19], v2 offset:2816
    v_mfma_f32_32x32x16_bf16 v[240:255], v[28:31], v[124:127], v[240:255]
    ds_read_b64_tr_b16 v[20:21], v2 offset:5120
    ds_read_b64_tr_b16 v[22:23], v2 offset:7680
    s_waitcnt vmcnt(20)
    s_mov_b64 exec, 1
    ds_add_u32 v0, v0 offset:0
    s_mov_b64 exec, -1
    s_waitcnt lgkmcnt(9)
    v_mfma_f32_32x32x16_bf16 v[176:191], v[32:35], v[128:131], v[176:191]
    ds_read_b64_tr_b16 v[24:25], v2 offset:5184
    ds_read_b64_tr_b16 v[26:27], v2 offset:7744
    s_add_u32 s42, s78, 16384
    buffer_load_dwordx4 v[120:123], v11, s[24:27], s42 offen sc1
    buffer_load_dwordx4 v[124:127], v11, s[24:27], s42 offen offset:1024 sc1
    s_setprio 2
    v_mfma_f32_32x32x16_bf16 v[192:207], v[36:39], v[128:131], v[192:207]
    s_setprio 0
    ds_read_b64_tr_b16 v[28:29], v2 offset:5248
    ds_read_b64_tr_b16 v[30:31], v2 offset:7808
    s_waitcnt lgkmcnt(9)
    v_mfma_f32_32x32x16_bf16 v[208:223], v[40:43], v[128:131], v[208:223]
    ds_read_b64_tr_b16 v[32:33], v2 offset:5312
    ds_read_b64_tr_b16 v[34:35], v2 offset:7872
    v_mfma_f32_32x32x16_bf16 v[224:239], v[44:47], v[128:131], v[224:239]
    ds_read_b64_tr_b16 v[36:37], v2 offset:5376
    ds_read_b64_tr_b16 v[38:39], v2 offset:7936
    s_waitcnt lgkmcnt(9)
    s_setprio 2
    v_mfma_f32_32x32x16_bf16 v[240:255], v[16:19], v[128:131], v[240:255]
    s_setprio 0
    ds_read_b64_tr_b16 v[40:41], v2 offset:10240
    ds_read_b64_tr_b16 v[42:43], v2 offset:12800
    v_mfma_f32_32x32x16_bf16 v[176:191], v[20:23], v[132:135], v[176:191]
    ds_read_b64_tr_b16 v[44:45], v2 offset:10304
    ds_read_b64_tr_b16 v[46:47], v2 offset:12864
    s_waitcnt lgkmcnt(8)
    v_mfma_f32_32x32x16_bf16 v[192:207], v[24:27], v[132:135], v[192:207]
    ds_read_b64_tr_b16 v[16:17], v2 offset:10368
    ds_read_b64_tr_b16 v[18:19], v2 offset:12928
    s_setprio 2
    v_mfma_f32_32x32x16_bf16 v[208:223], v[28:31], v[132:135], v[208:223]
    s_setprio 0
    ds_read_b64_tr_b16 v[20:21], v2 offset:10432
    ds_read_b64_tr_b16 v[22:23], v2 offset:12992
    s_waitcnt lgkmcnt(8)
    v_mfma_f32_32x32x16_bf16 v[224:239], v[32:35], v[132:135], v[224:239]
    ds_read_b64_tr_b16 v[24:25], v2 offset:10496
    ds_read_b64_tr_b16 v[26:27], v2 offset:13056
    v_mfma_f32_32x32x16_bf16 v[240:255], v[36:39], v[132:135], v[240:255]
    ds_read_b64_tr_b16 v[28:29], v2 offset:15360
    ds_read_b64_tr_b16 v[30:31], v2 offset:17920
    s_waitcnt lgkmcnt(8)
    s_setprio 2
    v_mfma_f32_32x32x16_bf16 v[176:191], v[40:43], v[136:139], v[176:191]
    s_setprio 0
    ds_read_b32 v15, v0 offset:0
    ds_read_b64_tr_b16 v[32:33], v2 offset:15424
    ds_read_b64_tr_b16 v[34:35], v2 offset:17984
    s_add_u32 s42, s79, 14336
    buffer_load_dwordx4 v[128:131], v11, s[24:27], s42 offen sc1
    buffer_load_dwordx4 v[132:135], v11, s[24:27], s42 offen offset:1024 sc1
    v_mfma_f32_32x32x16_bf16 v[192:207], v[44:47], v[136:139], v[192:207]
    ds_read_b64_tr_b16 v[36:37], v2 offset:15488
    ds_read_b64_tr_b16 v[38:39], v2 offset:18048
    s_waitcnt lgkmcnt(9)
    v_mfma_f32_32x32x16_bf16 v[208:223], v[16:19], v[136:139], v[208:223]
    ds_read_b64_tr_b16 v[40:41], v2 offset:15552
    ds_read_b64_tr_b16 v[42:43], v2 offset:18112
    s_setprio 2
    v_mfma_f32_32x32x16_bf16 v[224:239], v[20:23], v[136:139], v[224:239]
    s_setprio 0
    s_setprio 2
    s_waitcnt lgkmcnt(6)
L_cg58:
    v_cmp_gt_u32 vcc, 928, v15
    s_cbranch_vccz L_cg58_ok
    s_add_u32 s3, s3, 1
    s_cmp_ge_u32 s3, 0x400000
    s_cbranch_scc1 L_cg58_ok
    ds_read_b32 v15, v0 offset:0
    s_waitcnt lgkmcnt(0)
    s_branch L_cg58
L_cg58_ok:
    s_setprio 0
    s_setprio 2
    s_cmp_lg_u32 s36, 0
    s_cbranch_scc1 L_g_nocl
    v_mov_b32 v13, s61
    v_mov_b32 v14, s60
    v_cmp_gt_u32 vcc, 4, v1
    s_nop 1
    v_cndmask_b32 v14, v13, v14, vcc
    v_mul_u32_u24 v13, 512, v1
    s_mov_b64 exec, 0xf0
    v_subrev_u32 v13, 2032, v13
    s_mov_b64 exec, 0xff
    buffer_store_dword v14, v13, s[28:31], s62 offen sc1
    s_mov_b64 exec, -1
L_g_nocl:
    ds_read_b64_tr_b16 v[44:45], v2 offset:15616
    ds_read_b64_tr_b16 v[46:47], v2 offset:18176
    s_add_u32 s42, s67, 258048
    s_add_u32 s43, s67, 294912
    s_cmp_lt_u32 s36, 2
    s_cselect_b32 s43, s42, s43
    s_add_u32 m0, s63, 90112
    s_nop 0
    buffer_load_dwordx4 v6, s[8:11], s43 offen offset:0 lds
    buffer_load_dwordx4 v7, s[8:11], s43 offen offset:1024 lds
    s_setprio 0
    v_mfma_f32_32x32x16_bf16 v[240:255], v[24:27], v[136:139], v[240:255]
    ds_read_b64_tr_b16 v[16:17], v2 offset:20480
    ds_read_b64_tr_b16 v[18:19], v2 offset:23040
    buffer_load_dwordx4 v8, s[8:11], s43 offen offset:2048 lds
    buffer_load_dwordx4 v9, s[8:11], s43 offen offset:3072 lds
    s_add_u32 m0, s63, 94208
    s_nop 0
    buffer_load_dwordx4 v10, s[8:11], s43 offen offset:0 lds
    v_mfma_f32_32x32x16_bf16 v[176:191], v[28:31], v[140:143], v[176:191]
    ds_read_b64_tr_b16 v[20:21], v2 offset:20544
    ds_read_b64_tr_b16 v[22:23], v2 offset:23104
    s_lshl_b32 s40, s37, 2
    s_add_u32 s40, s40, s73
    s_mul_i32 s47, s40, 36864
    s_mul_i32 s41, s74, 288
    s_add_u32 s47, s47, s41
    s_lshl_b32 s40, s36, 5
    s_add_u32 s16, s47, s40
    s_add_u32 s17, s16, 128
    s_add_u32 s18, s47, 256
    s_add_u32 s19, s18, 18432
    s_waitcnt lgkmcnt(8)
    s_setprio 2
    v_mfma_f32_32x32x16_bf16 v[192:207], v[32:35], v[140:143], v[192:207]
    s_setprio 0
    ds_read_b64_tr_b16 v[24:25], v2 offset:20608
    ds_read_b64_tr_b16 v[26:27], v2 offset:23168
    s_setprio 2
    v_and_b32 v4, 31, v1
    v_mul_u32_u24 v4, 1152, v4
    v_lshrrev_b32 v5, 5, v1
    v_lshl_add_u32 v5, v5, 3, v4
    s_setprio 0
    v_mfma_f32_32x32x16_bf16 v[208:223], v[36:39], v[140:143], v[208:223]
    ds_read_b64_tr_b16 v[28:29], v2 offset:20672
    ds_read_b64_tr_b16 v[30:31], v2 offset:23232
    buffer_load_dwordx2 v[64:65], v5, s[4:7], s16 offen offset:0
    s_waitcnt lgkmcnt(8)
    v_mfma_f32_32x32x16_bf16 v[224:239], v[40:43], v[140:143], v[224:239]
    ds_read_b64_tr_b16 v[32:33], v2 offset:20736
    ds_read_b64_tr_b16 v[34:35], v2 offset:23296
    buffer_load_dwordx2 v[66:67], v5, s[4:7], s16 offen offset:16
    s_setprio 2
    v_mfma_f32_32x32x16_bf16 v[240:255], v[44:47], v[140:143], v[240:255]
    s_setprio 0
    ds_read_b64_tr_b16 v[36:37], v2 offset:25600
    ds_read_b64_tr_b16 v[38:39], v2 offset:28160
    buffer_load_dwordx2 v[68:69], v5, s[4:7], s17 offen offset:0
    buffer_load_dwordx2 v[70:71], v5, s[4:7], s17 offen offset:16
    buffer_load_dwordx2 v[72:73], v5, s[4:7], s18 offen offset:0
    buffer_load_dwordx2 v[74:75], v5, s[4:7], s18 offen offset:16
    s_waitcnt vmcnt(30)
    s_mov_b64 exec, 1
    ds_add_u32 v0, v0 offset:0
    s_mov_b64 exec, -1
    s_waitcnt vmcnt(28)
    s_waitcnt lgkmcnt(9)
    v_mfma_f32_32x32x16_bf16 v[176:191], v[16:19], v[144:147], v[176:191]
    ds_read_b64_tr_b16 v[40:41], v2 offset:25664
    ds_read_b64_tr_b16 v[42:43], v2 offset:28224
    s_add_u32 s42, s79, 16384
    buffer_load_dwordx4 v[136:139], v11, s[24:27], s42 offen sc1
    buffer_load_dwordx4 v[140:143], v11, s[24:27], s42 offen offset:1024 sc1
    v_mfma_f32_32x32x16_bf16 v[192:207], v[20:23], v[144:147], v[192:207]
    ds_read_b64_tr_b16 v[44:45], v2 offset:25728
    ds_read_b64_tr_b16 v[46:47], v2 offset:28288
    s_waitcnt lgkmcnt(9)
    s_setprio 2
    v_mfma_f32_32x32x16_bf16 v[208:223], v[24:27], v[144:147], v[208:223]
    s_setprio 0
    ds_read_b64_tr_b16 v[16:17], v2 offset:25792
    ds_read_b64_tr_b16 v[18:19], v2 offset:28352
    v_mfma_f32_32x32x16_bf16 v[224:239], v[28:31], v[144:147], v[224:239]
    ds_read_b64_tr_b16 v[20:21], v2 offset:25856
    ds_read_b64_tr_b16 v[22:23], v2 offset:28416
    s_waitcnt lgkmcnt(9)
    v_mfma_f32_32x32x16_bf16 v[240:255], v[32:35], v[144:147], v[240:255]
    ds_read_b64_tr_b16 v[24:25], v2 offset:30720
    ds_read_b64_tr_b16 v[26:27], v2 offset:33280
    s_setprio 2
    v_mfma_f32_32x32x16_bf16 v[176:191], v[36:39], v[148:151], v[176:191]
    s_setprio 0
    ds_read_b64_tr_b16 v[28:29], v2 offset:30784
    ds_read_b64_tr_b16 v[30:31], v2 offset:33344
    s_waitcnt lgkmcnt(8)
    v_mfma_f32_32x32x16_bf16 v[192:207], v[40:43], v[148:151], v[192:207]
    ds_read_b64_tr_b16 v[32:33], v2 offset:30848
    ds_read_b64_tr_b16 v[34:35], v2 offset:33408
    v_mfma_f32_32x32x16_bf16 v[208:223], v[44:47], v[148:151], v[208:223]
    ds_read_b64_tr_b16 v[36:37], v2 offset:30912
    ds_read_b64_tr_b16 v[38:39], v2 offset:33472
    s_waitcnt lgkmcnt(8)
    s_setprio 2
    v_mfma_f32_32x32x16_bf16 v[224:239], v[16:19], v[148:151], v[224:239]
    s_setprio 0
    ds_read_b64_tr_b16 v[40:41], v2 offset:30976
    ds_read_b64_tr_b16 v[42:43], v2 offset:33536
    v_mfma_f32_32x32x16_bf16 v[240:255], v[20:23], v[148:151], v[240:255]
    ds_read_b64_tr_b16 v[44:45], v2 offset:35840
    ds_read_b64_tr_b16 v[46:47], v2 offset:38400
    s_waitcnt vmcnt(28)
    s_waitcnt lgkmcnt(8)
    v_mfma_f32_32x32x16_bf16 v[176:191], v[24:27], v[152:155], v[176:191]
    ds_read_b32 v15, v0 offset:0
    ds_read_b64_tr_b16 v[16:17], v2 offset:35904
    ds_read_b64_tr_b16 v[18:19], v2 offset:38464
    s_setprio 2
    v_mfma_f32_32x32x16_bf16 v[192:207], v[28:31], v[152:155], v[192:207]
    s_setprio 0
    ds_read_b64_tr_b16 v[20:21], v2 offset:35968
    ds_read_b64_tr_b16 v[22:23], v2 offset:38528
    s_waitcnt lgkmcnt(9)
    v_mfma_f32_32x32x16_bf16 v[208:223], v[32:35], v[152:155], v[208:223]
    ds_read_b64_tr_b16 v[24:25], v2 offset:36032
    ds_read_b64_tr_b16 v[26:27], v2 offset:38592
    v_mfma_f32_32x32x16_bf16 v[224:239], v[36:39], v[152:155], v[224:239]
    s_setprio 2
    s_waitcnt lgkmcnt(6)
L_cg59:
    v_cmp_gt_u32 vcc, 944, v15
    s_cbranch_vccz L_cg59_ok
    s_add_u32 s3, s3, 1
    s_cmp_ge_u32 s3, 0x400000
    s_cbranch_scc1 L_cg59_ok
    ds_read_b32 v15, v0 offset:0
    s_waitcnt lgkmcnt(0)
    s_branch L_cg59
L_cg59_ok:
    s_setprio 0
    ds_read_b64_tr_b16 v[28:29], v2 offset:36096
    ds_read_b64_tr_b16 v[30:31], v2 offset:38656
    s_add_u32 s42, s75, 0
    s_add_u32 s43, s75, 41472
    s_cmp_lt_u32 s36, 2
    s_cselect_b32 s43, s42, s43
    s_add_u32 m0, s63, 0
    s_nop 0
    buffer_load_dwordx4 v6, s[20:23], s43 offen offset:0 lds
    buffer_load_dwordx4 v7, s[20:23], s43 offen offset:1024 lds
    s_setprio 2
    v_mfma_f32_32x32x16_bf16 v[240:255], v[40:43], v[152:155], v[240:255]
    s_setprio 0
    ds_read_b64_tr_b16 v[32:33], v3 offset:0
    ds_read_b64_tr_b16 v[34:35], v3 offset:2560
    buffer_load_dwordx4 v8, s[20:23], s43 offen offset:2048 lds
    buffer_load_dwordx4 v9, s[20:23], s43 offen offset:3072 lds
    s_add_u32 m0, s63, 4096
    s_nop 0
    buffer_load_dwordx4 v10, s[20:23], s43 offen offset:0 lds
    v_mfma_f32_32x32x16_bf16 v[176:191], v[44:47], v[156:159], v[176:191]
    ds_read_b64_tr_b16 v[36:37], v3 offset:64
    ds_read_b64_tr_b16 v[38:39], v3 offset:2624
    s_setprio 2
    v_and_b32 v14, 7, v1
    v_lshlrev_b32 v14, 2, v14
    s_setprio 0
    buffer_load_dword v13, v14, s[28:31], s44 offen offset:64 sc1
    s_waitcnt lgkmcnt(8)
    v_mfma_f32_32x32x16_bf16 v[192:207], v[16:19], v[156:159], v[192:207]
    ds_read_b64_tr_b16 v[40:41], v3 offset:128
    ds_read_b64_tr_b16 v[42:43], v3 offset:2688
    s_setprio 2
    v_mfma_f32_32x32x16_bf16 v[208:223], v[20:23], v[156:159], v[208:223]
    s_setprio 0
    ds_read_b64_tr_b16 v[44:45], v3 offset:192
    ds_read_b64_tr_b16 v[46:47], v3 offset:2752
    s_waitcnt lgkmcnt(8)
    v_mfma_f32_32x32x16_bf16 v[224:239], v[24:27], v[156:159], v[224:239]
    ds_read_b64_tr_b16 v[16:17], v3 offset:256
    ds_read_b64_tr_b16 v[18:19], v3 offset:2816
    v_mfma_f32_32x32x16_bf16 v[240:255], v[28:31], v[156:159], v[240:255]
    ds_read_b64_tr_b16 v[20:21], v3 offset:5120
    ds_read_b64_tr_b16 v[22:23], v3 offset:7680
    s_waitcnt vmcnt(23)
    s_mov_b64 exec, 1
    ds_add_u32 v0, v0 offset:0
    s_mov_b64 exec, -1
    s_waitcnt lgkmcnt(9)
    s_setprio 2
    v_mfma_f32_32x32x16_bf16 v[176:191], v[32:35], v[160:163], v[176:191]
    s_setprio 0
    ds_read_b64_tr_b16 v[24:25], v3 offset:5184
    ds_read_b64_tr_b16 v[26:27], v3 offset:7744
    v_mfma_f32_32x32x16_bf16 v[192:207], v[36:39], v[160:163], v[192:207]
    ds_read_b64_tr_b16 v[28:29], v3 offset:5248
    ds_read_b64_tr_b16 v[30:31], v3 offset:7808
    s_waitcnt lgkmcnt(9)
    v_mfma_f32_32x32x16_bf16 v[208:223], v[40:43], v[160:163], v[208:223]
    ds_read_b64_tr_b16 v[32:33], v3 offset:5312
    ds_read_b64_tr_b16 v[34:35], v3 offset:7872
    s_setprio 2
    v_mfma_f32_32x32x16_bf16 v[224:239], v[44:47], v[160:163], v[224:239]
    s_setprio 0
    ds_read_b64_tr_b16 v[36:37], v3 offset:5376
    ds_read_b64_tr_b16 v[38:39], v3 offset:7936
    s_waitcnt lgkmcnt(9)
    v_mfma_f32_32x32x16_bf16 v[240:255], v[16:19], v[160:163], v[240:255]
    ds_read_b64_tr_b16 v[40:41], v3 offset:10240
    ds_read_b64_tr_b16 v[42:43], v3 offset:12800
    v_mfma_f32_32x32x16_bf16 v[176:191], v[20:23], v[164:167], v[176:191]
    ds_read_b64_tr_b16 v[44:45], v3 offset:10304
    ds_read_b64_tr_b16 v[46:47], v3 offset:12864
    s_waitcnt lgkmcnt(8)
    s_setprio 2
    v_mfma_f32_32x32x16_bf16 v[192:207], v[24:27], v[164:167], v[192:207]
    s_setprio 0
    ds_read_b64_tr_b16 v[16:17], v3 offset:10368
    ds_read_b64_tr_b16 v[18:19], v3 offset:12928
    v_mfma_f32_32x32x16_bf16 v[208:223], v[28:31], v[164:167], v[208:223]
    ds_read_b64_tr_b16 v[20:21], v3 offset:10432
    ds_read_b64_tr_b16 v[22:23], v3 offset:12992
    s_waitcnt lgkmcnt(8)
    v_mfma_f32_32x32x16_bf16 v[224:239], v[32:35], v[164:167], v[224:239]
    ds_read_b64_tr_b16 v[24:25], v3 offset:10496
    ds_read_b64_tr_b16 v[26:27], v3 offset:13056
    s_setprio 2
    v_mfma_f32_32x32x16_bf16 v[240:255], v[36:39], v[164:167], v[240:255]
    s_setprio 0
    ds_read_b64_tr_b16 v[28:29], v3 offset:15360
    ds_read_b64_tr_b16 v[30:31], v3 offset:17920
    s_waitcnt lgkmcnt(8)
    v_mfma_f32_32x32x16_bf16 v[176:191], v[40:43], v[168:171], v[176:191]
    ds_read_b32 v15, v0 offset:0
    ds_read_b64_tr_b16 v[32:33], v3 offset:15424
    ds_read_b64_tr_b16 v[34:35], v3 offset:17984
    v_mfma_f32_32x32x16_bf16 v[192:207], v[44:47], v[168:171], v[192:207]
    ds_read_b64_tr_b16 v[36:37], v3 offset:15488
    ds_read_b64_tr_b16 v[38:39], v3 offset:18048
    s_waitcnt lgkmcnt(9)
    s_setprio 2
    v_mfma_f32_32x32x16_bf16 v[208:223], v[16:19], v[168:171], v[208:223]
    s_setprio 0
    ds_read_b64_tr_b16 v[40:41], v3 offset:15552
    ds_read_b64_tr_b16 v[42:43], v3 offset:18112
    v_mfma_f32_32x32x16_bf16 v[224:239], v[20:23], v[168:171], v[224:239]
    s_setprio 2
    s_waitcnt lgkmcnt(6)
L_cg60:
    v_cmp_gt_u32 vcc, 960, v15
    s_cbranch_vccz L_cg60_ok
    s_add_u32 s3, s3, 1
    s_cmp_ge_u32 s3, 0x400000
    s_cbranch_scc1 L_cg60_ok
    ds_read_b32 v15, v0 offset:0
    s_waitcnt lgkmcnt(0)
    s_branch L_cg60
L_cg60_ok:
    s_setprio 0
    ds_read_b64_tr_b16 v[44:45], v3 offset:15616
    ds_read_b64_tr_b16 v[46:47], v3 offset:18176
    s_add_u32 s42, s75, 82944
    s_add_u32 s43, s75, 124416
    s_cmp_lt_u32 s36, 2
    s_cselect_b32 s43, s42, s43
    s_add_u32 m0, s63, 20480
    s_nop 0
    buffer_load_dwordx4 v6, s[20:23], s43 offen offset:0 lds
    buffer_load_dwordx4 v7, s[20:23], s43 offen offset:1024 lds
    v_mfma_f32_32x32x16_bf16 v[240:255], v[24:27], v[168:171], v[240:255]
    ds_read_b64_tr_b16 v[16:17], v3 offset:20480
    ds_read_b64_tr_b16 v[18:19], v3 offset:23040
    buffer_load_dwordx4 v8, s[20:23], s43 offen offset:2048 lds
    buffer_load_dwordx4 v9, s[20:23], s43 offen offset:3072 lds
    s_add_u32 m0, s63, 24576
    s_nop 0
    buffer_load_dwordx4 v10, s[20:23], s43 offen offset:0 lds
    s_setprio 2
    v_mfma_f32_32x32x16_bf16 v[176:191], v[28:31], v[172:175], v[176:191]
    s_setprio 0
    ds_read_b64_tr_b16 v[20:21], v3 offset:20544
    ds_read_b64_tr_b16 v[22:23], v3 offset:23104
    s_waitcnt lgkmcnt(8)
    v_mfma_f32_32x32x16_bf16 v[192:207], v[32:35], v[172:175], v[192:207]
    ds_read_b64_tr_b16 v[24:25], v3 offset:20608
    ds_read_b64_tr_b16 v[26:27], v3 offset:23168
    v_mfma_f32_32x32x16_bf16 v[208:223], v[36:39], v[172:175], v[208:223]
    ds_read_b64_tr_b16 v[28:29], v3 offset:20672
    ds_read_b64_tr_b16 v[30:31], v3 offset:23232
    s_waitcnt lgkmcnt(8)
    s_setprio 2
    v_mfma_f32_32x32x16_bf16 v[224:239], v[40:43], v[172:175], v[224:239]
    s_setprio 0
    ds_read_b64_tr_b16 v[32:33], v3 offset:20736
    ds_read_b64_tr_b16 v[34:35], v3 offset:23296
    v_mfma_f32_32x32x16_bf16 v[240:255], v[44:47], v[172:175], v[240:255]
    ds_read_b64_tr_b16 v[36:37], v3 offset:25600
    ds_read_b64_tr_b16 v[38:39], v3 offset:28160
    s_waitcnt vmcnt(19)
    s_setprio 2
    s_waitcnt vmcnt(5)
    s_cmp_lg_u32 s36, 0
    s_cbranch_scc1 L_o_ok
L_o_chk:
    v_cmp_ne_u32 s[40:41], s60, v13
    v_cmp_ne_u32 vcc, s61, v13
    s_nop 0
    s_and_b32 s40, s40, 0x0f
    s_and_b32 s41, vcc_lo, 0xf0
    s_or_b32 s40, s40, s41
    s_cbranch_scc0 L_o_ok
    s_add_u32 s3, s3, 16
    s_cmp_ge_u32 s3, 0x400000
    s_cbranch_scc1 L_o_ok
    s_sleep 4
    buffer_load_dword v13, v14, s[28:31], s44 offen offset:64 sc1
    s_waitcnt vmcnt(0)
    s_branch L_o_chk
L_o_ok:
    s_mov_b64 exec, 1
    ds_add_u32 v0, v0 offset:0
    s_mov_b64 exec, -1
    s_waitcnt lgkmcnt(9)
    s_setprio 0
    v_mfma_f32_32x32x16_bf16 v[176:191], v[16:19], v[112:115], v[176:191]
    ds_read_b64_tr_b16 v[40:41], v3 offset:25664
    ds_read_b64_tr_b16 v[42:43], v3 offset:28224
    s_setprio 2
    v_mfma_f32_32x32x16_bf16 v[192:207], v[20:23], v[112:115], v[192:207]
    s_setprio 0
    ds_read_b64_tr_b16 v[44:45], v3 offset:25728
    ds_read_b64_tr_b16 v[46:47], v3 offset:28288
    s_waitcnt lgkmcnt(9)
    v_mfma_f32_32x32x16_bf16 v[208:223], v[24:27], v[112:115], v[208:223]
    ds_read_b64_tr_b16 v[16:17], v3 offset:25792
    ds_read_b64_tr_b16 v[18:19], v3 offset:28352
    v_mfma_f32_32x32x16_bf16 v[224:239], v[28:31], v[112:115], v[224:239]
    ds_read_b64_tr_b16 v[20:21], v3 offset:25856
    ds_read_b64_tr_b16 v[22:23], v3 offset:28416
    s_waitcnt lgkmcnt(9)
    s_setprio 2
    v_mfma_f32_32x32x16_bf16 v[240:255], v[32:35], v[112:115], v[240:255]
    s_setprio 0
    ds_read_b64_tr_b16 v[24:25], v3 offset:30720
    ds_read_b64_tr_b16 v[26:27], v3 offset:33280
    v_mfma_f32_32x32x16_bf16 v[176:191], v[36:39], v[116:119], v[176:191]
    ds_read_b64_tr_b16 v[28:29], v3 offset:30784
    ds_read_b64_tr_b16 v[30:31], v3 offset:33344
    s_waitcnt lgkmcnt(8)
    v_mfma_f32_32x32x16_bf16 v[192:207], v[40:43], v[116:119], v[192:207]
    ds_read_b64_tr_b16 v[32:33], v3 offset:30848
    ds_read_b64_tr_b16 v[34:35], v3 offset:33408
    s_setprio 2
    v_mfma_f32_32x32x16_bf16 v[208:223], v[44:47], v[116:119], v[208:223]
    s_setprio 0
    ds_read_b64_tr_b16 v[36:37], v3 offset:30912
    ds_read_b64_tr_b16 v[38:39], v3 offset:33472
    s_waitcnt lgkmcnt(8)
    v_mfma_f32_32x32x16_bf16 v[224:239], v[16:19], v[116:119], v[224:239]
    ds_read_b64_tr_b16 v[40:41], v3 offset:30976
    ds_read_b64_tr_b16 v[42:43], v3 offset:33536
    v_mfma_f32_32x32x16_bf16 v[240:255], v[20:23], v[116:119], v[240:255]
    ds_read_b64_tr_b16 v[44:45], v3 offset:35840
    ds_read_b64_tr_b16 v[46:47], v3 offset:38400
    s_waitcnt lgkmcnt(8)
    s_setprio 2
    v_mfma_f32_32x32x16_bf16 v[176:191], v[24:27], v[120:123], v[176:191]
    s_setprio 0
    ds_read_b32 v15, v0 offset:0
    ds_read_b64_tr_b16 v[16:17], v3 offset:35904
    ds_read_b64_tr_b16 v[18:19], v3 offset:38464
    v_mfma_f32_32x32x16_bf16 v[192:207], v[28:31], v[120:123], v[192:207]
    ds_read_b64_tr_b16 v[20:21], v3 offset:35968
    ds_read_b64_tr_b16 v[22:23], v3 offset:38528
    s_waitcnt lgkmcnt(9)
    v_mfma_f32_32x32x16_bf16 v[208:223], v[32:35], v[120:123], v[208:223]
    ds_read_b64_tr_b16 v[24:25], v3 offset:36032
    ds_read_b64_tr_b16 v[26:27], v3 offset:38592
    s_setprio 2
    v_mfma_f32_32x32x16_bf16 v[224:239], v[36:39], v[120:123], v[224:239]
    s_setprio 0
    s_setprio 2
    s_waitcnt lgkmcnt(6)
L_cg61:
    v_cmp_gt_u32 vcc, 976, v15
    s_cbranch_vccz L_cg61_ok
    s_add_u32 s3, s3, 1
    s_cmp_ge_u32 s3, 0x400000
    s_cbranch_scc1 L_cg61_ok
    ds_read_b32 v15, v0 offset:0
    s_waitcnt lgkmcnt(0)
    s_branch L_cg61
L_cg61_ok:
    s_setprio 0
    ds_read_b64_tr_b16 v[28:29], v3 offset:36096
    ds_read_b64_tr_b16 v[30:31], v3 offset:38656
    s_mov_b32 s56, 4096
    s_mov_b32 s41, 13421773
    s_setprio 2
    v_add_u32 v13, 0, v11
    v_mul_hi_u32 v14, v13, s41
    v_lshrrev_b32 v14, 1, v14
    v_mul_u32_u24 v14, 18432, v14
    v_add_u32 v6, v6, v14
    s_setprio 0
    v_mfma_f32_32x32x16_bf16 v[240:255], v[40:43], v[120:123], v[240:255]
    ds_read_b64_tr_b16 v[32:33], v3 offset:40960
    ds_read_b64_tr_b16 v[34:35], v3 offset:43520
    s_mov_b32 s56, 3072
    s_mov_b32 s41, 13421773
    s_setprio 2
    v_add_u32 v13, 1024, v11
    v_mul_hi_u32 v14, v13, s41
    v_lshrrev_b32 v14, 1, v14
    v_mul_u32_u24 v14, 18432, v14
    v_add_u32 v7, v7, v14
    s_setprio 0
    v_mfma_f32_32x32x16_bf16 v[176:191], v[44:47], v[124:127], v[176:191]
    ds_read_b64_tr_b16 v[36:37], v3 offset:41024
    ds_read_b64_tr_b16 v[38:39], v3 offset:43584
    s_mov_b32 s56, 2048
    s_mov_b32 s41, 13421773
    s_setprio 2
    v_add_u32 v13, 2048, v11
    v_mul_hi_u32 v14, v13, s41
    v_lshrrev_b32 v14, 1, v14
    v_mul_u32_u24 v14, 18432, v14
    v_add_u32 v8, v8, v14
    s_setprio 0
    s_waitcnt lgkmcnt(8)
    s_setprio 2
    v_mfma_f32_32x32x16_bf16 v[192:207], v[16:19], v[124:127], v[192:207]
    s_setprio 0
    ds_read_b64_tr_b16 v[40:41], v3 offset:41088
    ds_read_b64_tr_b16 v[42:43], v3 offset:43648
    s_mov_b32 s56, 1024
    s_mov_b32 s41, 13421773
    s_setprio 2
    v_add_u32 v13, 3072, v11
    v_mul_hi_u32 v14, v13, s41
    v_lshrrev_b32 v14, 1, v14
    v_mul_u32_u24 v14, 18432, v14
    v_add_u32 v9, v9, v14
    s_setprio 0
    v_mfma_f32_32x32x16_bf16 v[208:223], v[20:23], v[124:127], v[208:223]
    ds_read_b64_tr_b16 v[44:45], v3 offset:41152
    ds_read_b64_tr_b16 v[46:47], v3 offset:43712
    s_mov_b32 s56, 4096
    s_mov_b32 s41, 13421773
    s_setprio 2
    v_add_u32 v13, 4096, v11
    v_mul_hi_u32 v14, v13, s41
    v_lshrrev_b32 v14, 1, v14
    v_mul_u32_u24 v14, 18432, v14
    v_add_u32 v10, v10, v14
    s_setprio 0
    s_waitcnt lgkmcnt(8)
    v_mfma_f32_32x32x16_bf16 v[224:239], v[24:27], v[124:127], v[224:239]
    ds_read_b64_tr_b16 v[16:17], v3 offset:41216
    ds_read_b64_tr_b16 v[18:19], v3 offset:43776
    s_mov_b32 s42, s72
    s_mov_b32 s43, s72
    s_cmp_lt_u32 s36, 2
    s_cselect_b32 s43, s42, s43
    s_add_u32 m0, s63, 49152
    s_nop 0
    buffer_load_dwordx4 v6, s[20:23], s43 offen offset:0 lds
    buffer_load_dwordx4 v7, s[20:23], s43 offen offset:1024 lds
    s_setprio 2
    v_mfma_f32_32x32x16_bf16 v[240:255], v[28:31], v[124:127], v[240:255]
    s_setprio 0
    ds_read_b64_tr_b16 v[20:21], v3 offset:46080
    ds_read_b64_tr_b16 v[22:23], v3 offset:48640
    buffer_load_dwordx4 v8, s[20:23], s43 offen offset:2048 lds
    buffer_load_dwordx4 v9, s[20:23], s43 offen offset:3072 lds
    s_add_u32 m0, s63, 53248
    s_nop 0
    buffer_load_dwordx4 v10, s[20:23], s43 offen offset:0 lds
    s_mov_b64 exec, 1
    ds_add_u32 v0, v0 offset:0
    s_mov_b64 exec, -1
    s_waitcnt lgkmcnt(9)
    v_mfma_f32_32x32x16_bf16 v[176:191], v[32:35], v[128:131], v[176:191]
    ds_read_b64_tr_b16 v[24:25], v3 offset:46144
    ds_read_b64_tr_b16 v[26:27], v3 offset:48704
    s_add_u32 s42, s48, 0
    buffer_load_dwordx4 v[144:147], v11, s[24:27], s42 offen sc1
    buffer_load_dwordx4 v[148:151], v11, s[24:27], s42 offen offset:1024 sc1
    v_mfma_f32_32x32x16_bf16 v[192:207], v[36:39], v[128:131], v[192:207]
    ds_read_b64_tr_b16 v[28:29], v3 offset:46208
    ds_read_b64_tr_b16 v[30:31], v3 offset:48768
    s_add_u32 s42, s48, 2048
    buffer_load_dwordx4 v[152:155], v11, s[24:27], s42 offen sc1
    buffer_load_dwordx4 v[156:159], v11, s[24:27], s42 offen offset:1024 sc1
    s_waitcnt lgkmcnt(9)
    s_setprio 2
    v_mfma_f32_32x32x16_bf16 v[208:223], v[40:43], v[128:131], v[208:223]
    s_setprio 0
    ds_read_b64_tr_b16 v[32:33], v3 offset:46272
    ds_read_b64_tr_b16 v[34:35], v3 offset:48832
    s_add_u32 s42, s48, 4096
    buffer_load_dwordx4 v[160:163], v11, s[24:27], s42 offen sc1
    buffer_load_dwordx4 v[164:167], v11, s[24:27], s42 offen offset:1024 sc1
    v_mfma_f32_32x32x16_bf16 v[224:239], v[44:47], v[128:131], v[224:239]
    ds_read_b64_tr_b16 v[36:37], v3 offset:46336
    ds_read_b64_tr_b16 v[38:39], v3 offset:48896
    s_add_u32 s42, s48, 6144
    buffer_load_dwordx4 v[168:171], v11, s[24:27], s42 offen sc1
    buffer_load_dwordx4 v[172:175], v11, s[24:27], s42 offen offset:1024 sc1
    s_waitcnt lgkmcnt(9)
    v_mfma_f32_32x32x16_bf16 v[240:255], v[16:19], v[128:131], v[240:255]
    ds_read_b64_tr_b16 v[40:41], v3 offset:51200
    ds_read_b64_tr_b16 v[42:43], v3 offset:53760
    s_mov_b32 s42, s49
    buffer_load_dwordx4 v[112:115], v11, s[24:27], s42 offen sc1
    s_setprio 2
    v_mfma_f32_32x32x16_bf16 v[176:191], v[20:23], v[132:135], v[176:191]
    s_setprio 0
    ds_read_b64_tr_b16 v[44:45], v3 offset:51264
    ds_read_b64_tr_b16 v[46:47], v3 offset:53824
    s_waitcnt lgkmcnt(8)
    v_mfma_f32_32x32x16_bf16 v[192:207], v[24:27], v[132:135], v[192:207]
    ds_read_b64_tr_b16 v[16:17], v3 offset:51328
    ds_read_b64_tr_b16 v[18:19], v3 offset:53888
    v_mfma_f32_32x32x16_bf16 v[208:223], v[28:31], v[132:135], v[208:223]
    ds_read_b64_tr_b16 v[20:21], v3 offset:51392
    ds_read_b64_tr_b16 v[22:23], v3 offset:53952
    s_waitcnt lgkmcnt(8)
    s_setprio 2
    v_mfma_f32_32x32x16_bf16 v[224:239], v[32:35], v[132:135], v[224:239]
    s_setprio 0
    ds_read_b64_tr_b16 v[24:25], v3 offset:51456
    ds_read_b64_tr_b16 v[26:27], v3 offset:54016
    v_mfma_f32_32x32x16_bf16 v[240:255], v[36:39], v[132:135], v[240:255]
    ds_read_b64_tr_b16 v[28:29], v3 offset:56320
    ds_read_b64_tr_b16 v[30:31], v3 offset:58880
    s_waitcnt lgkmcnt(8)
    v_mfma_f32_32x32x16_bf16 v[176:191], v[40:43], v[136:139], v[176:191]
    ds_read_b32 v15, v0 offset:0
    ds_read_b64_tr_b16 v[32:33], v3 offset:56384
    ds_read_b64_tr_b16 v[34:35], v3 offset:58944
    s_setprio 2
    v_mfma_f32_32x32x16_bf16 v[192:207], v[44:47], v[136:139], v[192:207]
    s_setprio 0
    ds_read_b64_tr_b16 v[36:37], v3 offset:56448
    ds_read_b64_tr_b16 v[38:39], v3 offset:59008
    s_waitcnt lgkmcnt(9)
    v_mfma_f32_32x32x16_bf16 v[208:223], v[16:19], v[136:139], v[208:223]
    ds_read_b64_tr_b16 v[40:41], v3 offset:56512
    ds_read_b64_tr_b16 v[42:43], v3 offset:59072
    v_mfma_f32_32x32x16_bf16 v[224:239], v[20:23], v[136:139], v[224:239]
    s_setprio 2
    s_waitcnt lgkmcnt(6)
L_cg62:
    v_cmp_gt_u32 vcc, 992, v15
    s_cbranch_vccz L_cg62_ok
    s_add_u32 s3, s3, 1
    s_cmp_ge_u32 s3, 0x400000
    s_cbranch_scc1 L_cg62_ok
    ds_read_b32 v15, v0 offset:0
    s_waitcnt lgkmcnt(0)
    s_branch L_cg62
L_cg62_ok:
    s_setprio 0
    ds_read_b64_tr_b16 v[44:45], v3 offset:56576
    ds_read_b64_tr_b16 v[46:47], v3 offset:59136
    s_setprio 2
    v_and_b32 v14, 7, v1
    v_lshlrev_b32 v14, 2, v14
    s_setprio 0
    buffer_load_dword v13, v14, s[28:31], s44 offen offset:96 sc1
    s_setprio 2
    v_mfma_f32_32x32x16_bf16 v[240:255], v[24:27], v[136:139], v[240:255]
    s_setprio 0
    ds_read_b64_tr_b16 v[16:17], v2 offset:0
    ds_read_b64_tr_b16 v[18:19], v2 offset:2560
    v_mfma_f32_32x32x16_bf16 v[176:191], v[28:31], v[140:143], v[176:191]
    ds_read_b64_tr_b16 v[20:21], v2 offset:64
    ds_read_b64_tr_b16 v[22:23], v2 offset:2624
    s_waitcnt lgkmcnt(8)
    v_mfma_f32_32x32x16_bf16 v[192:207], v[32:35], v[140:143], v[192:207]
    ds_read_b64_tr_b16 v[24:25], v2 offset:128
    ds_read_b64_tr_b16 v[26:27], v2 offset:2688
    s_setprio 2
    v_mfma_f32_32x32x16_bf16 v[208:223], v[36:39], v[140:143], v[208:223]
    s_setprio 0
    ds_read_b64_tr_b16 v[28:29], v2 offset:192
    ds_read_b64_tr_b16 v[30:31], v2 offset:2752
    s_waitcnt lgkmcnt(8)
    v_mfma_f32_32x32x16_bf16 v[224:239], v[40:43], v[140:143], v[224:239]
    ds_read_b64_tr_b16 v[32:33], v2 offset:256
    ds_read_b64_tr_b16 v[34:35], v2 offset:2816
    v_mfma_f32_32x32x16_bf16 v[240:255], v[44:47], v[140:143], v[240:255]
    ds_read_b64_tr_b16 v[36:37], v2 offset:5120
    ds_read_b64_tr_b16 v[38:39], v2 offset:7680
    s_waitcnt vmcnt(15)
    s_mov_b64 exec, 1
    ds_add_u32 v0, v0 offset:0
    s_mov_b64 exec, -1
    s_waitcnt vmcnt(8)
    s_waitcnt lgkmcnt(9)
    s_setprio 2
    v_mfma_f32_32x32x16_bf16 v[176:191], v[16:19], v[144:147], v[176:191]
    s_setprio 0
    ds_read_b64_tr_b16 v[40:41], v2 offset:5184
    ds_read_b64_tr_b16 v[42:43], v2 offset:7744
    v_mfma_f32_32x32x16_bf16 v[192:207], v[20:23], v[144:147], v[192:207]
    ds_read_b64_tr_b16 v[44:45], v2 offset:5248
    ds_read_b64_tr_b16 v[46:47], v2 offset:7808
    s_waitcnt lgkmcnt(9)
    v_mfma_f32_32x32x16_bf16 v[208:223], v[24:27], v[144:147], v[208:223]
    ds_read_b64_tr_b16 v[16:17], v2 offset:5312
    ds_read_b64_tr_b16 v[18:19], v2 offset:7872
    s_setprio 2
    v_mfma_f32_32x32x16_bf16 v[224:239], v[28:31], v[144:147], v[224:239]
    s_setprio 0
    ds_read_b64_tr_b16 v[20:21], v2 offset:5376
    ds_read_b64_tr_b16 v[22:23], v2 offset:7936
    s_waitcnt lgkmcnt(9)
    v_mfma_f32_32x32x16_bf16 v[240:255], v[32:35], v[144:147], v[240:255]
    ds_read_b64_tr_b16 v[24:25], v2 offset:10240
    ds_read_b64_tr_b16 v[26:27], v2 offset:12800
    v_mfma_f32_32x32x16_bf16 v[176:191], v[36:39], v[148:151], v[176:191]
    ds_read_b64_tr_b16 v[28:29], v2 offset:10304
    ds_read_b64_tr_b16 v[30:31], v2 offset:12864
    s_waitcnt lgkmcnt(8)
    s_setprio 2
    v_mfma_f32_32x32x16_bf16 v[192:207], v[40:43], v[148:151], v[192:207]
    s_setprio 0
    ds_read_b64_tr_b16 v[32:33], v2 offset:10368
    ds_read_b64_tr_b16 v[34:35], v2 offset:12928
    v_mfma_f32_32x32x16_bf16 v[208:223], v[44:47], v[148:151], v[208:223]
    ds_read_b64_tr_b16 v[36:37], v2 offset:10432
    ds_read_b64_tr_b16 v[38:39], v2 offset:12992
    s_waitcnt lgkmcnt(8)
    v_mfma_f32_32x32x16_bf16 v[224:239], v[16:19], v[148:151], v[224:239]
    ds_read_b64_tr_b16 v[40:41], v2 offset:10496
    ds_read_b64_tr_b16 v[42:43], v2 offset:13056
    s_setprio 2
    v_mfma_f32_32x32x16_bf16 v[240:255], v[20:23], v[148:151], v[240:255]
    s_setprio 0
    ds_read_b64_tr_b16 v[44:45], v2 offset:15360
    ds_read_b64_tr_b16 v[46:47], v2 offset:17920
    s_waitcnt vmcnt(6)
    s_waitcnt lgkmcnt(8)
    v_mfma_f32_32x32x16_bf16 v[176:191], v[24:27], v[152:155], v[176:191]
    ds_read_b32 v15, v0 offset:0
    ds_read_b64_tr_b16 v[16:17], v2 offset:15424
    ds_read_b64_tr_b16 v[18:19], v2 offset:17984
    v_mfma_f32_32x32x16_bf16 v[192:207], v[28:31], v[152:155], v[192:207]
    ds_read_b64_tr_b16 v[20:21], v2 offset:15488
    ds_read_b64_tr_b16 v[22:23], v2 offset:18048
    s_waitcnt lgkmcnt(9)
    s_setprio 2
    v_mfma_f32_32x32x16_bf16 v[208:223], v[32:35], v[152:155], v[208:223]
    s_setprio 0
    ds_read_b64_tr_b16 v[24:25], v2 offset:15552
    ds_read_b64_tr_b16 v[26:27], v2 offset:18112
    v_mfma_f32_32x32x16_bf16 v[224:239], v[36:39], v[152:155], v[224:239]
    s_setprio 2
    s_waitcnt lgkmcnt(6)
L_cg63:
    v_cmp_gt_u32 vcc, 1008, v15
    s_cbranch_vccz L_cg63_ok
    s_add_u32 s3, s3, 1
    s_cmp_ge_u32 s3, 0x400000
    s_cbranch_scc1 L_cg63_ok
    ds_read_b32 v15, v0 offset:0
    s_waitcnt lgkmcnt(0)
    s_branch L_cg63
L_cg63_ok:
    s_setprio 0
    ds_read_b64_tr_b16 v[28:29], v2 offset:15616
    ds_read_b64_tr_b16 v[30:31], v2 offset:18176
    v_mfma_f32_32x32x16_bf16 v[240:255], v[40:43], v[152:155], v[240:255]
    ds_read_b64_tr_b16 v[32:33], v2 offset:20480
    ds_read_b64_tr_b16 v[34:35], v2 offset:23040
    s_setprio 2
    v_mfma_f32_32x32x16_bf16 v[176:191], v[44:47], v[156:159], v[176:191]
    s_setprio 0
    ds_read_b64_tr_b16 v[36:37], v2 offset:20544
    ds_read_b64_tr_b16 v[38:39], v2 offset:23104
    s_waitcnt lgkmcnt(8)
    v_mfma_f32_32x32x16_bf16 v[192:207], v[16:19], v[156:159], v[192:207]
    ds_read_b64_tr_b16 v[40:41], v2 offset:20608
    ds_read_b64_tr_b16 v[42:43], v2 offset:23168
    v_mfma_f32_32x32x16_bf16 v[208:223], v[20:23], v[156:159], v[208:223]
    ds_read_b64_tr_b16 v[44:45], v2 offset:20672
    ds_read_b64_tr_b16 v[46:47], v2 offset:23232
    s_waitcnt lgkmcnt(8)
    s_setprio 2
    v_mfma_f32_32x32x16_bf16 v[224:239], v[24:27], v[156:159], v[224:239]
    s_setprio 0
    ds_read_b64_tr_b16 v[16:17], v2 offset:20736
    ds_read_b64_tr_b16 v[18:19], v2 offset:23296
    v_mfma_f32_32x32x16_bf16 v[240:255], v[28:31], v[156:159], v[240:255]
    ds_read_b64_tr_b16 v[20:21], v2 offset:25600
    ds_read_b64_tr_b16 v[22:23], v2 offset:28160
    s_setprio 2
    s_waitcnt vmcnt(0)
    s_cmp_lg_u32 s36, 0
    s_cbranch_scc1 L_c_ok
L_c_chk:
    v_cmp_ne_u32 s[40:41], s60, v13
    v_cmp_ne_u32 vcc, s61, v13
    s_nop 0
    s_and_b32 s40, s40, 0x0f
    s_and_b32 s41, vcc_lo, 0xf0
    s_or_b32 s40, s40, s41
    s_cbranch_scc0 L_c_ok
    s_add_u32 s3, s3, 16
    s_cmp_ge_u32 s3, 0x400000
    s_cbranch_scc1 L_c_ok
    s_sleep 4
    buffer_load_dword v13, v14, s[28:31], s44 offen offset:96 sc1
    s_waitcnt vmcnt(0)
    s_branch L_c_chk
L_c_ok:
    s_mov_b64 exec, 1
    ds_add_u32 v0, v0 offset:0
    s_mov_b64 exec, -1
    s_waitcnt lgkmcnt(9)
    s_setprio 0
    v_mfma_f32_32x32x16_bf16 v[176:191], v[32:35], v[160:163], v[176:191]
    ds_read_b64_tr_b16 v[24:25], v2 offset:25664
    ds_read_b64_tr_b16 v[26:27], v2 offset:28224
    s_setprio 2
    v_mfma_f32_32x32x16_bf16 v[192:207], v[36:39], v[160:163], v[192:207]
    s_setprio 0
    ds_read_b64_tr_b16 v[28:29], v2 offset:25728
    ds_read_b64_tr_b16 v[30:31], v2 offset:28288
    s_waitcnt lgkmcnt(9)
    v_mfma_f32_32x32x16_bf16 v[208:223], v[40:43], v[160:163], v[208:223]
    ds_read_b64_tr_b16 v[32:33], v2 offset:25792
    ds_read_b64_tr_b16 v[34:35], v2 offset:28352
    v_mfma_f32_32x32x16_bf16 v[224:239], v[44:47], v[160:163], v[224:239]
    ds_read_b64_tr_b16 v[36:37], v2 offset:25856
    ds_read_b64_tr_b16 v[38:39], v2 offset:28416
    s_waitcnt lgkmcnt(9)
    s_setprio 2
    v_mfma_f32_32x32x16_bf16 v[240:255], v[16:19], v[160:163], v[240:255]
    s_setprio 0
    ds_read_b64_tr_b16 v[40:41], v2 offset:30720
    ds_read_b64_tr_b16 v[42:43], v2 offset:33280
    v_mfma_f32_32x32x16_bf16 v[176:191], v[20:23], v[164:167], v[176:191]
    ds_read_b64_tr_b16 v[44:45], v2 offset:30784
    ds_read_b64_tr_b16 v[46:47], v2 offset:33344
    s_waitcnt lgkmcnt(8)
    v_mfma_f32_32x32x16_bf16 v[192:207], v[24:27], v[164:167], v[192:207]
    ds_read_b64_tr_b16 v[16:17], v2 offset:30848
    ds_read_b64_tr_b16 v[18:19], v2 offset:33408
    s_setprio 2
    v_mfma_f32_32x32x16_bf16 v[208:223], v[28:31], v[164:167], v[208:223]
    s_setprio 0
    ds_read_b64_tr_b16 v[20:21], v2 offset:30912
    ds_read_b64_tr_b16 v[22:23], v2 offset:33472
    s_waitcnt lgkmcnt(8)
    v_mfma_f32_32x32x16_bf16 v[224:239], v[32:35], v[164:167], v[224:239]
    ds_read_b64_tr_b16 v[24:25], v2 offset:30976
    ds_read_b64_tr_b16 v[26:27], v2 offset:33536
    v_mfma_f32_32x32x16_bf16 v[240:255], v[36:39], v[164:167], v[240:255]
    ds_read_b64_tr_b16 v[28:29], v2 offset:35840
    ds_read_b64_tr_b16 v[30:31], v2 offset:38400
    s_waitcnt lgkmcnt(8)
    s_setprio 2
    v_mfma_f32_32x32x16_bf16 v[176:191], v[40:43], v[168:171], v[176:191]
    s_setprio 0
    ds_read_b32 v15, v0 offset:0
    ds_read_b64_tr_b16 v[32:33], v2 offset:35904
    ds_read_b64_tr_b16 v[34:35], v2 offset:38464
    v_mfma_f32_32x32x16_bf16 v[192:207], v[44:47], v[168:171], v[192:207]
    ds_read_b64_tr_b16 v[36:37], v2 offset:35968
    ds_read_b64_tr_b16 v[38:39], v2 offset:38528
    s_waitcnt lgkmcnt(9)
    v_mfma_f32_32x32x16_bf16 v[208:223], v[16:19], v[168:171], v[208:223]
    ds_read_b64_tr_b16 v[40:41], v2 offset:36032
    ds_read_b64_tr_b16 v[42:43], v2 offset:38592
    s_setprio 2
    v_mfma_f32_32x32x16_bf16 v[224:239], v[20:23], v[168:171], v[224:239]
    s_setprio 0
    s_setprio 2
    s_waitcnt lgkmcnt(6)
L_cg64:
    v_cmp_gt_u32 vcc, 1024, v15
    s_cbranch_vccz L_cg64_ok
    s_add_u32 s3, s3, 1
    s_cmp_ge_u32 s3, 0x400000
    s_cbranch_scc1 L_cg64_ok
    ds_read_b32 v15, v0 offset:0
    s_waitcnt lgkmcnt(0)
    s_branch L_cg64
L_cg64_ok:
    s_setprio 0
    ds_read_b64_tr_b16 v[44:45], v2 offset:36096
    ds_read_b64_tr_b16 v[46:47], v2 offset:38656
    v_mfma_f32_32x32x16_bf16 v[240:255], v[24:27], v[168:171], v[240:255]
    ds_read_b64_tr_b16 v[16:17], v3 offset:0
    ds_read_b64_tr_b16 v[18:19], v3 offset:2560
    v_mfma_f32_32x32x16_bf16 v[176:191], v[28:31], v[172:175], v[176:191]
    ds_read_b64_tr_b16 v[20:21], v3 offset:64
    ds_read_b64_tr_b16 v[22:23], v3 offset:2624
    s_waitcnt lgkmcnt(8)
    s_setprio 2
    v_mfma_f32_32x32x16_bf16 v[192:207], v[32:35], v[172:175], v[192:207]
    s_setprio 0
    ds_read_b64_tr_b16 v[24:25], v3 offset:128
    ds_read_b64_tr_b16 v[26:27], v3 offset:2688
    v_mfma_f32_32x32x16_bf16 v[208:223], v[36:39], v[172:175], v[208:223]
    ds_read_b64_tr_b16 v[28:29], v3 offset:192
    ds_read_b64_tr_b16 v[30:31], v3 offset:2752
    s_waitcnt lgkmcnt(8)
    v_mfma_f32_32x32x16_bf16 v[224:239], v[40:43], v[172:175], v[224:239]
    ds_read_b64_tr_b16 v[32:33], v3 offset:256
    ds_read_b64_tr_b16 v[34:35], v3 offset:2816
    s_setprio 2
    v_mfma_f32_32x32x16_bf16 v[240:255], v[44:47], v[172:175], v[240:255]
    s_setprio 0
    s_waitcnt lgkmcnt(6)
    v_mfma_f32_32x32x16_bf16 v[176:191], v[16:19], v[112:115], v[176:191]
    v_mfma_f32_32x32x16_bf16 v[192:207], v[20:23], v[112:115], v[192:207]
    s_waitcnt lgkmcnt(2)
    s_setprio 2
    v_mfma_f32_32x32x16_bf16 v[208:223], v[24:27], v[112:115], v[208:223]
    s_setprio 0
    v_mfma_f32_32x32x16_bf16 v[224:239], v[28:31], v[112:115], v[224:239]
    s_waitcnt lgkmcnt(0)
    v_mfma_f32_32x32x16_bf16 v[240:255], v[32:35], v[112:115], v[240:255]
    s_lshl_b32 s40, s37, 2
    s_add_u32 s40, s40, s74
    s_mul_i32 s70, s40, 147456
    s_cmp_eq_u32 s36, s73
    s_cbranch_scc1 L_g_own
    s_lshl_b32 s41, s73, 2
    s_add_u32 s41, s41, s36
    s_mul_i32 s41, s41, 9216
    s_add_u32 s41, s41, s70
    v_cvt_pk_bf16_f32 v48, v176, v177
    v_cvt_pk_bf16_f32 v49, v178, v179
    v_cvt_pk_bf16_f32 v50, v180, v181
    v_cvt_pk_bf16_f32 v51, v182, v183
    buffer_store_dwordx4 v[48:51], v11, s[28:31], s41 offen offset:0 sc1
    v_cvt_pk_bf16_f32 v52, v184, v185
    v_cvt_pk_bf16_f32 v53, v186, v187
    v_cvt_pk_bf16_f32 v54, v188, v189
    v_cvt_pk_bf16_f32 v55, v190, v191
    buffer_store_dwordx4 v[52:55], v11, s[28:31], s41 offen offset:1024 sc1
    v_cvt_pk_bf16_f32 v56, v192, v193
    v_cvt_pk_bf16_f32 v57, v194, v195
    v_cvt_pk_bf16_f32 v58, v196, v197
    v_cvt_pk_bf16_f32 v59, v198, v199
    buffer_store_dwordx4 v[56:59], v11, s[28:31], s41 offen offset:2048 sc1
    v_cvt_pk_bf16_f32 v60, v200, v201
    v_cvt_pk_bf16_f32 v61, v202, v203
    v_cvt_pk_bf16_f32 v62, v204, v205
    v_cvt_pk_bf16_f32 v63, v206, v207
    buffer_store_dwordx4 v[60:63], v11, s[28:31], s41 offen offset:3072 sc1
    v_cvt_pk_bf16_f32 v48, v208, v209
    v_cvt_pk_bf16_f32 v49, v210, v211
    v_cvt_pk_bf16_f32 v50, v212, v213
    v_cvt_pk_bf16_f32 v51, v214, v215
    s_add_u32 s41, s41, 4096
    buffer_store_dwordx4 v[48:51], v11, s[28:31], s41 offen offset:0 sc1
    v_cvt_pk_bf16_f32 v52, v216, v217
    v_cvt_pk_bf16_f32 v53, v218, v219
    v_cvt_pk_bf16_f32 v54, v220, v221
    v_cvt_pk_bf16_f32 v55, v222, v223
    buffer_store_dwordx4 v[52:55], v11, s[28:31], s41 offen offset:1024 sc1
    v_cvt_pk_bf16_f32 v56, v224, v225
    v_cvt_pk_bf16_f32 v57, v226, v227
    v_cvt_pk_bf16_f32 v58, v228, v229
    v_cvt_pk_bf16_f32 v59, v230, v231
    buffer_store_dwordx4 v[56:59], v11, s[28:31], s41 offen offset:2048 sc1
    v_cvt_pk_bf16_f32 v60, v232, v233
    v_cvt_pk_bf16_f32 v61, v234, v235
    v_cvt_pk_bf16_f32 v62, v236, v237
    v_cvt_pk_bf16_f32 v63, v238, v239
    buffer_store_dwordx4 v[60:63], v11, s[28:31], s41 offen offset:3072 sc1
    v_cvt_pk_bf16_f32 v48, v240, v241
    v_cvt_pk_bf16_f32 v49, v242, v243
    v_cvt_pk_bf16_f32 v50, v244, v245
    v_cvt_pk_bf16_f32 v51, v246, v247
    s_add_u32 s41, s41, 4096
    buffer_store_dwordx4 v[48:51], v11, s[28:31], s41 offen offset:0 sc1
    s_branch L_g_st
L_g_own:
    s_nop 11
    ds_write_b128 v11, v[176:179] offset:1024
    ds_write_b128 v11, v[180:183] offset:2048
    ds_write_b128 v11, v[184:187] offset:3072
    ds_write_b128 v11, v[188:191] offset:4096
    ds_write_b128 v11, v[192:195] offset:5120
    ds_write_b128 v11, v[196:199] offset:6144
    ds_write_b128 v11, v[200:203] offset:7168
    ds_write_b128 v11, v[204:207] offset:8192
    ds_write_b128 v11, v[208:211] offset:9216
    ds_write_b128 v11, v[212:215] offset:10240
    ds_write_b128 v11, v[216:219] offset:11264
    ds_write_b128 v11, v[220:223] offset:12288
    ds_write_b128 v11, v[224:227] offset:13312
    ds_write_b128 v11, v[228:231] offset:14336
    ds_write_b128 v11, v[232:235] offset:15360
    ds_write_b128 v11, v[236:239] offset:16384
    ds_write_b128 v11, v[240:243] offset:17408
    ds_write_b128 v11, v[244:247] offset:18432
L_g_st:
    s_mul_i32 s41, s73, 9216
    s_add_u32 s41, s41, s70
    s_lshl_b32 s42, s36, 10
    s_add_u32 s41, s41, s42
    s_add_u32 s40, s73, 1
    s_and_b32 s40, s40, 3
    s_mul_i32 s40, s40, 36864
    s_add_u32 s71, s40, s41
    s_add_u32 s40, s73, 2
    s_and_b32 s40, s40, 3
    s_mul_i32 s40, s40, 36864
    s_add_u32 s69, s40, s41
    s_add_u32 s40, s73, 3
    s_and_b32 s40, s40, 3
    s_mul_i32 s40, s40, 36864
    s_add_u32 s43, s40, s41
    s_movk_i32 s62, 0x1000
    s_cmp_eq_u32 s36, 0
    s_cselect_b32 s62, 8192, s62
    v_add_u32 v7, 4096, v11
    v_add_u32 v8, s62, v11
    buffer_load_dwordx4 v[100:103], v11, s[28:31], s71 offen sc1
    buffer_load_dwordx4 v[104:107], v11, s[28:31], s69 offen sc1
    buffer_load_dwordx4 v[108:111], v11, s[28:31], s43 offen sc1
    buffer_load_dwordx4 v[112:115], v7, s[28:31], s71 offen sc1
    buffer_load_dwordx4 v[116:119], v7, s[28:31], s69 offen sc1
    buffer_load_dwordx4 v[120:123], v7, s[28:31], s43 offen sc1
    buffer_load_dwordx4 v[124:127], v8, s[28:31], s71 offen sc1
    buffer_load_dwordx4 v[128:131], v8, s[28:31], s69 offen sc1
    buffer_load_dwordx4 v[132:135], v8, s[28:31], s43 offen sc1
    s_waitcnt lgkmcnt(0)
    s_barrier
    s_lshl_b32 s40, s36, 11
    v_add_u32 v6, s40, v11
    ds_read_b128 v[76:79], v6 offset:1024
    ds_read_b128 v[80:83], v6 offset:2048
    ds_read_b128 v[84:87], v6 offset:9216
    ds_read_b128 v[88:91], v6 offset:10240
    ds_read_b128 v[92:95], v6 offset:17408
    ds_read_b128 v[96:99], v6 offset:18432
L_g_gchk:
    s_waitcnt vmcnt(0)
    v_max3_u32 v2, v100, v101, v102
    v_max3_u32 v2, v2, v103, v104
    v_max3_u32 v2, v2, v105, v106
    v_max3_u32 v2, v2, v107, v108
    v_max3_u32 v2, v2, v109, v110
    v_max3_u32 v2, v2, v111, v112
    v_max3_u32 v2, v2, v113, v114
    v_max3_u32 v2, v2, v115, v116
    v_max3_u32 v2, v2, v117, v118
    v_max3_u32 v2, v2, v119, v120
    v_max3_u32 v2, v2, v121, v122
    v_max3_u32 v2, v2, v123, v124
    v_max3_u32 v2, v2, v125, v126
    v_max3_u32 v2, v2, v127, v128
    v_max3_u32 v2, v2, v129, v130
    v_max3_u32 v2, v2, v131, v132
    v_max3_u32 v2, v2, v133, v134
    v_max_u32 v2, v2, v135
    v_cmp_eq_u32 vcc, -1, v2
    s_cbranch_vccz L_g_gok
    s_add_u32 s3, s3, 64
    s_cmp_ge_u32 s3, 0x400000
    s_cbranch_scc1 L_g_gok
    buffer_load_dwordx4 v[100:103], v11, s[28:31], s71 offen sc1
    buffer_load_dwordx4 v[104:107], v11, s[28:31], s69 offen sc1
    buffer_load_dwordx4 v[108:111], v11, s[28:31], s43 offen sc1
    buffer_load_dwordx4 v[112:115], v7, s[28:31], s71 offen sc1
    buffer_load_dwordx4 v[116:119], v7, s[28:31], s69 offen sc1
    buffer_load_dwordx4 v[120:123], v7, s[28:31], s43 offen sc1
    buffer_load_dwordx4 v[124:127], v8, s[28:31], s71 offen sc1
    buffer_load_dwordx4 v[128:131], v8, s[28:31], s69 offen sc1
    buffer_load_dwordx4 v[132:135], v8, s[28:31], s43 offen sc1
    s_branch L_g_gchk
L_g_gok:
    s_waitcnt lgkmcnt(0)
    v_lshlrev_b32 v140, 16, v100
    v_and_b32 v141, s54, v100
    v_lshlrev_b32 v142, 16, v101
    v_and_b32 v143, s54, v101
    v_lshlrev_b32 v144, 16, v102
    v_and_b32 v145, s54, v102
    v_lshlrev_b32 v146, 16, v103
    v_and_b32 v147, s54, v103
    v_pk_add_f32 v[76:77], v[76:77], v[140:141]
    v_pk_add_f32 v[78:79], v[78:79], v[142:143]
    v_pk_add_f32 v[80:81], v[80:81], v[144:145]
    v_pk_add_f32 v[82:83], v[82:83], v[146:147]
    v_lshlrev_b32 v140, 16, v104
    v_and_b32 v141, s54, v104
    v_lshlrev_b32 v142, 16, v105
    v_and_b32 v143, s54, v105
    v_lshlrev_b32 v144, 16, v106
    v_and_b32 v145, s54, v106
    v_lshlrev_b32 v146, 16, v107
    v_and_b32 v147, s54, v107
    v_pk_add_f32 v[76:77], v[76:77], v[140:141]
    v_pk_add_f32 v[78:79], v[78:79], v[142:143]
    v_pk_add_f32 v[80:81], v[80:81], v[144:145]
    v_pk_add_f32 v[82:83], v[82:83], v[146:147]
    v_lshlrev_b32 v140, 16, v108
    v_and_b32 v141, s54, v108
    v_lshlrev_b32 v142, 16, v109
    v_and_b32 v143, s54, v109
    v_lshlrev_b32 v144, 16, v110
    v_and_b32 v145, s54, v110
    v_lshlrev_b32 v146, 16, v111
    v_and_b32 v147, s54, v111
    v_pk_add_f32 v[76:77], v[76:77], v[140:141]
    v_pk_add_f32 v[78:79], v[78:79], v[142:143]
    v_pk_add_f32 v[80:81], v[80:81], v[144:145]
    v_pk_add_f32 v[82:83], v[82:83], v[146:147]
    v_lshlrev_b32 v140, 16, v64
    v_and_b32 v141, s54, v64
    v_lshlrev_b32 v142, 16, v65
    v_and_b32 v143, s54, v65
    v_lshlrev_b32 v144, 16, v66
    v_and_b32 v145, s54, v66
    v_lshlrev_b32 v146, 16, v67
    v_and_b32 v147, s54, v67
    v_pk_add_f32 v[76:77], v[76:77], v[140:141]
    v_pk_add_f32 v[78:79], v[78:79], v[142:143]
    v_pk_add_f32 v[80:81], v[80:81], v[144:145]
    v_pk_add_f32 v[82:83], v[82:83], v[146:147]
    v_cvt_pk_bf16_f32 v148, v76, v77
    v_cvt_pk_bf16_f32 v149, v78, v79
    v_cvt_pk_bf16_f32 v150, v80, v81
    v_cvt_pk_bf16_f32 v151, v82, v83
    buffer_store_dwordx2 v[148:149], v5, s[12:15], s16 offen offset:0
    buffer_store_dwordx2 v[150:151], v5, s[12:15], s16 offen offset:16
    v_lshlrev_b32 v140, 16, v112
    v_and_b32 v141, s54, v112
    v_lshlrev_b32 v142, 16, v113
    v_and_b32 v143, s54, v113
    v_lshlrev_b32 v144, 16, v114
    v_and_b32 v145, s54, v114
    v_lshlrev_b32 v146, 16, v115
    v_and_b32 v147, s54, v115
    v_pk_add_f32 v[84:85], v[84:85], v[140:141]
    v_pk_add_f32 v[86:87], v[86:87], v[142:143]
    v_pk_add_f32 v[88:89], v[88:89], v[144:145]
    v_pk_add_f32 v[90:91], v[90:91], v[146:147]
    v_lshlrev_b32 v140, 16, v116
    v_and_b32 v141, s54, v116
    v_lshlrev_b32 v142, 16, v117
    v_and_b32 v143, s54, v117
    v_lshlrev_b32 v144, 16, v118
    v_and_b32 v145, s54, v118
    v_lshlrev_b32 v146, 16, v119
    v_and_b32 v147, s54, v119
    v_pk_add_f32 v[84:85], v[84:85], v[140:141]
    v_pk_add_f32 v[86:87], v[86:87], v[142:143]
    v_pk_add_f32 v[88:89], v[88:89], v[144:145]
    v_pk_add_f32 v[90:91], v[90:91], v[146:147]
    v_lshlrev_b32 v140, 16, v120
    v_and_b32 v141, s54, v120
    v_lshlrev_b32 v142, 16, v121
    v_and_b32 v143, s54, v121
    v_lshlrev_b32 v144, 16, v122
    v_and_b32 v145, s54, v122
    v_lshlrev_b32 v146, 16, v123
    v_and_b32 v147, s54, v123
    v_pk_add_f32 v[84:85], v[84:85], v[140:141]
    v_pk_add_f32 v[86:87], v[86:87], v[142:143]
    v_pk_add_f32 v[88:89], v[88:89], v[144:145]
    v_pk_add_f32 v[90:91], v[90:91], v[146:147]
    v_lshlrev_b32 v140, 16, v68
    v_and_b32 v141, s54, v68
    v_lshlrev_b32 v142, 16, v69
    v_and_b32 v143, s54, v69
    v_lshlrev_b32 v144, 16, v70
    v_and_b32 v145, s54, v70
    v_lshlrev_b32 v146, 16, v71
    v_and_b32 v147, s54, v71
    v_pk_add_f32 v[84:85], v[84:85], v[140:141]
    v_pk_add_f32 v[86:87], v[86:87], v[142:143]
    v_pk_add_f32 v[88:89], v[88:89], v[144:145]
    v_pk_add_f32 v[90:91], v[90:91], v[146:147]
    v_cvt_pk_bf16_f32 v152, v84, v85
    v_cvt_pk_bf16_f32 v153, v86, v87
    v_cvt_pk_bf16_f32 v154, v88, v89
    v_cvt_pk_bf16_f32 v155, v90, v91
    buffer_store_dwordx2 v[152:153], v5, s[12:15], s17 offen offset:0
    buffer_store_dwordx2 v[154:155], v5, s[12:15], s17 offen offset:16
    s_cmp_lg_u32 s36, 0
    s_cbranch_scc1 L_g_no3
    v_lshlrev_b32 v140, 16, v124
    v_and_b32 v141, s54, v124
    v_lshlrev_b32 v142, 16, v125
    v_and_b32 v143, s54, v125
    v_lshlrev_b32 v144, 16, v126
    v_and_b32 v145, s54, v126
    v_lshlrev_b32 v146, 16, v127
    v_and_b32 v147, s54, v127
    v_pk_add_f32 v[92:93], v[92:93], v[140:141]
    v_pk_add_f32 v[94:95], v[94:95], v[142:143]
    v_pk_add_f32 v[96:97], v[96:97], v[144:145]
    v_pk_add_f32 v[98:99], v[98:99], v[146:147]
    v_lshlrev_b32 v140, 16, v128
    v_and_b32 v141, s54, v128
    v_lshlrev_b32 v142, 16, v129
    v_and_b32 v143, s54, v129
    v_lshlrev_b32 v144, 16, v130
    v_and_b32 v145, s54, v130
    v_lshlrev_b32 v146, 16, v131
    v_and_b32 v147, s54, v131
    v_pk_add_f32 v[92:93], v[92:93], v[140:141]
    v_pk_add_f32 v[94:95], v[94:95], v[142:143]
    v_pk_add_f32 v[96:97], v[96:97], v[144:145]
    v_pk_add_f32 v[98:99], v[98:99], v[146:147]
    v_lshlrev_b32 v140, 16, v132
    v_and_b32 v141, s54, v132
    v_lshlrev_b32 v142, 16, v133
    v_and_b32 v143, s54, v133
    v_lshlrev_b32 v144, 16, v134
    v_and_b32 v145, s54, v134
    v_lshlrev_b32 v146, 16, v135
    v_and_b32 v147, s54, v135
    v_pk_add_f32 v[92:93], v[92:93], v[140:141]
    v_pk_add_f32 v[94:95], v[94:95], v[142:143]
    v_pk_add_f32 v[96:97], v[96:97], v[144:145]
    v_pk_add_f32 v[98:99], v[98:99], v[146:147]
    v_lshlrev_b32 v140, 16, v72
    v_and_b32 v141, s54, v72
    v_lshlrev_b32 v142, 16, v73
    v_and_b32 v143, s54, v73
    v_lshlrev_b32 v144, 16, v74
    v_and_b32 v145, s54, v74
    v_lshlrev_b32 v146, 16, v75
    v_and_b32 v147, s54, v75
    v_pk_add_f32 v[92:93], v[92:93], v[140:141]
    v_pk_add_f32 v[94:95], v[94:95], v[142:143]
    v_pk_add_f32 v[96:97], v[96:97], v[144:145]
    v_pk_add_f32 v[98:99], v[98:99], v[146:147]
    v_cvt_pk_bf16_f32 v156, v92, v93
    v_cvt_pk_bf16_f32 v157, v94, v95
    v_cvt_pk_bf16_f32 v158, v96, v97
    v_cvt_pk_bf16_f32 v159, v98, v99
    buffer_store_dwordx2 v[156:157], v5, s[12:15], s18 offen offset:0
    buffer_store_dwordx2 v[158:159], v5, s[12:15], s18 offen offset:16
L_g_no3:
    s_endpgm
L_at:
    s_mov_b32 s24, s86
    s_mov_b32 s25, s87
    s_mov_b32 s26, 21233664
    s_mov_b32 s27, 0x20000
    s_add_u32 s28, s86, 21495808
    s_addc_u32 s29, s87, 0
    s_mov_b32 s30, 201728
    s_mov_b32 s31, 0x20000
    s_mov_b32 s32, s84
    s_mov_b32 s33, s85
    s_mov_b32 s34, 256
    s_mov_b32 s35, 0x20000
    v_mov_b32 v2, 0
    v_mov_b32 v3, 0
    ds_write_b64 v2, v[2:3]
    ds_write_b64 v2, v[2:3] offset:8
    ds_write_b64 v2, v[2:3] offset:16
    ds_write_b64 v2, v[2:3] offset:24
    v_mov_b32 v28, 136
    v_mov_b32 v26, 0
    v_mov_b32 v27, 0
    s_or_b32 s40, s2, s36
    s_cmp_lg_u32 s40, 0
    s_cbranch_scc1 L_at_notag
    s_memrealtime s[60:61]
    s_waitcnt lgkmcnt(0)
    s_or_b32 s60, s60, 1
    s_or_b32 s61, s61, 0x80000000
    v_mov_b32 v24, s60
    v_mov_b32 v25, s61
    s_mov_b64 exec, 1
    buffer_store_dwordx2 v[24:25], v28, s[32:35], 0 offen sc1
    s_mov_b64 exec, -1
L_at_notag:
    s_getpc_b64 s[4:5]
L_pc:
    s_sub_u32 s4, s4, L_pc-KSTART
    s_subb_u32 s5, s5, 0
    s_mov_b32 s6, L_end-KSTART
    s_mov_b32 s7, 0x20000
    s_lshr_b32 s40, s2, 3
    s_lshl_b32 s40, s40, 2
    s_add_u32 s40, s40, s36
    s_mul_hi_u32 s41, s40, 0x1c71c71d
    s_mul_i32 s41, s41, 9
    s_sub_u32 s40, s40, s41
    s_lshl_b32 s40, s40, 13
    v_lshlrev_b32 v2, 7, v1
    buffer_load_dword v20, v2, s[4:7], s40 offen
    s_mov_b32 s8, s66
    s_mov_b32 s9, s67
    s_mov_b32 s10, 663552
    s_mov_b32 s11, 0x20000
    s_sub_u32 s12, s76, 4096
    s_subb_u32 s13, s77, 0
    s_mov_b32 s14, 5312512
    s_mov_b32 s15, 0x20000
    s_sub_u32 s16, s78, 4096
    s_subb_u32 s17, s79, 0
    s_mov_b32 s18, 5312512
    s_mov_b32 s19, 0x20000
    s_cmp_ge_u32 s38, 2
    s_cbranch_scc1 L_at_nokvdma
    s_bitcmp1_b32 s38, 0
    s_cselect_b32 s20, s70, s68
    s_cselect_b32 s21, s71, s69
    s_mov_b32 s22, 20736
    s_mov_b32 s23, 0x20000
    v_lshrrev_b32 v3, 2, v1
    v_mul_u32_u24 v3, 36, v3
    v_and_b32 v4, 3, v1
    v_lshl_add_u32 v14, v4, 4, v3
    v_add_u32 v4, 1, v4
    v_lshrrev_b32 v4, 2, v4
    v_lshl_add_u32 v14, v4, 30, v14
    s_mul_i32 s40, s36, 9216
    s_add_u32 s40, s40, 115712
    s_mul_i32 s41, s36, 9
    s_lshl_b32 s42, s62, 2
    s_add_u32 s41, s41, s42
    s_add_u32 s42, s41, 0
    s_cmp_ge_u32 s42, 36
    s_cselect_b32 s43, 36, 0
    s_sub_u32 s42, s42, s43
    s_mul_i32 s42, s42, 576
    s_add_u32 m0, s40, 0
    s_nop 0
    buffer_load_dwordx4 v14, s[20:23], s42 offen lds
    s_add_u32 s42, s41, 1
    s_cmp_ge_u32 s42, 36
    s_cselect_b32 s43, 36, 0
    s_sub_u32 s42, s42, s43
    s_mul_i32 s42, s42, 576
    s_add_u32 m0, s40, 1024
    s_nop 0
    buffer_load_dwordx4 v14, s[20:23], s42 offen lds
    s_add_u32 s42, s41, 2
    s_cmp_ge_u32 s42, 36
    s_cselect_b32 s43, 36, 0
    s_sub_u32 s42, s42, s43
    s_mul_i32 s42, s42, 576
    s_add_u32 m0, s40, 2048
    s_nop 0
    buffer_load_dwordx4 v14, s[20:23], s42 offen lds
    s_add_u32 s42, s41, 3
    s_cmp_ge_u32 s42, 36
    s_cselect_b32 s43, 36, 0
    s_sub_u32 s42, s42, s43
    s_mul_i32 s42, s42, 576
    s_add_u32 m0, s40, 3072
    s_nop 0
    buffer_load_dwordx4 v14, s[20:23], s42 offen lds
    s_add_u32 s42, s41, 4
    s_cmp_ge_u32 s42, 36
    s_cselect_b32 s43, 36, 0
    s_sub_u32 s42, s42, s43
    s_mul_i32 s42, s42, 576
    s_add_u32 m0, s40, 4096
    s_nop 0
    buffer_load_dwordx4 v14, s[20:23], s42 offen lds
    s_add_u32 s42, s41, 5
    s_cmp_ge_u32 s42, 36
    s_cselect_b32 s43, 36, 0
    s_sub_u32 s42, s42, s43
    s_mul_i32 s42, s42, 576
    s_add_u32 m0, s40, 5120
    s_nop 0
    buffer_load_dwordx4 v14, s[20:23], s42 offen lds
    s_add_u32 s42, s41, 6
    s_cmp_ge_u32 s42, 36
    s_cselect_b32 s43, 36, 0
    s_sub_u32 s42, s42, s43
    s_mul_i32 s42, s42, 576
    s_add_u32 m0, s40, 6144
    s_nop 0
    buffer_load_dwordx4 v14, s[20:23], s42 offen lds
    s_add_u32 s42, s41, 7
    s_cmp_ge_u32 s42, 36
    s_cselect_b32 s43, 36, 0
    s_sub_u32 s42, s42, s43
    s_mul_i32 s42, s42, 576
    s_add_u32 m0, s40, 7168
    s_nop 0
    buffer_load_dwordx4 v14, s[20:23], s42 offen lds
    s_add_u32 s42, s41, 8
    s_cmp_ge_u32 s42, 36
    s_cselect_b32 s43, 36, 0
    s_sub_u32 s42, s42, s43
    s_mul_i32 s42, s42, 576
    s_add_u32 m0, s40, 8192
    s_nop 0
    buffer_load_dwordx4 v14, s[20:23], s42 offen lds
L_at_nokvdma:
    s_waitcnt vmcnt(0)
    s_mov_b32 s74, s72
    s_mov_b32 s75, s73
    s_add_u32 s64, s62, 0
    s_cmp_ge_u32 s64, 9
    s_cselect_b32 s40, 9, 0
    s_sub_u32 s64, s64, s40
    s_add_u32 s65, s62, 1
    s_cmp_ge_u32 s65, 9
    s_cselect_b32 s40, 9, 0
    s_sub_u32 s65, s65, s40
    s_add_u32 s66, s62, 2
    s_cmp_ge_u32 s66, 9
    s_cselect_b32 s40, 9, 0
    s_sub_u32 s66, s66, s40
    s_add_u32 s67, s62, 3
    s_cmp_ge_u32 s67, 9
    s_cselect_b32 s40, 9, 0
    s_sub_u32 s67, s67, s40
    s_add_u32 s68, s62, 4
    s_cmp_ge_u32 s68, 9
    s_cselect_b32 s40, 9, 0
    s_sub_u32 s68, s68, s40
    s_add_u32 s69, s62, 5
    s_cmp_ge_u32 s69, 9
    s_cselect_b32 s40, 9, 0
    s_sub_u32 s69, s69, s40
    s_add_u32 s70, s62, 6
    s_cmp_ge_u32 s70, 9
    s_cselect_b32 s40, 9, 0
    s_sub_u32 s70, s70, s40
    s_add_u32 s71, s62, 7
    s_cmp_ge_u32 s71, 9
    s_cselect_b32 s40, 9, 0
    s_sub_u32 s71, s71, s40
    s_add_u32 s72, s62, 8
    s_cmp_ge_u32 s72, 9
    s_cselect_b32 s40, 9, 0
    s_sub_u32 s72, s72, s40
    s_mul_i32 s46, s36, 147456
    s_mul_i32 s40, s38, 576
    s_add_u32 s46, s46, s40
    s_and_b32 s40, s38, 1
    s_lshl_b32 s41, s40, 6
    s_add_u32 s47, s46, s41
    s_xor_b32 s41, s40, 1
    s_lshl_b32 s41, s41, 9
    s_add_u32 s48, s46, s41
    s_add_u32 s48, s48, 4096
    s_mul_i32 s49, s36, 18432
    s_mul_i32 s41, s38, 72
    s_add_u32 s49, s49, s41
    v_lshrrev_b32 v14, 3, v1
    v_bfe_u32 v15, v1, 1, 2
    v_and_b32 v13, 1, v1
    v_lshlrev_b32 v13, 4, v13
    v_and_b32 v5, 2, v14
    v_xor_b32 v5, v15, v5
    v_lshrrev_b32 v4, 1, v5
    v_mul_u32_u24 v4, 36, v4
    v_and_b32 v5, 1, v5
    v_lshl_add_u32 v4, v5, 5, v4
    v_and_b32 v5, v5, v1
    v_lshl_add_u32 v4, v5, 30, v4
    v_mul_u32_u24 v5, 1152, v14
    v_add3_u32 v6, v5, v4, v13
    v_lshrrev_b32 v2, 2, v1
    v_mul_u32_u24 v2, 9216, v2
    v_and_b32 v3, 3, v1
    v_lshl_add_u32 v7, v3, 4, v2
    v_xor_b32 v8, 32, v7
    v_bfe_u32 v5, v14, 1, 1
    v_xor_b32 v5, v15, v5
    v_lshl_add_u32 v5, v5, 5, v13
    v_mul_u32_u24 v4, 9216, v14
    v_add_u32 v9, v4, v5
    v_add_u32 v9, 4096, v9
    v_add_u32 v10, 72704, v9
    s_mul_i32 s64, s64, 589824
    s_mul_i32 s65, s65, 589824
    s_mul_i32 s66, s66, 589824
    s_mul_i32 s67, s67, 589824
    s_mul_i32 s68, s68, 589824
    s_mul_i32 s69, s69, 589824
    s_mul_i32 s70, s70, 589824
    s_mul_i32 s71, s71, 589824
    s_mul_i32 s72, s72, 589824
    s_waitcnt lgkmcnt(0)
    s_barrier
    s_lshr_b32 s43, s64, 3
    s_add_u32 s43, s43, s49
    s_add_u32 m0, s45, 0
    s_nop 0
    buffer_load_dwordx4 v6, s[8:11], s43 offen lds
    s_add_u32 s43, s43, 9216
    s_add_u32 m0, s45, 1024
    s_nop 0
    buffer_load_dwordx4 v6, s[8:11], s43 offen lds
    s_lshr_b32 s43, s65, 3
    s_add_u32 s43, s43, s49
    s_add_u32 m0, s45, 2048
    s_nop 0
    buffer_load_dwordx4 v6, s[8:11], s43 offen lds
    s_add_u32 s43, s43, 9216
    s_add_u32 m0, s45, 3072
    s_nop 0
    buffer_load_dwordx4 v6, s[8:11], s43 offen lds
    s_lshr_b32 s43, s66, 3
    s_add_u32 s43, s43, s49
    s_add_u32 m0, s45, 16384
    s_nop 0
    buffer_load_dwordx4 v6, s[8:11], s43 offen lds
    s_add_u32 s43, s43, 9216
    s_add_u32 m0, s45, 17408
    s_nop 0
    buffer_load_dwordx4 v6, s[8:11], s43 offen lds
    s_lshr_b32 s43, s67, 3
    s_add_u32 s43, s43, s49
    s_add_u32 m0, s45, 18432
    s_nop 0
    buffer_load_dwordx4 v6, s[8:11], s43 offen lds
    s_add_u32 s43, s43, 9216
    s_add_u32 m0, s45, 19456
    s_nop 0
    buffer_load_dwordx4 v6, s[8:11], s43 offen lds
    s_lshr_b32 s43, s68, 3
    s_add_u32 s43, s43, s49
    s_add_u32 m0, s45, 32768
    s_nop 0
    buffer_load_dwordx4 v6, s[8:11], s43 offen lds
    s_add_u32 s43, s43, 9216
    s_add_u32 m0, s45, 33792
    s_nop 0
    buffer_load_dwordx4 v6, s[8:11], s43 offen lds
    s_lshr_b32 s43, s69, 3
    s_add_u32 s43, s43, s49
    s_add_u32 m0, s45, 34816
    s_nop 0
    buffer_load_dwordx4 v6, s[8:11], s43 offen lds
    s_add_u32 s43, s43, 9216
    s_add_u32 m0, s45, 35840
    s_nop 0
    buffer_load_dwordx4 v6, s[8:11], s43 offen lds
    s_lshr_b32 s43, s70, 3
    s_add_u32 s43, s43, s49
    s_add_u32 m0, s45, 49152
    s_nop 0
    buffer_load_dwordx4 v6, s[8:11], s43 offen lds
    s_add_u32 s43, s43, 9216
    s_add_u32 m0, s45, 50176
    s_nop 0
    buffer_load_dwordx4 v6, s[8:11], s43 offen lds
    s_lshr_b32 s43, s71, 3
    s_add_u32 s43, s43, s49
    s_add_u32 m0, s45, 51200
    s_nop 0
    buffer_load_dwordx4 v6, s[8:11], s43 offen lds
    s_add_u32 s43, s43, 9216
    s_add_u32 m0, s45, 52224
    s_nop 0
    buffer_load_dwordx4 v6, s[8:11], s43 offen lds
    s_waitcnt vmcnt(8)
    s_mov_b64 exec, 1
    ds_add_u32 v0, v0 offset:8
    s_mov_b64 exec, -1
    s_lshr_b32 s43, s72, 3
    s_add_u32 s43, s43, s49
    s_add_u32 m0, s45, 65536
    s_nop 0
    buffer_load_dwordx4 v6, s[8:11], s43 offen lds
    s_add_u32 s43, s43, 9216
    s_add_u32 m0, s45, 66560
    s_nop 0
    buffer_load_dwordx4 v6, s[8:11], s43 offen lds
    s_add_u32 s43, s64, s48
    s_add_u32 m0, s45, 67584
    s_nop 0
    buffer_load_dwordx4 v7, s[12:15], s43 offen lds
    s_add_u32 m0, s45, 68608
    s_nop 0
    buffer_load_dwordx4 v8, s[16:19], s43 offen lds
    s_add_u32 s43, s65, s48
    s_add_u32 m0, s45, 81920
    s_nop 0
    buffer_load_dwordx4 v7, s[12:15], s43 offen lds
    s_add_u32 m0, s45, 82944
    s_nop 0
    buffer_load_dwordx4 v8, s[16:19], s43 offen lds
    s_add_u32 s43, s66, s48
    s_add_u32 m0, s45, 83968
    s_nop 0
    buffer_load_dwordx4 v7, s[12:15], s43 offen lds
    s_add_u32 m0, s45, 84992
    s_nop 0
    buffer_load_dwordx4 v8, s[16:19], s43 offen lds
    s_waitcnt vmcnt(8)
    s_mov_b64 exec, 1
    ds_add_u32 v0, v0 offset:12
    s_mov_b64 exec, -1
    s_add_u32 s43, s67, s48
    s_add_u32 m0, s45, 98304
    s_nop 0
    buffer_load_dwordx4 v7, s[12:15], s43 offen lds
    s_add_u32 m0, s45, 99328
    s_nop 0
    buffer_load_dwordx4 v8, s[16:19], s43 offen lds
    s_add_u32 s43, s68, s48
    s_add_u32 m0, s45, 100352
    s_nop 0
    buffer_load_dwordx4 v7, s[12:15], s43 offen lds
    s_add_u32 m0, s45, 101376
    s_nop 0
    buffer_load_dwordx4 v8, s[16:19], s43 offen lds
    buffer_load_dwordx2 v[24:25], v28, s[32:35], 0 offen sc1
    s_add_u32 s12, s86, 22020096
    s_addc_u32 s13, s87, 0
    s_mov_b32 s14, 9469952
    s_mov_b32 s15, 0x20000
    s_waitcnt vmcnt(1)
    s_mov_b64 exec, 1
    ds_add_u32 v0, v0 offset:16
    s_mov_b64 exec, -1
    s_waitcnt vmcnt(0)
L_at_tagchk:
    v_readfirstlane_b32 s60, v24
    v_readfirstlane_b32 s61, v25
    s_nop 1
    s_min_u32 s40, s60, s61
    s_cmp_lg_u32 s40, 0
    s_cbranch_scc1 L_at_tagok
    s_add_u32 s3, s3, 16
    s_cmp_ge_u32 s3, 0x400000
    s_cbranch_scc1 L_at_tagok
    s_sleep 8
    buffer_load_dwordx2 v[24:25], v28, s[32:35], 0 offen sc1
    s_waitcnt vmcnt(0)
    s_branch L_at_tagchk
L_at_tagok:
    ds_write_b32 v0, v24 offset:28
    ds_write_b32 v0, v25 offset:32
    s_cmp_ge_u32 s38, 2
    s_cbranch_scc1 L_at_nopubkv
    s_lshl_b32 s43, s36, 11
    s_add_u32 s43, s43, 152576
    v_add_u32 v3, s43, v11
    s_mul_i32 s43, s39, 3072
    s_add_u32 s43, s43, 0
    v_and_b32 v6, 31, v1
    v_lshrrev_b32 v4, 5, v1
    v_mul_u32_u24 v4, 320, v4
    v_lshl_add_u32 v4, v6, 4, v4
    v_lshlrev_b32 v7, 2, v1
    ds_read_b32 v15, v0 offset:20
    s_waitcnt lgkmcnt(0)
L_ckvh:
    v_cmp_gt_u32 vcc, 16, v15
    s_cbranch_vccz L_ckvh_ok
    s_add_u32 s3, s3, 1
    s_cmp_ge_u32 s3, 0x400000
    s_cbranch_scc1 L_ckvh_ok
    s_sleep 1
    ds_read_b32 v15, v0 offset:20
    s_waitcnt lgkmcnt(0)
    s_branch L_ckvh
L_ckvh_ok:
    ds_read_b128 v[16:19], v3
    ds_read_b128 v[20:23], v3 offset:1024
    s_waitcnt lgkmcnt(0)
    s_cmp_eq_u32 s38, 1
    s_cbranch_scc1 L_at_pubv
    buffer_store_dwordx4 v[16:19], v11, s[28:31], s43 offen sc1
    buffer_store_dword v20, v7, s[28:31], s43 offen offset:1024 sc1
    ds_swizzle_b32 v22, v21 offset:0x41f
    s_waitcnt lgkmcnt(0)
    v_max_f32 v21, v21, v22
    ds_swizzle_b32 v22, v21 offset:0x81f
    s_waitcnt lgkmcnt(0)
    v_max_f32 v21, v21, v22
    ds_swizzle_b32 v22, v21 offset:0x101f
    s_waitcnt lgkmcnt(0)
    v_max_f32 v21, v21, v22
    ds_swizzle_b32 v22, v21 offset:0x201f
    s_waitcnt lgkmcnt(0)
    v_max_f32 v21, v21, v22
    ds_swizzle_b32 v22, v21 offset:0x401f
    s_waitcnt lgkmcnt(0)
    v_max_f32 v21, v21, v22
    v_mov_b32 v26, v21
    s_branch L_at_pubf
L_at_pubv:
    v_cmp_gt_u32 vcc, 20, v6
    s_nop 1
    s_and_saveexec_b64 s[56:57], vcc
    buffer_store_dwordx4 v[16:19], v4, s[28:31], s43 offen offset:1280 sc1
    buffer_store_dwordx4 v[20:23], v4, s[28:31], s43 offen offset:1920 sc1
    s_mov_b64 exec, s[56:57]
L_at_pubf:
    s_lshl_b32 s40, s38, 6
    s_add_u32 s40, s40, s39
    s_lshl_b32 s40, s40, 4
    s_add_u32 s40, s40, 197632
    v_mov_b32 v7, 0
    s_waitcnt vmcnt(0)
    s_mov_b64 exec, 1
    buffer_store_dwordx4 v[24:27], v7, s[28:31], s40 offen sc1
    s_mov_b64 exec, -1
L_at_nopubkv:
    v_mov_b32 v5, v11
    v_add_u32 v2, 115712, v5
    v_and_b32 v6, 31, v1
    v_lshlrev_b32 v3, 2, v6
    v_add_u32 v3, 116736, v3
    v_min_u32 v7, 19, v6
    v_cmp_eq_u32 vcc, 22, v6
    s_nop 1
    v_cndmask_b32 v7, v7, 18, vcc
    v_lshrrev_b32 v8, 5, v1
    v_mul_u32_u24 v8, 320, v8
    v_lshl_add_u32 v9, v7, 4, v8
    v_add_u32 v4, 116992, v9
    s_mul_i32 s44, s36, 3072
    s_add_u32 s45, s44, 0
    s_add_u32 s44, s44, 115712
    v_mov_b32 v80, 0
    v_mov_b32 v81, 0
    v_mov_b32 v82, 0
    v_mov_b32 v83, 0
    v_mov_b32 v84, 0
    v_mov_b32 v85, 0
    v_mov_b32 v86, 0
    v_mov_b32 v87, 0
    v_mov_b32 v88, 0
    v_mov_b32 v89, 0
    v_mov_b32 v90, 0
    v_mov_b32 v91, 0
    v_mov_b32 v92, 0
    v_mov_b32 v93, 0
    v_mov_b32 v94, 0
    v_mov_b32 v95, 0
    v_mov_b32 v22, 0
    v_mov_b32 v23, 0
    v_mov_b32 v118, 0
    v_mov_b32 v119, 0
    v_mov_b32 v96, 0
    v_mov_b32 v97, 0
    v_mov_b32 v98, 0
    v_mov_b32 v99, 0
    v_mov_b32 v100, 0
    v_mov_b32 v101, 0
    v_mov_b32 v102, 0
    v_mov_b32 v103, 0
    v_mov_b32 v104, 0
    v_mov_b32 v105, 0
    v_mov_b32 v106, 0
    v_mov_b32 v107, 0
    v_mov_b32 v108, 0
    v_mov_b32 v109, 0
    v_mov_b32 v110, 0
    v_mov_b32 v111, 0
    v_mov_b32 v30, 0
    v_mov_b32 v31, 0
    v_mov_b32 v126, 0
    v_mov_b32 v127, 0
    s_mul_i32 s43, s36, 3072
    s_add_u32 s43, s43, 140288
    v_lshl_add_u32 v10, v1, 3, s43
    s_add_u32 s10, s45, 196608
    s_bfe_u32 s40, s2, 0x40003
    s_mul_i32 s40, s40, 12288
    s_add_u32 s48, s45, s40
    s_cmp_lg_u32 s36, 0
    s_cbranch_scc1 L_at_go
    ds_read_b32 v15, v0 offset:0
    s_waitcnt lgkmcnt(0)
L_capre:
    v_cmp_gt_u32 vcc, 80, v15
    s_cbranch_vccz L_capre_ok
    s_add_u32 s3, s3, 1
    s_cmp_ge_u32 s3, 0x400000
    s_cbranch_scc1 L_capre_ok
    s_sleep 2
    ds_read_b32 v15, v0 offset:0
    s_waitcnt lgkmcnt(0)
    s_branch L_capre
L_capre_ok:
    s_mov_b32 s40, 197632
L_at_poll:
    buffer_load_dwordx4 v[32:35], v11, s[28:31], s40 offen sc1
    buffer_load_dwordx2 v[36:37], v11, s[28:31], s40 offen offset:1024 sc1
    s_waitcnt vmcnt(0)
    v_cmp_ne_u64 vcc, s[60:61], v[32:33]
    v_cmp_ne_u64 s[8:9], s[60:61], v[36:37]
    s_nop 1
    s_or_b64 vcc, vcc, s[8:9]
    s_cbranch_scc0 L_at_got
    s_add_u32 s3, s3, 16
    s_cmp_ge_u32 s3, 0x400000
    s_cbranch_scc1 L_at_got
    s_sleep 32
    s_branch L_at_poll
L_at_got:
    v_mov_b32 v12, v34
    ds_swizzle_b32 v13, v12 offset:0x41f
    s_waitcnt lgkmcnt(0)
    v_max_f32 v12, v12, v13
    ds_swizzle_b32 v13, v12 offset:0x81f
    s_waitcnt lgkmcnt(0)
    v_max_f32 v12, v12, v13
    ds_swizzle_b32 v13, v12 offset:0x101f
    s_waitcnt lgkmcnt(0)
    v_max_f32 v12, v12, v13
    ds_swizzle_b32 v13, v12 offset:0x201f
    s_waitcnt lgkmcnt(0)
    v_max_f32 v12, v12, v13
    ds_swizzle_b32 v13, v12 offset:0x401f
    s_waitcnt lgkmcnt(0)
    v_max_f32 v12, v12, v13
    v_mov_b32 v13, v12
    s_nop 1
    v_permlane32_swap_b32 v12, v13
    v_max_f32 v12, v12, v13
    v_sqrt_f32 v12, v12
    s_nop 0
    v_mul_f32 v12, 0x3f820000, v12
    v_mov_b32 v13, 0
    v_cvt_pk_bf16_f32 v12, v12, v13
    ds_write_b32 v0, v12 offset:36
L_at_go:
    s_mov_b64 exec, 1
    ds_add_u32 v0, v0 offset:4
    s_mov_b64 exec, -1
    ds_read_b32 v15, v0 offset:4
    s_waitcnt lgkmcnt(0)
L_ca1:
    v_cmp_gt_u32 vcc, 16, v15
    s_cbranch_vccz L_ca1_ok
    s_add_u32 s3, s3, 1
    s_cmp_ge_u32 s3, 0x400000
    s_cbranch_scc1 L_ca1_ok
    s_sleep 1
    ds_read_b32 v15, v0 offset:4
    s_waitcnt lgkmcnt(0)
    s_branch L_ca1
L_ca1_ok:
    s_add_u32 m0, s44, 0
    s_nop 0
    buffer_load_dwordx4 v5, s[28:31], s48 offen offset:0 sc1 lds
    buffer_load_dwordx4 v5, s[28:31], s48 offen offset:1024 sc1 lds
    buffer_load_dwordx4 v5, s[28:31], s48 offen offset:2048 sc1 lds
    s_add_u32 s48, s48, 12288
    s_cmp_eq_u32 s48, s10
    s_cselect_b32 s48, s45, s48
    s_add_u32 m0, s44, 12288
    s_nop 0
    buffer_load_dwordx4 v5, s[28:31], s48 offen offset:0 sc1 lds
    buffer_load_dwordx4 v5, s[28:31], s48 offen offset:1024 sc1 lds
    buffer_load_dwordx4 v5, s[28:31], s48 offen offset:2048 sc1 lds
    s_add_u32 s48, s48, 12288
    s_cmp_eq_u32 s48, s10
    s_cselect_b32 s48, s45, s48
    ds_read_b32 v117, v0 offset:36
    ds_read_b32 v125, v0 offset:36
    v_add_u32 v12, s43, v5
    ds_read_b32 v15, v0 offset:0
    s_waitcnt lgkmcnt(0)
L_caq:
    v_cmp_gt_u32 vcc, 96, v15
    s_cbranch_vccz L_caq_ok
    s_add_u32 s3, s3, 1
    s_cmp_ge_u32 s3, 0x400000
    s_cbranch_scc1 L_caq_ok
    s_sleep 1
    ds_read_b32 v15, v0 offset:0
    s_waitcnt lgkmcnt(0)
    s_branch L_caq
L_caq_ok:
    ds_read_b128 v[16:19], v12 offset:0
    ds_read_b64 v[20:21], v10 offset:1024
    ds_read_b128 v[24:27], v12 offset:1536
    ds_read_b64 v[28:29], v10 offset:2560
    s_waitcnt vmcnt(3)
    s_waitcnt lgkmcnt(0)
    s_mov_b64 exec, 1
    ds_add_u32 v0, v0 offset:4
    s_mov_b64 exec, -1
    ds_read_b32 v15, v0 offset:4
    s_waitcnt lgkmcnt(0)
L_ca2:
    v_cmp_gt_u32 vcc, 32, v15
    s_cbranch_vccz L_ca2_ok
    s_add_u32 s3, s3, 1
    s_cmp_ge_u32 s3, 0x400000
    s_cbranch_scc1 L_ca2_ok
    ds_read_b32 v15, v0 offset:4
    s_waitcnt lgkmcnt(0)
    s_branch L_ca2
L_ca2_ok:
    s_setprio 1
    ds_read_b128 v[112:115], v2 offset:0
    ds_read_b32 v116, v3 offset:0
    s_waitcnt lgkmcnt(0)
    v_mfma_f32_32x32x16_bf16 v[32:47], v[112:115], v[16:19], 0
    v_mfma_f32_32x32x16_bf16 v[32:47], v[116:119], v[20:23], v[32:47]
    s_nop 7
    s_nop 3
    s_mov_b32 s47, 0
    s_mov_b32 s46, 12288
    s_mov_b32 s63, 12288
    s_add_u32 s49, s44, 24576
    s_mov_b32 s53, 16
    s_mov_b32 s52, 32
    s_mov_b32 s54, 96
    s_mov_b32 s57, 48
    s_bfe_u32 s62, s2, 0x30003
    s_add_u32 s62, s62, 3
    s_mov_b32 s4, s80
    s_mov_b32 s5, s81
    s_mov_b32 s6, 5308416
    s_mov_b32 s7, 0x20000
    s_mov_b32 s20, s74
    s_mov_b32 s21, s75
    s_mov_b32 s22, 663552
    s_mov_b32 s23, 0x20000
    s_lshl_b32 s40, s2, 2
    s_add_u32 s40, s40, s36
    s_mul_i32 s8, s40, 5248
    s_mul_i32 s9, s40, 768
    v_min_u32 v144, 40, v1
    v_lshlrev_b32 v144, 7, v144
    v_min_u32 v145, 5, v1
    v_lshlrev_b32 v145, 7, v145
    v_mfma_f32_32x32x16_bf16 v[48:63], v[112:115], v[24:27], 0
    ds_read_b128 v[120:123], v2 offset:3072
    ds_read_b32 v124, v3 offset:3072
    ds_read_b128 v[128:131], v4 offset:0
    ds_read_b128 v[132:135], v4 offset:640
    v_exp_f32 v32, v32
    v_exp_f32 v33, v33
    v_exp_f32 v34, v34
    v_exp_f32 v35, v35
    v_mfma_f32_32x32x16_bf16 v[48:63], v[116:119], v[28:31], v[48:63]
    v_exp_f32 v36, v36
    v_exp_f32 v37, v37
    v_exp_f32 v38, v38
    v_exp_f32 v39, v39
    v_cvt_pk_bf16_f32 v64, v32, v33
    v_cvt_pk_bf16_f32 v65, v34, v35
    v_exp_f32 v40, v40
    v_exp_f32 v41, v41
    v_exp_f32 v42, v42
    v_exp_f32 v43, v43
    v_cvt_pk_bf16_f32 v66, v36, v37
    v_cvt_pk_bf16_f32 v67, v38, v39
    v_exp_f32 v44, v44
    v_exp_f32 v45, v45
    v_exp_f32 v46, v46
    v_exp_f32 v47, v47
    v_cvt_pk_bf16_f32 v68, v40, v41
    v_cvt_pk_bf16_f32 v69, v42, v43
    v_cvt_pk_bf16_f32 v70, v44, v45
    v_cvt_pk_bf16_f32 v71, v46, v47
    s_waitcnt lgkmcnt(2)
    v_mfma_f32_32x32x16_bf16 v[32:47], v[120:123], v[16:19], 0
    v_exp_f32 v48, v48
    v_exp_f32 v49, v49
    v_exp_f32 v50, v50
    v_exp_f32 v51, v51
    v_mfma_f32_32x32x16_bf16 v[32:47], v[124:127], v[20:23], v[32:47]
    v_exp_f32 v52, v52
    v_exp_f32 v53, v53
    v_exp_f32 v54, v54
    v_exp_f32 v55, v55
    v_cvt_pk_bf16_f32 v72, v48, v49
    v_cvt_pk_bf16_f32 v73, v50, v51
    s_waitcnt lgkmcnt(0)
    v_mfma_f32_32x32x16_bf16 v[80:95], v[128:131], v[64:67], v[80:95]
    s_mov_b32 m0, s49
    s_nop 0
    buffer_load_dwordx4 v5, s[28:31], s48 offen offset:0 sc1 lds
    buffer_load_dwordx4 v5, s[28:31], s48 offen offset:1024 sc1 lds
    buffer_load_dwordx4 v5, s[28:31], s48 offen offset:2048 sc1 lds
    v_exp_f32 v56, v56
    v_exp_f32 v57, v57
    v_exp_f32 v58, v58
    v_exp_f32 v59, v59
    v_cvt_pk_bf16_f32 v74, v52, v53
    v_cvt_pk_bf16_f32 v75, v54, v55
    v_mfma_f32_32x32x16_bf16 v[80:95], v[132:135], v[68:71], v[80:95]
    v_exp_f32 v60, v60
    v_exp_f32 v61, v61
    v_exp_f32 v62, v62
    v_exp_f32 v63, v63
    v_cvt_pk_bf16_f32 v76, v56, v57
    v_cvt_pk_bf16_f32 v77, v58, v59
    v_cvt_pk_bf16_f32 v78, v60, v61
    v_cvt_pk_bf16_f32 v79, v62, v63
    v_mfma_f32_32x32x16_bf16 v[48:63], v[120:123], v[24:27], 0
    ds_read_b128 v[112:115], v2 offset:6144
    ds_read_b32 v116, v3 offset:6144
    ds_read_b128 v[136:139], v4 offset:3072
    ds_read_b128 v[140:143], v4 offset:3712
    v_exp_f32 v32, v32
    v_exp_f32 v33, v33
    v_exp_f32 v34, v34
    v_exp_f32 v35, v35
    v_mfma_f32_32x32x16_bf16 v[48:63], v[124:127], v[28:31], v[48:63]
    v_exp_f32 v36, v36
    v_exp_f32 v37, v37
    v_exp_f32 v38, v38
    v_exp_f32 v39, v39
    v_cvt_pk_bf16_f32 v64, v32, v33
    v_cvt_pk_bf16_f32 v65, v34, v35
    v_mfma_f32_32x32x16_bf16 v[96:111], v[128:131], v[72:75], v[96:111]
    v_exp_f32 v40, v40
    v_exp_f32 v41, v41
    v_exp_f32 v42, v42
    v_exp_f32 v43, v43
    v_cvt_pk_bf16_f32 v66, v36, v37
    v_cvt_pk_bf16_f32 v67, v38, v39
    v_mfma_f32_32x32x16_bf16 v[96:111], v[132:135], v[76:79], v[96:111]
    v_exp_f32 v44, v44
    v_exp_f32 v45, v45
    v_exp_f32 v46, v46
    v_exp_f32 v47, v47
    v_cvt_pk_bf16_f32 v68, v40, v41
    v_cvt_pk_bf16_f32 v69, v42, v43
    v_cvt_pk_bf16_f32 v70, v44, v45
    v_cvt_pk_bf16_f32 v71, v46, v47
    s_waitcnt lgkmcnt(2)
    v_mfma_f32_32x32x16_bf16 v[32:47], v[112:115], v[16:19], 0
    v_exp_f32 v48, v48
    v_exp_f32 v49, v49
    v_exp_f32 v50, v50
    v_exp_f32 v51, v51
    v_mfma_f32_32x32x16_bf16 v[32:47], v[116:119], v[20:23], v[32:47]
    v_exp_f32 v52, v52
    v_exp_f32 v53, v53
    v_exp_f32 v54, v54
    v_exp_f32 v55, v55
    v_cvt_pk_bf16_f32 v72, v48, v49
    v_cvt_pk_bf16_f32 v73, v50, v51
    s_waitcnt lgkmcnt(0)
    v_mfma_f32_32x32x16_bf16 v[80:95], v[136:139], v[64:67], v[80:95]
    s_waitcnt vmcnt(3)
    s_mov_b64 exec, 1
    ds_add_u32 v0, v0 offset:4
    s_mov_b64 exec, -1
    s_add_u32 s52, s52, s53
    v_exp_f32 v56, v56
    v_exp_f32 v57, v57
    v_exp_f32 v58, v58
    v_exp_f32 v59, v59
    v_cvt_pk_bf16_f32 v74, v52, v53
    v_cvt_pk_bf16_f32 v75, v54, v55
    v_mfma_f32_32x32x16_bf16 v[80:95], v[140:143], v[68:71], v[80:95]
    v_exp_f32 v60, v60
    v_exp_f32 v61, v61
    v_exp_f32 v62, v62
    v_exp_f32 v63, v63
    v_cvt_pk_bf16_f32 v76, v56, v57
    v_cvt_pk_bf16_f32 v77, v58, v59
    v_cvt_pk_bf16_f32 v78, v60, v61
    v_cvt_pk_bf16_f32 v79, v62, v63
    v_mfma_f32_32x32x16_bf16 v[48:63], v[112:115], v[24:27], 0
    ds_read_b128 v[120:123], v2 offset:9216
    ds_read_b32 v124, v3 offset:9216
    ds_read_b128 v[128:131], v4 offset:6144
    ds_read_b128 v[132:135], v4 offset:6784
    ds_read_b32 v15, v0 offset:4
    v_exp_f32 v32, v32
    v_exp_f32 v33, v33
    v_exp_f32 v34, v34
    v_exp_f32 v35, v35
    v_mfma_f32_32x32x16_bf16 v[48:63], v[116:119], v[28:31], v[48:63]
    v_exp_f32 v36, v36
    v_exp_f32 v37, v37
    v_exp_f32 v38, v38
    v_exp_f32 v39, v39
    v_cvt_pk_bf16_f32 v64, v32, v33
    v_cvt_pk_bf16_f32 v65, v34, v35
    v_mfma_f32_32x32x16_bf16 v[96:111], v[136:139], v[72:75], v[96:111]
    v_exp_f32 v40, v40
    v_exp_f32 v41, v41
    v_exp_f32 v42, v42
    v_exp_f32 v43, v43
    v_cvt_pk_bf16_f32 v66, v36, v37
    v_cvt_pk_bf16_f32 v67, v38, v39
    v_mfma_f32_32x32x16_bf16 v[96:111], v[140:143], v[76:79], v[96:111]
    v_exp_f32 v44, v44
    v_exp_f32 v45, v45
    v_exp_f32 v46, v46
    v_exp_f32 v47, v47
    v_cvt_pk_bf16_f32 v68, v40, v41
    v_cvt_pk_bf16_f32 v69, v42, v43
    v_cvt_pk_bf16_f32 v70, v44, v45
    v_cvt_pk_bf16_f32 v71, v46, v47
    s_waitcnt lgkmcnt(3)
    v_mfma_f32_32x32x16_bf16 v[32:47], v[120:123], v[16:19], 0
    v_exp_f32 v48, v48
    v_exp_f32 v49, v49
    v_exp_f32 v50, v50
    v_exp_f32 v51, v51
    v_mfma_f32_32x32x16_bf16 v[32:47], v[124:127], v[20:23], v[32:47]
    v_exp_f32 v52, v52
    v_exp_f32 v53, v53
    v_exp_f32 v54, v54
    v_exp_f32 v55, v55
    v_cvt_pk_bf16_f32 v72, v48, v49
    v_cvt_pk_bf16_f32 v73, v50, v51
    s_waitcnt lgkmcnt(1)
    v_mfma_f32_32x32x16_bf16 v[80:95], v[128:131], v[64:67], v[80:95]
    s_waitcnt lgkmcnt(0)
L_cr1:
    v_cmp_gt_u32 vcc, s52, v15
    s_cbranch_vccz L_cr1_ok
    s_add_u32 s3, s3, 1
    s_cmp_ge_u32 s3, 0x400000
    s_cbranch_scc1 L_cr1_ok
    ds_read_b32 v15, v0 offset:4
    s_waitcnt lgkmcnt(0)
    s_branch L_cr1
L_cr1_ok:
    v_exp_f32 v56, v56
    v_exp_f32 v57, v57
    v_exp_f32 v58, v58
    v_exp_f32 v59, v59
    v_cvt_pk_bf16_f32 v74, v52, v53
    v_cvt_pk_bf16_f32 v75, v54, v55
    v_mfma_f32_32x32x16_bf16 v[80:95], v[132:135], v[68:71], v[80:95]
    v_exp_f32 v60, v60
    v_exp_f32 v61, v61
    v_exp_f32 v62, v62
    v_exp_f32 v63, v63
    v_cvt_pk_bf16_f32 v76, v56, v57
    v_cvt_pk_bf16_f32 v77, v58, v59
    v_cvt_pk_bf16_f32 v78, v60, v61
    v_cvt_pk_bf16_f32 v79, v62, v63
    v_mfma_f32_32x32x16_bf16 v[48:63], v[120:123], v[24:27], 0
    v_add_u32 v2, s46, v2
    v_add_u32 v3, s46, v3
    ds_read_b128 v[112:115], v2 offset:0
    ds_read_b32 v116, v3 offset:0
    ds_read_b128 v[136:139], v4 offset:9216
    ds_read_b128 v[140:143], v4 offset:9856
    v_add_u32 v4, s46, v4
    ds_read_b32 v13, v0 offset:0
    v_exp_f32 v32, v32
    v_exp_f32 v33, v33
    v_exp_f32 v34, v34
    v_exp_f32 v35, v35
    v_mfma_f32_32x32x16_bf16 v[48:63], v[124:127], v[28:31], v[48:63]
    v_exp_f32 v36, v36
    v_exp_f32 v37, v37
    v_exp_f32 v38, v38
    v_exp_f32 v39, v39
    v_cvt_pk_bf16_f32 v64, v32, v33
    v_cvt_pk_bf16_f32 v65, v34, v35
    v_mfma_f32_32x32x16_bf16 v[96:111], v[128:131], v[72:75], v[96:111]
    v_exp_f32 v40, v40
    v_exp_f32 v41, v41
    v_exp_f32 v42, v42
    v_exp_f32 v43, v43
    v_cvt_pk_bf16_f32 v66, v36, v37
    v_cvt_pk_bf16_f32 v67, v38, v39
    v_mfma_f32_32x32x16_bf16 v[96:111], v[132:135], v[76:79], v[96:111]
    v_exp_f32 v44, v44
    v_exp_f32 v45, v45
    v_exp_f32 v46, v46
    v_exp_f32 v47, v47
    v_cvt_pk_bf16_f32 v68, v40, v41
    v_cvt_pk_bf16_f32 v69, v42, v43
    v_cvt_pk_bf16_f32 v70, v44, v45
    v_cvt_pk_bf16_f32 v71, v46, v47
    s_waitcnt lgkmcnt(3)
    v_mfma_f32_32x32x16_bf16 v[32:47], v[112:115], v[16:19], 0
    v_exp_f32 v48, v48
    v_exp_f32 v49, v49
    v_exp_f32 v50, v50
    v_exp_f32 v51, v51
    v_mfma_f32_32x32x16_bf16 v[32:47], v[116:119], v[20:23], v[32:47]
    v_exp_f32 v52, v52
    v_exp_f32 v53, v53
    v_exp_f32 v54, v54
    v_exp_f32 v55, v55
    v_cvt_pk_bf16_f32 v72, v48, v49
    v_cvt_pk_bf16_f32 v73, v50, v51
    s_waitcnt lgkmcnt(1)
    v_mfma_f32_32x32x16_bf16 v[80:95], v[136:139], v[64:67], v[80:95]
    s_mov_b64 exec, 1
    ds_add_u32 v0, v0 offset:4
    s_mov_b64 exec, -1
    s_add_u32 s52, s52, s53
    v_exp_f32 v56, v56
    v_exp_f32 v57, v57
    v_exp_f32 v58, v58
    v_exp_f32 v59, v59
    v_cvt_pk_bf16_f32 v74, v52, v53
    v_cvt_pk_bf16_f32 v75, v54, v55
    v_mfma_f32_32x32x16_bf16 v[80:95], v[140:143], v[68:71], v[80:95]
    v_exp_f32 v60, v60
    v_exp_f32 v61, v61
    v_exp_f32 v62, v62
    v_exp_f32 v63, v63
    v_cvt_pk_bf16_f32 v76, v56, v57
    v_cvt_pk_bf16_f32 v77, v58, v59
    v_cvt_pk_bf16_f32 v78, v60, v61
    v_cvt_pk_bf16_f32 v79, v62, v63
    s_add_u32 s47, s47, 1
    s_cmp_eq_u32 s47, 3
    s_cselect_b32 s47, 0, s47
    s_cmp_eq_u32 s47, 2
    s_cselect_b32 s46, 0xffffa000, s63
    s_add_u32 s48, s48, 12288
    s_cmp_eq_u32 s48, s10
    s_cselect_b32 s48, s45, s48
    s_add_u32 s49, s49, 12288
    s_add_u32 s40, s44, 36864
    s_cmp_eq_u32 s49, s40
    s_cselect_b32 s49, s44, s49
    s_add_u32 s54, s54, s57
    s_waitcnt lgkmcnt(1)
L_cp2:
    v_cmp_gt_u32 vcc, s54, v13
    s_cbranch_vccz L_cp2_ok
    s_add_u32 s3, s3, 1
    s_cmp_ge_u32 s3, 0x400000
    s_cbranch_scc1 L_cp2_ok
    s_sleep 2
    ds_read_b32 v13, v0 offset:0
    s_waitcnt lgkmcnt(0)
    s_branch L_cp2
L_cp2_ok:
    s_mov_b32 s50, 13
.p2align 6
L_at_loop:
    v_mfma_f32_32x32x16_bf16 v[48:63], v[112:115], v[24:27], 0
    ds_read_b128 v[120:123], v2 offset:3072
    ds_read_b32 v124, v3 offset:3072
    ds_read_b128 v[128:131], v4 offset:0
    ds_read_b128 v[132:135], v4 offset:640
    ds_read_b32 v15, v0 offset:4
    v_exp_f32 v32, v32
    v_exp_f32 v33, v33
    v_exp_f32 v34, v34
    v_exp_f32 v35, v35
    v_mfma_f32_32x32x16_bf16 v[48:63], v[116:119], v[28:31], v[48:63]
    v_exp_f32 v36, v36
    v_exp_f32 v37, v37
    v_exp_f32 v38, v38
    v_exp_f32 v39, v39
    v_cvt_pk_bf16_f32 v64, v32, v33
    v_cvt_pk_bf16_f32 v65, v34, v35
    v_mfma_f32_32x32x16_bf16 v[96:111], v[136:139], v[72:75], v[96:111]
    v_exp_f32 v40, v40
    v_exp_f32 v41, v41
    v_exp_f32 v42, v42
    v_exp_f32 v43, v43
    v_cvt_pk_bf16_f32 v66, v36, v37
    v_cvt_pk_bf16_f32 v67, v38, v39
    v_mfma_f32_32x32x16_bf16 v[96:111], v[140:143], v[76:79], v[96:111]
    v_exp_f32 v44, v44
    v_exp_f32 v45, v45
    v_exp_f32 v46, v46
    v_exp_f32 v47, v47
    v_cvt_pk_bf16_f32 v68, v40, v41
    v_cvt_pk_bf16_f32 v69, v42, v43
    v_cvt_pk_bf16_f32 v70, v44, v45
    v_cvt_pk_bf16_f32 v71, v46, v47
    s_waitcnt lgkmcnt(3)
    v_mfma_f32_32x32x16_bf16 v[32:47], v[120:123], v[16:19], 0
    v_exp_f32 v48, v48
    v_exp_f32 v49, v49
    v_exp_f32 v50, v50
    v_exp_f32 v51, v51
    v_mfma_f32_32x32x16_bf16 v[32:47], v[124:127], v[20:23], v[32:47]
    v_exp_f32 v52, v52
    v_exp_f32 v53, v53
    v_exp_f32 v54, v54
    v_exp_f32 v55, v55
    v_cvt_pk_bf16_f32 v72, v48, v49
    v_cvt_pk_bf16_f32 v73, v50, v51
    s_waitcnt lgkmcnt(1)
    v_mfma_f32_32x32x16_bf16 v[80:95], v[128:131], v[64:67], v[80:95]
    s_waitcnt lgkmcnt(0)
L_cw3:
    v_cmp_gt_u32 vcc, s52, v15
    s_cbranch_vccz L_cw3_ok
    s_add_u32 s3, s3, 1
    s_cmp_ge_u32 s3, 0x400000
    s_cbranch_scc1 L_cw3_ok
    ds_read_b32 v15, v0 offset:4
    s_waitcnt lgkmcnt(0)
    s_branch L_cw3
L_cw3_ok:
    s_mov_b32 m0, s49
    s_nop 0
    buffer_load_dwordx4 v5, s[28:31], s48 offen offset:0 sc1 lds
    buffer_load_dwordx4 v5, s[28:31], s48 offen offset:1024 sc1 lds
    buffer_load_dwordx4 v5, s[28:31], s48 offen offset:2048 sc1 lds
    v_exp_f32 v56, v56
    v_exp_f32 v57, v57
    v_exp_f32 v58, v58
    v_exp_f32 v59, v59
    v_cvt_pk_bf16_f32 v74, v52, v53
    v_cvt_pk_bf16_f32 v75, v54, v55
    v_mfma_f32_32x32x16_bf16 v[80:95], v[132:135], v[68:71], v[80:95]
    v_exp_f32 v60, v60
    v_exp_f32 v61, v61
    v_exp_f32 v62, v62
    v_exp_f32 v63, v63
    v_cvt_pk_bf16_f32 v76, v56, v57
    v_cvt_pk_bf16_f32 v77, v58, v59
    v_cvt_pk_bf16_f32 v78, v60, v61
    v_cvt_pk_bf16_f32 v79, v62, v63
    v_mfma_f32_32x32x16_bf16 v[48:63], v[120:123], v[24:27], 0
    ds_read_b128 v[112:115], v2 offset:6144
    ds_read_b32 v116, v3 offset:6144
    ds_read_b128 v[136:139], v4 offset:3072
    ds_read_b128 v[140:143], v4 offset:3712
    v_exp_f32 v32, v32
    v_exp_f32 v33, v33
    v_exp_f32 v34, v34
    v_exp_f32 v35, v35
    v_mfma_f32_32x32x16_bf16 v[48:63], v[124:127], v[28:31], v[48:63]
    v_exp_f32 v36, v36
    v_exp_f32 v37, v37
    v_exp_f32 v38, v38
    v_exp_f32 v39, v39
    v_cvt_pk_bf16_f32 v64, v32, v33
    v_cvt_pk_bf16_f32 v65, v34, v35
    v_mfma_f32_32x32x16_bf16 v[96:111], v[128:131], v[72:75], v[96:111]
    v_exp_f32 v40, v40
    v_exp_f32 v41, v41
    v_exp_f32 v42, v42
    v_exp_f32 v43, v43
    v_cvt_pk_bf16_f32 v66, v36, v37
    v_cvt_pk_bf16_f32 v67, v38, v39
    v_mfma_f32_32x32x16_bf16 v[96:111], v[132:135], v[76:79], v[96:111]
    v_exp_f32 v44, v44
    v_exp_f32 v45, v45
    v_exp_f32 v46, v46
    v_exp_f32 v47, v47
    v_cvt_pk_bf16_f32 v68, v40, v41
    v_cvt_pk_bf16_f32 v69, v42, v43
    v_cvt_pk_bf16_f32 v70, v44, v45
    v_cvt_pk_bf16_f32 v71, v46, v47
    s_waitcnt lgkmcnt(2)
    v_mfma_f32_32x32x16_bf16 v[32:47], v[112:115], v[16:19], 0
    v_exp_f32 v48, v48
    v_exp_f32 v49, v49
    v_exp_f32 v50, v50
    v_exp_f32 v51, v51
    v_mfma_f32_32x32x16_bf16 v[32:47], v[116:119], v[20:23], v[32:47]
    v_exp_f32 v52, v52
    v_exp_f32 v53, v53
    v_exp_f32 v54, v54
    v_exp_f32 v55, v55
    v_cvt_pk_bf16_f32 v72, v48, v49
    v_cvt_pk_bf16_f32 v73, v50, v51
    s_waitcnt lgkmcnt(0)
    v_mfma_f32_32x32x16_bf16 v[80:95], v[136:139], v[64:67], v[80:95]
    s_waitcnt vmcnt(3)
    s_mov_b64 exec, 1
    ds_add_u32 v0, v0 offset:4
    s_mov_b64 exec, -1
    s_add_u32 s52, s52, s53
    s_cmp_lg_u32 s50, s62
    s_cbranch_scc1 L_at_notouch
    buffer_load_dword v146, v144, s[4:7], s8 offen
    buffer_load_dword v147, v145, s[20:23], s9 offen
L_at_notouch:
    v_exp_f32 v56, v56
    v_exp_f32 v57, v57
    v_exp_f32 v58, v58
    v_exp_f32 v59, v59
    v_cvt_pk_bf16_f32 v74, v52, v53
    v_cvt_pk_bf16_f32 v75, v54, v55
    v_mfma_f32_32x32x16_bf16 v[80:95], v[140:143], v[68:71], v[80:95]
    v_exp_f32 v60, v60
    v_exp_f32 v61, v61
    v_exp_f32 v62, v62
    v_exp_f32 v63, v63
    v_cvt_pk_bf16_f32 v76, v56, v57
    v_cvt_pk_bf16_f32 v77, v58, v59
    v_cvt_pk_bf16_f32 v78, v60, v61
    v_cvt_pk_bf16_f32 v79, v62, v63
    v_mfma_f32_32x32x16_bf16 v[48:63], v[112:115], v[24:27], 0
    ds_read_b128 v[120:123], v2 offset:9216
    ds_read_b32 v124, v3 offset:9216
    ds_read_b128 v[128:131], v4 offset:6144
    ds_read_b128 v[132:135], v4 offset:6784
    ds_read_b32 v15, v0 offset:4
    v_exp_f32 v32, v32
    v_exp_f32 v33, v33
    v_exp_f32 v34, v34
    v_exp_f32 v35, v35
    v_mfma_f32_32x32x16_bf16 v[48:63], v[116:119], v[28:31], v[48:63]
    v_exp_f32 v36, v36
    v_exp_f32 v37, v37
    v_exp_f32 v38, v38
    v_exp_f32 v39, v39
    v_cvt_pk_bf16_f32 v64, v32, v33
    v_cvt_pk_bf16_f32 v65, v34, v35
    v_mfma_f32_32x32x16_bf16 v[96:111], v[136:139], v[72:75], v[96:111]
    v_exp_f32 v40, v40
    v_exp_f32 v41, v41
    v_exp_f32 v42, v42
    v_exp_f32 v43, v43
    v_cvt_pk_bf16_f32 v66, v36, v37
    v_cvt_pk_bf16_f32 v67, v38, v39
    v_mfma_f32_32x32x16_bf16 v[96:111], v[140:143], v[76:79], v[96:111]
    v_exp_f32 v44, v44
    v_exp_f32 v45, v45
    v_exp_f32 v46, v46
    v_exp_f32 v47, v47
    v_cvt_pk_bf16_f32 v68, v40, v41
    v_cvt_pk_bf16_f32 v69, v42, v43
    v_cvt_pk_bf16_f32 v70, v44, v45
    v_cvt_pk_bf16_f32 v71, v46, v47
    s_waitcnt lgkmcnt(3)
    v_mfma_f32_32x32x16_bf16 v[32:47], v[120:123], v[16:19], 0
    v_exp_f32 v48, v48
    v_exp_f32 v49, v49
    v_exp_f32 v50, v50
    v_exp_f32 v51, v51
    v_mfma_f32_32x32x16_bf16 v[32:47], v[124:127], v[20:23], v[32:47]
    v_exp_f32 v52, v52
    v_exp_f32 v53, v53
    v_exp_f32 v54, v54
    v_exp_f32 v55, v55
    v_cvt_pk_bf16_f32 v72, v48, v49
    v_cvt_pk_bf16_f32 v73, v50, v51
    s_waitcnt lgkmcnt(1)
    v_mfma_f32_32x32x16_bf16 v[80:95], v[128:131], v[64:67], v[80:95]
    s_waitcnt lgkmcnt(0)
L_cr3:
    v_cmp_gt_u32 vcc, s52, v15
    s_cbranch_vccz L_cr3_ok
    s_add_u32 s3, s3, 1
    s_cmp_ge_u32 s3, 0x400000
    s_cbranch_scc1 L_cr3_ok
    ds_read_b32 v15, v0 offset:4
    s_waitcnt lgkmcnt(0)
    s_branch L_cr3
L_cr3_ok:
    v_exp_f32 v56, v56
    v_exp_f32 v57, v57
    v_exp_f32 v58, v58
    v_exp_f32 v59, v59
    v_cvt_pk_bf16_f32 v74, v52, v53
    v_cvt_pk_bf16_f32 v75, v54, v55
    v_mfma_f32_32x32x16_bf16 v[80:95], v[132:135], v[68:71], v[80:95]
    v_exp_f32 v60, v60
    v_exp_f32 v61, v61
    v_exp_f32 v62, v62
    v_exp_f32 v63, v63
    v_cvt_pk_bf16_f32 v76, v56, v57
    v_cvt_pk_bf16_f32 v77, v58, v59
    v_cvt_pk_bf16_f32 v78, v60, v61
    v_cvt_pk_bf16_f32 v79, v62, v63
    v_mfma_f32_32x32x16_bf16 v[48:63], v[120:123], v[24:27], 0
    v_add_u32 v2, s46, v2
    v_add_u32 v3, s46, v3
    ds_read_b128 v[112:115], v2 offset:0
    ds_read_b32 v116, v3 offset:0
    ds_read_b128 v[136:139], v4 offset:9216
    ds_read_b128 v[140:143], v4 offset:9856
    v_add_u32 v4, s46, v4
    ds_read_b32 v13, v0 offset:0
    v_exp_f32 v32, v32
    v_exp_f32 v33, v33
    v_exp_f32 v34, v34
    v_exp_f32 v35, v35
    v_mfma_f32_32x32x16_bf16 v[48:63], v[124:127], v[28:31], v[48:63]
    v_exp_f32 v36, v36
    v_exp_f32 v37, v37
    v_exp_f32 v38, v38
    v_exp_f32 v39, v39
    v_cvt_pk_bf16_f32 v64, v32, v33
    v_cvt_pk_bf16_f32 v65, v34, v35
    v_mfma_f32_32x32x16_bf16 v[96:111], v[128:131], v[72:75], v[96:111]
    v_exp_f32 v40, v40
    v_exp_f32 v41, v41
    v_exp_f32 v42, v42
    v_exp_f32 v43, v43
    v_cvt_pk_bf16_f32 v66, v36, v37
    v_cvt_pk_bf16_f32 v67, v38, v39
    v_mfma_f32_32x32x16_bf16 v[96:111], v[132:135], v[76:79], v[96:111]
    v_exp_f32 v44, v44
    v_exp_f32 v45, v45
    v_exp_f32 v46, v46
    v_exp_f32 v47, v47
    v_cvt_pk_bf16_f32 v68, v40, v41
    v_cvt_pk_bf16_f32 v69, v42, v43
    v_cvt_pk_bf16_f32 v70, v44, v45
    v_cvt_pk_bf16_f32 v71, v46, v47
    s_waitcnt lgkmcnt(3)
    v_mfma_f32_32x32x16_bf16 v[32:47], v[112:115], v[16:19], 0
    v_exp_f32 v48, v48
    v_exp_f32 v49, v49
    v_exp_f32 v50, v50
    v_exp_f32 v51, v51
    v_mfma_f32_32x32x16_bf16 v[32:47], v[116:119], v[20:23], v[32:47]
    v_exp_f32 v52, v52
    v_exp_f32 v53, v53
    v_exp_f32 v54, v54
    v_exp_f32 v55, v55
    v_cvt_pk_bf16_f32 v72, v48, v49
    v_cvt_pk_bf16_f32 v73, v50, v51
    s_waitcnt lgkmcnt(1)
    v_mfma_f32_32x32x16_bf16 v[80:95], v[136:139], v[64:67], v[80:95]
    s_mov_b64 exec, 1
    ds_add_u32 v0, v0 offset:4
    s_mov_b64 exec, -1
    s_add_u32 s52, s52, s53
    v_exp_f32 v56, v56
    v_exp_f32 v57, v57
    v_exp_f32 v58, v58
    v_exp_f32 v59, v59
    v_cvt_pk_bf16_f32 v74, v52, v53
    v_cvt_pk_bf16_f32 v75, v54, v55
    v_mfma_f32_32x32x16_bf16 v[80:95], v[140:143], v[68:71], v[80:95]
    v_exp_f32 v60, v60
    v_exp_f32 v61, v61
    v_exp_f32 v62, v62
    v_exp_f32 v63, v63
    v_cvt_pk_bf16_f32 v76, v56, v57
    v_cvt_pk_bf16_f32 v77, v58, v59
    v_cvt_pk_bf16_f32 v78, v60, v61
    v_cvt_pk_bf16_f32 v79, v62, v63
    s_add_u32 s47, s47, 1
    s_cmp_eq_u32 s47, 3
    s_cselect_b32 s47, 0, s47
    s_cmp_eq_u32 s47, 2
    s_cselect_b32 s46, 0xffffa000, s63
    s_add_u32 s48, s48, 12288
    s_cmp_eq_u32 s48, s10
    s_cselect_b32 s48, s45, s48
    s_add_u32 s49, s49, 12288
    s_add_u32 s40, s44, 36864
    s_cmp_eq_u32 s49, s40
    s_cselect_b32 s49, s44, s49
    s_add_u32 s54, s54, s57
    s_waitcnt lgkmcnt(1)
L_cp4:
    v_cmp_gt_u32 vcc, s54, v13
    s_cbranch_vccz L_cp4_ok
    s_add_u32 s3, s3, 1
    s_cmp_ge_u32 s3, 0x400000
    s_cbranch_scc1 L_cp4_ok
    s_sleep 2
    ds_read_b32 v13, v0 offset:0
    s_waitcnt lgkmcnt(0)
    s_branch L_cp4
L_cp4_ok:
    s_sub_u32 s50, s50, 1
    s_cmp_lg_u32 s50, 0
    s_cbranch_scc1 L_at_loop
    v_mfma_f32_32x32x16_bf16 v[48:63], v[112:115], v[24:27], 0
    ds_read_b128 v[120:123], v2 offset:3072
    ds_read_b32 v124, v3 offset:3072
    ds_read_b128 v[128:131], v4 offset:0
    ds_read_b128 v[132:135], v4 offset:640
    ds_read_b32 v15, v0 offset:4
    v_exp_f32 v32, v32
    v_exp_f32 v33, v33
    v_exp_f32 v34, v34
    v_exp_f32 v35, v35
    v_mfma_f32_32x32x16_bf16 v[48:63], v[116:119], v[28:31], v[48:63]
    v_exp_f32 v36, v36
    v_exp_f32 v37, v37
    v_exp_f32 v38, v38
    v_exp_f32 v39, v39
    v_cvt_pk_bf16_f32 v64, v32, v33
    v_cvt_pk_bf16_f32 v65, v34, v35
    v_mfma_f32_32x32x16_bf16 v[96:111], v[136:139], v[72:75], v[96:111]
    v_exp_f32 v40, v40
    v_exp_f32 v41, v41
    v_exp_f32 v42, v42
    v_exp_f32 v43, v43
    v_cvt_pk_bf16_f32 v66, v36, v37
    v_cvt_pk_bf16_f32 v67, v38, v39
    v_mfma_f32_32x32x16_bf16 v[96:111], v[140:143], v[76:79], v[96:111]
    v_exp_f32 v44, v44
    v_exp_f32 v45, v45
    v_exp_f32 v46, v46
    v_exp_f32 v47, v47
    v_cvt_pk_bf16_f32 v68, v40, v41
    v_cvt_pk_bf16_f32 v69, v42, v43
    v_cvt_pk_bf16_f32 v70, v44, v45
    v_cvt_pk_bf16_f32 v71, v46, v47
    s_waitcnt lgkmcnt(3)
    v_mfma_f32_32x32x16_bf16 v[32:47], v[120:123], v[16:19], 0
    v_exp_f32 v48, v48
    v_exp_f32 v49, v49
    v_exp_f32 v50, v50
    v_exp_f32 v51, v51
    v_mfma_f32_32x32x16_bf16 v[32:47], v[124:127], v[20:23], v[32:47]
    v_exp_f32 v52, v52
    v_exp_f32 v53, v53
    v_exp_f32 v54, v54
    v_exp_f32 v55, v55
    v_cvt_pk_bf16_f32 v72, v48, v49
    v_cvt_pk_bf16_f32 v73, v50, v51
    s_waitcnt lgkmcnt(1)
    v_mfma_f32_32x32x16_bf16 v[80:95], v[128:131], v[64:67], v[80:95]
    s_waitcnt lgkmcnt(0)
L_cw5:
    v_cmp_gt_u32 vcc, s52, v15
    s_cbranch_vccz L_cw5_ok
    s_add_u32 s3, s3, 1
    s_cmp_ge_u32 s3, 0x400000
    s_cbranch_scc1 L_cw5_ok
    ds_read_b32 v15, v0 offset:4
    s_waitcnt lgkmcnt(0)
    s_branch L_cw5
L_cw5_ok:
    v_exp_f32 v56, v56
    v_exp_f32 v57, v57
    v_exp_f32 v58, v58
    v_exp_f32 v59, v59
    v_cvt_pk_bf16_f32 v74, v52, v53
    v_cvt_pk_bf16_f32 v75, v54, v55
    v_mfma_f32_32x32x16_bf16 v[80:95], v[132:135], v[68:71], v[80:95]
    v_exp_f32 v60, v60
    v_exp_f32 v61, v61
    v_exp_f32 v62, v62
    v_exp_f32 v63, v63
    v_cvt_pk_bf16_f32 v76, v56, v57
    v_cvt_pk_bf16_f32 v77, v58, v59
    v_cvt_pk_bf16_f32 v78, v60, v61
    v_cvt_pk_bf16_f32 v79, v62, v63
    v_mfma_f32_32x32x16_bf16 v[48:63], v[120:123], v[24:27], 0
    ds_read_b128 v[112:115], v2 offset:6144
    ds_read_b32 v116, v3 offset:6144
    ds_read_b128 v[136:139], v4 offset:3072
    ds_read_b128 v[140:143], v4 offset:3712
    v_exp_f32 v32, v32
    v_exp_f32 v33, v33
    v_exp_f32 v34, v34
    v_exp_f32 v35, v35
    v_mfma_f32_32x32x16_bf16 v[48:63], v[124:127], v[28:31], v[48:63]
    v_exp_f32 v36, v36
    v_exp_f32 v37, v37
    v_exp_f32 v38, v38
    v_exp_f32 v39, v39
    v_cvt_pk_bf16_f32 v64, v32, v33
    v_cvt_pk_bf16_f32 v65, v34, v35
    v_mfma_f32_32x32x16_bf16 v[96:111], v[128:131], v[72:75], v[96:111]
    v_exp_f32 v40, v40
    v_exp_f32 v41, v41
    v_exp_f32 v42, v42
    v_exp_f32 v43, v43
    v_cvt_pk_bf16_f32 v66, v36, v37
    v_cvt_pk_bf16_f32 v67, v38, v39
    v_mfma_f32_32x32x16_bf16 v[96:111], v[132:135], v[76:79], v[96:111]
    v_exp_f32 v44, v44
    v_exp_f32 v45, v45
    v_exp_f32 v46, v46
    v_exp_f32 v47, v47
    v_cvt_pk_bf16_f32 v68, v40, v41
    v_cvt_pk_bf16_f32 v69, v42, v43
    v_cvt_pk_bf16_f32 v70, v44, v45
    v_cvt_pk_bf16_f32 v71, v46, v47
    s_waitcnt lgkmcnt(2)
    v_mfma_f32_32x32x16_bf16 v[32:47], v[112:115], v[16:19], 0
    v_exp_f32 v48, v48
    v_exp_f32 v49, v49
    v_exp_f32 v50, v50
    v_exp_f32 v51, v51
    v_mfma_f32_32x32x16_bf16 v[32:47], v[116:119], v[20:23], v[32:47]
    v_exp_f32 v52, v52
    v_exp_f32 v53, v53
    v_exp_f32 v54, v54
    v_exp_f32 v55, v55
    v_cvt_pk_bf16_f32 v72, v48, v49
    v_cvt_pk_bf16_f32 v73, v50, v51
    s_waitcnt lgkmcnt(0)
    v_mfma_f32_32x32x16_bf16 v[80:95], v[136:139], v[64:67], v[80:95]
    s_waitcnt vmcnt(0)
    s_mov_b64 exec, 1
    ds_add_u32 v0, v0 offset:4
    s_mov_b64 exec, -1
    s_add_u32 s52, s52, s53
    v_exp_f32 v56, v56
    v_exp_f32 v57, v57
    v_exp_f32 v58, v58
    v_exp_f32 v59, v59
    v_cvt_pk_bf16_f32 v74, v52, v53
    v_cvt_pk_bf16_f32 v75, v54, v55
    v_mfma_f32_32x32x16_bf16 v[80:95], v[140:143], v[68:71], v[80:95]
    v_exp_f32 v60, v60
    v_exp_f32 v61, v61
    v_exp_f32 v62, v62
    v_exp_f32 v63, v63
    v_cvt_pk_bf16_f32 v76, v56, v57
    v_cvt_pk_bf16_f32 v77, v58, v59
    v_cvt_pk_bf16_f32 v78, v60, v61
    v_cvt_pk_bf16_f32 v79, v62, v63
    v_mfma_f32_32x32x16_bf16 v[48:63], v[112:115], v[24:27], 0
    ds_read_b128 v[120:123], v2 offset:9216
    ds_read_b32 v124, v3 offset:9216
    ds_read_b128 v[128:131], v4 offset:6144
    ds_read_b128 v[132:135], v4 offset:6784
    ds_read_b32 v15, v0 offset:4
    v_exp_f32 v32, v32
    v_exp_f32 v33, v33
    v_exp_f32 v34, v34
    v_exp_f32 v35, v35
    v_mfma_f32_32x32x16_bf16 v[48:63], v[116:119], v[28:31], v[48:63]
    v_exp_f32 v36, v36
    v_exp_f32 v37, v37
    v_exp_f32 v38, v38
    v_exp_f32 v39, v39
    v_cvt_pk_bf16_f32 v64, v32, v33
    v_cvt_pk_bf16_f32 v65, v34, v35
    v_mfma_f32_32x32x16_bf16 v[96:111], v[136:139], v[72:75], v[96:111]
    v_exp_f32 v40, v40
    v_exp_f32 v41, v41
    v_exp_f32 v42, v42
    v_exp_f32 v43, v43
    v_cvt_pk_bf16_f32 v66, v36, v37
    v_cvt_pk_bf16_f32 v67, v38, v39
    v_mfma_f32_32x32x16_bf16 v[96:111], v[140:143], v[76:79], v[96:111]
    v_exp_f32 v44, v44
    v_exp_f32 v45, v45
    v_exp_f32 v46, v46
    v_exp_f32 v47, v47
    v_cvt_pk_bf16_f32 v68, v40, v41
    v_cvt_pk_bf16_f32 v69, v42, v43
    v_cvt_pk_bf16_f32 v70, v44, v45
    v_cvt_pk_bf16_f32 v71, v46, v47
    s_waitcnt lgkmcnt(3)
    v_mfma_f32_32x32x16_bf16 v[32:47], v[120:123], v[16:19], 0
    v_exp_f32 v48, v48
    v_exp_f32 v49, v49
    v_exp_f32 v50, v50
    v_exp_f32 v51, v51
    v_mfma_f32_32x32x16_bf16 v[32:47], v[124:127], v[20:23], v[32:47]
    v_exp_f32 v52, v52
    v_exp_f32 v53, v53
    v_exp_f32 v54, v54
    v_exp_f32 v55, v55
    v_cvt_pk_bf16_f32 v72, v48, v49
    v_cvt_pk_bf16_f32 v73, v50, v51
    s_waitcnt lgkmcnt(1)
    v_mfma_f32_32x32x16_bf16 v[80:95], v[128:131], v[64:67], v[80:95]
    s_waitcnt lgkmcnt(0)
L_cr5:
    v_cmp_gt_u32 vcc, s52, v15
    s_cbranch_vccz L_cr5_ok
    s_add_u32 s3, s3, 1
    s_cmp_ge_u32 s3, 0x400000
    s_cbranch_scc1 L_cr5_ok
    ds_read_b32 v15, v0 offset:4
    s_waitcnt lgkmcnt(0)
    s_branch L_cr5
L_cr5_ok:
    v_exp_f32 v56, v56
    v_exp_f32 v57, v57
    v_exp_f32 v58, v58
    v_exp_f32 v59, v59
    v_cvt_pk_bf16_f32 v74, v52, v53
    v_cvt_pk_bf16_f32 v75, v54, v55
    v_mfma_f32_32x32x16_bf16 v[80:95], v[132:135], v[68:71], v[80:95]
    v_exp_f32 v60, v60
    v_exp_f32 v61, v61
    v_exp_f32 v62, v62
    v_exp_f32 v63, v63
    v_cvt_pk_bf16_f32 v76, v56, v57
    v_cvt_pk_bf16_f32 v77, v58, v59
    v_cvt_pk_bf16_f32 v78, v60, v61
    v_cvt_pk_bf16_f32 v79, v62, v63
    v_mfma_f32_32x32x16_bf16 v[48:63], v[120:123], v[24:27], 0
    v_add_u32 v2, s46, v2
    v_add_u32 v3, s46, v3
    ds_read_b128 v[112:115], v2 offset:0
    ds_read_b32 v116, v3 offset:0
    ds_read_b128 v[136:139], v4 offset:9216
    ds_read_b128 v[140:143], v4 offset:9856
    v_add_u32 v4, s46, v4
    ds_read_b32 v13, v0 offset:0
    v_exp_f32 v32, v32
    v_exp_f32 v33, v33
    v_exp_f32 v34, v34
    v_exp_f32 v35, v35
    v_mfma_f32_32x32x16_bf16 v[48:63], v[124:127], v[28:31], v[48:63]
    v_exp_f32 v36, v36
    v_exp_f32 v37, v37
    v_exp_f32 v38, v38
    v_exp_f32 v39, v39
    v_cvt_pk_bf16_f32 v64, v32, v33
    v_cvt_pk_bf16_f32 v65, v34, v35
    v_mfma_f32_32x32x16_bf16 v[96:111], v[128:131], v[72:75], v[96:111]
    v_exp_f32 v40, v40
    v_exp_f32 v41, v41
    v_exp_f32 v42, v42
    v_exp_f32 v43, v43
    v_cvt_pk_bf16_f32 v66, v36, v37
    v_cvt_pk_bf16_f32 v67, v38, v39
    v_mfma_f32_32x32x16_bf16 v[96:111], v[132:135], v[76:79], v[96:111]
    v_exp_f32 v44, v44
    v_exp_f32 v45, v45
    v_exp_f32 v46, v46
    v_exp_f32 v47, v47
    v_cvt_pk_bf16_f32 v68, v40, v41
    v_cvt_pk_bf16_f32 v69, v42, v43
    v_cvt_pk_bf16_f32 v70, v44, v45
    v_cvt_pk_bf16_f32 v71, v46, v47
    s_waitcnt lgkmcnt(3)
    v_mfma_f32_32x32x16_bf16 v[32:47], v[112:115], v[16:19], 0
    v_exp_f32 v48, v48
    v_exp_f32 v49, v49
    v_exp_f32 v50, v50
    v_exp_f32 v51, v51
    v_mfma_f32_32x32x16_bf16 v[32:47], v[116:119], v[20:23], v[32:47]
    v_exp_f32 v52, v52
    v_exp_f32 v53, v53
    v_exp_f32 v54, v54
    v_exp_f32 v55, v55
    v_cvt_pk_bf16_f32 v72, v48, v49
    v_cvt_pk_bf16_f32 v73, v50, v51
    s_waitcnt lgkmcnt(1)
    v_mfma_f32_32x32x16_bf16 v[80:95], v[136:139], v[64:67], v[80:95]
    s_mov_b64 exec, 1
    ds_add_u32 v0, v0 offset:4
    s_mov_b64 exec, -1
    s_add_u32 s52, s52, s53
    v_exp_f32 v56, v56
    v_exp_f32 v57, v57
    v_exp_f32 v58, v58
    v_exp_f32 v59, v59
    v_cvt_pk_bf16_f32 v74, v52, v53
    v_cvt_pk_bf16_f32 v75, v54, v55
    v_mfma_f32_32x32x16_bf16 v[80:95], v[140:143], v[68:71], v[80:95]
    v_exp_f32 v60, v60
    v_exp_f32 v61, v61
    v_exp_f32 v62, v62
    v_exp_f32 v63, v63
    v_cvt_pk_bf16_f32 v76, v56, v57
    v_cvt_pk_bf16_f32 v77, v58, v59
    v_cvt_pk_bf16_f32 v78, v60, v61
    v_cvt_pk_bf16_f32 v79, v62, v63
    s_add_u32 s47, s47, 1
    s_cmp_eq_u32 s47, 3
    s_cselect_b32 s47, 0, s47
    s_cmp_eq_u32 s47, 2
    s_cselect_b32 s46, 0xffffa000, s63
    s_add_u32 s48, s48, 12288
    s_cmp_eq_u32 s48, s10
    s_cselect_b32 s48, s45, s48
    s_add_u32 s49, s49, 12288
    s_add_u32 s40, s44, 36864
    s_cmp_eq_u32 s49, s40
    s_cselect_b32 s49, s44, s49
    s_add_u32 s54, s54, s57
    s_waitcnt lgkmcnt(1)
L_cp6:
    v_cmp_gt_u32 vcc, s54, v13
    s_cbranch_vccz L_cp6_ok
    s_add_u32 s3, s3, 1
    s_cmp_ge_u32 s3, 0x400000
    s_cbranch_scc1 L_cp6_ok
    s_sleep 2
    ds_read_b32 v13, v0 offset:0
    s_waitcnt lgkmcnt(0)
    s_branch L_cp6
L_cp6_ok:
    v_mfma_f32_32x32x16_bf16 v[48:63], v[112:115], v[24:27], 0
    ds_read_b128 v[120:123], v2 offset:3072
    ds_read_b32 v124, v3 offset:3072
    ds_read_b128 v[128:131], v4 offset:0
    ds_read_b128 v[132:135], v4 offset:640
    v_exp_f32 v32, v32
    v_exp_f32 v33, v33
    v_exp_f32 v34, v34
    v_exp_f32 v35, v35
    v_mfma_f32_32x32x16_bf16 v[48:63], v[116:119], v[28:31], v[48:63]
    v_exp_f32 v36, v36
    v_exp_f32 v37, v37
    v_exp_f32 v38, v38
    v_exp_f32 v39, v39
    v_cvt_pk_bf16_f32 v64, v32, v33
    v_cvt_pk_bf16_f32 v65, v34, v35
    v_mfma_f32_32x32x16_bf16 v[96:111], v[136:139], v[72:75], v[96:111]
    v_exp_f32 v40, v40
    v_exp_f32 v41, v41
    v_exp_f32 v42, v42
    v_exp_f32 v43, v43
    v_cvt_pk_bf16_f32 v66, v36, v37
    v_cvt_pk_bf16_f32 v67, v38, v39
    v_mfma_f32_32x32x16_bf16 v[96:111], v[140:143], v[76:79], v[96:111]
    v_exp_f32 v44, v44
    v_exp_f32 v45, v45
    v_exp_f32 v46, v46
    v_exp_f32 v47, v47
    v_cvt_pk_bf16_f32 v68, v40, v41
    v_cvt_pk_bf16_f32 v69, v42, v43
    v_cvt_pk_bf16_f32 v70, v44, v45
    v_cvt_pk_bf16_f32 v71, v46, v47
    s_waitcnt lgkmcnt(2)
    v_mfma_f32_32x32x16_bf16 v[32:47], v[120:123], v[16:19], 0
    v_exp_f32 v48, v48
    v_exp_f32 v49, v49
    v_exp_f32 v50, v50
    v_exp_f32 v51, v51
    v_mfma_f32_32x32x16_bf16 v[32:47], v[124:127], v[20:23], v[32:47]
    v_exp_f32 v52, v52
    v_exp_f32 v53, v53
    v_exp_f32 v54, v54
    v_exp_f32 v55, v55
    v_cvt_pk_bf16_f32 v72, v48, v49
    v_cvt_pk_bf16_f32 v73, v50, v51
    s_waitcnt lgkmcnt(0)
    v_mfma_f32_32x32x16_bf16 v[80:95], v[128:131], v[64:67], v[80:95]
    v_exp_f32 v56, v56
    v_exp_f32 v57, v57
    v_exp_f32 v58, v58
    v_exp_f32 v59, v59
    v_cvt_pk_bf16_f32 v74, v52, v53
    v_cvt_pk_bf16_f32 v75, v54, v55
    v_mfma_f32_32x32x16_bf16 v[80:95], v[132:135], v[68:71], v[80:95]
    v_exp_f32 v60, v60
    v_exp_f32 v61, v61
    v_exp_f32 v62, v62
    v_exp_f32 v63, v63
    v_cvt_pk_bf16_f32 v76, v56, v57
    v_cvt_pk_bf16_f32 v77, v58, v59
    v_cvt_pk_bf16_f32 v78, v60, v61
    v_cvt_pk_bf16_f32 v79, v62, v63
    v_mfma_f32_32x32x16_bf16 v[48:63], v[120:123], v[24:27], 0
    ds_read_b128 v[112:115], v2 offset:6144
    ds_read_b32 v116, v3 offset:6144
    ds_read_b128 v[136:139], v4 offset:3072
    ds_read_b128 v[140:143], v4 offset:3712
    v_exp_f32 v32, v32
    v_exp_f32 v33, v33
    v_exp_f32 v34, v34
    v_exp_f32 v35, v35
    v_mfma_f32_32x32x16_bf16 v[48:63], v[124:127], v[28:31], v[48:63]
    v_exp_f32 v36, v36
    v_exp_f32 v37, v37
    v_exp_f32 v38, v38
    v_exp_f32 v39, v39
    v_cvt_pk_bf16_f32 v64, v32, v33
    v_cvt_pk_bf16_f32 v65, v34, v35
    v_mfma_f32_32x32x16_bf16 v[96:111], v[128:131], v[72:75], v[96:111]
    v_exp_f32 v40, v40
    v_exp_f32 v41, v41
    v_exp_f32 v42, v42
    v_exp_f32 v43, v43
    v_cvt_pk_bf16_f32 v66, v36, v37
    v_cvt_pk_bf16_f32 v67, v38, v39
    v_mfma_f32_32x32x16_bf16 v[96:111], v[132:135], v[76:79], v[96:111]
    v_exp_f32 v44, v44
    v_exp_f32 v45, v45
    v_exp_f32 v46, v46
    v_exp_f32 v47, v47
    v_cvt_pk_bf16_f32 v68, v40, v41
    v_cvt_pk_bf16_f32 v69, v42, v43
    v_cvt_pk_bf16_f32 v70, v44, v45
    v_cvt_pk_bf16_f32 v71, v46, v47
    s_waitcnt lgkmcnt(2)
    v_mfma_f32_32x32x16_bf16 v[32:47], v[112:115], v[16:19], 0
    v_exp_f32 v48, v48
    v_exp_f32 v49, v49
    v_exp_f32 v50, v50
    v_exp_f32 v51, v51
    v_mfma_f32_32x32x16_bf16 v[32:47], v[116:119], v[20:23], v[32:47]
    v_exp_f32 v52, v52
    v_exp_f32 v53, v53
    v_exp_f32 v54, v54
    v_exp_f32 v55, v55
    v_cvt_pk_bf16_f32 v72, v48, v49
    v_cvt_pk_bf16_f32 v73, v50, v51
    s_waitcnt lgkmcnt(0)
    v_mfma_f32_32x32x16_bf16 v[80:95], v[136:139], v[64:67], v[80:95]
    v_exp_f32 v56, v56
    v_exp_f32 v57, v57
    v_exp_f32 v58, v58
    v_exp_f32 v59, v59
    v_cvt_pk_bf16_f32 v74, v52, v53
    v_cvt_pk_bf16_f32 v75, v54, v55
    v_mfma_f32_32x32x16_bf16 v[80:95], v[140:143], v[68:71], v[80:95]
    v_exp_f32 v60, v60
    v_exp_f32 v61, v61
    v_exp_f32 v62, v62
    v_exp_f32 v63, v63
    v_cvt_pk_bf16_f32 v76, v56, v57
    v_cvt_pk_bf16_f32 v77, v58, v59
    v_cvt_pk_bf16_f32 v78, v60, v61
    v_cvt_pk_bf16_f32 v79, v62, v63
    v_mfma_f32_32x32x16_bf16 v[48:63], v[112:115], v[24:27], 0
    ds_read_b128 v[120:123], v2 offset:9216
    ds_read_b32 v124, v3 offset:9216
    ds_read_b128 v[128:131], v4 offset:6144
    ds_read_b128 v[132:135], v4 offset:6784
    v_exp_f32 v32, v32
    v_exp_f32 v33, v33
    v_exp_f32 v34, v34
    v_exp_f32 v35, v35
    v_mfma_f32_32x32x16_bf16 v[48:63], v[116:119], v[28:31], v[48:63]
    v_exp_f32 v36, v36
    v_exp_f32 v37, v37
    v_exp_f32 v38, v38
    v_exp_f32 v39, v39
    v_cvt_pk_bf16_f32 v64, v32, v33
    v_cvt_pk_bf16_f32 v65, v34, v35
    v_mfma_f32_32x32x16_bf16 v[96:111], v[136:139], v[72:75], v[96:111]
    v_exp_f32 v40, v40
    v_exp_f32 v41, v41
    v_exp_f32 v42, v42
    v_exp_f32 v43, v43
    v_cvt_pk_bf16_f32 v66, v36, v37
    v_cvt_pk_bf16_f32 v67, v38, v39
    v_mfma_f32_32x32x16_bf16 v[96:111], v[140:143], v[76:79], v[96:111]
    v_exp_f32 v44, v44
    v_exp_f32 v45, v45
    v_exp_f32 v46, v46
    v_exp_f32 v47, v47
    v_cvt_pk_bf16_f32 v68, v40, v41
    v_cvt_pk_bf16_f32 v69, v42, v43
    v_cvt_pk_bf16_f32 v70, v44, v45
    v_cvt_pk_bf16_f32 v71, v46, v47
    s_waitcnt lgkmcnt(2)
    v_mfma_f32_32x32x16_bf16 v[32:47], v[120:123], v[16:19], 0
    v_exp_f32 v48, v48
    v_exp_f32 v49, v49
    v_exp_f32 v50, v50
    v_exp_f32 v51, v51
    v_mfma_f32_32x32x16_bf16 v[32:47], v[124:127], v[20:23], v[32:47]
    v_exp_f32 v52, v52
    v_exp_f32 v53, v53
    v_exp_f32 v54, v54
    v_exp_f32 v55, v55
    v_cvt_pk_bf16_f32 v72, v48, v49
    v_cvt_pk_bf16_f32 v73, v50, v51
    s_waitcnt lgkmcnt(0)
    v_mfma_f32_32x32x16_bf16 v[80:95], v[128:131], v[64:67], v[80:95]
    v_exp_f32 v56, v56
    v_exp_f32 v57, v57
    v_exp_f32 v58, v58
    v_exp_f32 v59, v59
    v_cvt_pk_bf16_f32 v74, v52, v53
    v_cvt_pk_bf16_f32 v75, v54, v55
    v_mfma_f32_32x32x16_bf16 v[80:95], v[132:135], v[68:71], v[80:95]
    v_exp_f32 v60, v60
    v_exp_f32 v61, v61
    v_exp_f32 v62, v62
    v_exp_f32 v63, v63
    v_cvt_pk_bf16_f32 v76, v56, v57
    v_cvt_pk_bf16_f32 v77, v58, v59
    v_cvt_pk_bf16_f32 v78, v60, v61
    v_cvt_pk_bf16_f32 v79, v62, v63
    v_mfma_f32_32x32x16_bf16 v[48:63], v[120:123], v[24:27], 0
    ds_read_b128 v[136:139], v4 offset:9216
    ds_read_b128 v[140:143], v4 offset:9856
    v_exp_f32 v32, v32
    v_exp_f32 v33, v33
    v_exp_f32 v34, v34
    v_exp_f32 v35, v35
    v_mfma_f32_32x32x16_bf16 v[48:63], v[124:127], v[28:31], v[48:63]
    v_exp_f32 v36, v36
    v_exp_f32 v37, v37
    v_exp_f32 v38, v38
    v_exp_f32 v39, v39
    v_cvt_pk_bf16_f32 v64, v32, v33
    v_cvt_pk_bf16_f32 v65, v34, v35
    v_mfma_f32_32x32x16_bf16 v[96:111], v[128:131], v[72:75], v[96:111]
    v_exp_f32 v40, v40
    v_exp_f32 v41, v41
    v_exp_f32 v42, v42
    v_exp_f32 v43, v43
    v_cvt_pk_bf16_f32 v66, v36, v37
    v_cvt_pk_bf16_f32 v67, v38, v39
    v_mfma_f32_32x32x16_bf16 v[96:111], v[132:135], v[76:79], v[96:111]
    v_exp_f32 v44, v44
    v_exp_f32 v45, v45
    v_exp_f32 v46, v46
    v_exp_f32 v47, v47
    v_cvt_pk_bf16_f32 v68, v40, v41
    v_cvt_pk_bf16_f32 v69, v42, v43
    v_cvt_pk_bf16_f32 v70, v44, v45
    v_cvt_pk_bf16_f32 v71, v46, v47
    v_exp_f32 v48, v48
    v_exp_f32 v49, v49
    v_exp_f32 v50, v50
    v_exp_f32 v51, v51
    v_exp_f32 v52, v52
    v_exp_f32 v53, v53
    v_exp_f32 v54, v54
    v_exp_f32 v55, v55
    v_cvt_pk_bf16_f32 v72, v48, v49
    v_cvt_pk_bf16_f32 v73, v50, v51
    s_waitcnt lgkmcnt(0)
    v_mfma_f32_32x32x16_bf16 v[80:95], v[136:139], v[64:67], v[80:95]
    v_exp_f32 v56, v56
    v_exp_f32 v57, v57
    v_exp_f32 v58, v58
    v_exp_f32 v59, v59
    v_cvt_pk_bf16_f32 v74, v52, v53
    v_cvt_pk_bf16_f32 v75, v54, v55
    v_mfma_f32_32x32x16_bf16 v[80:95], v[140:143], v[68:71], v[80:95]
    v_exp_f32 v60, v60
    v_exp_f32 v61, v61
    v_exp_f32 v62, v62
    v_exp_f32 v63, v63
    v_cvt_pk_bf16_f32 v76, v56, v57
    v_cvt_pk_bf16_f32 v77, v58, v59
    v_cvt_pk_bf16_f32 v78, v60, v61
    v_cvt_pk_bf16_f32 v79, v62, v63
    v_mfma_f32_32x32x16_bf16 v[96:111], v[136:139], v[72:75], v[96:111]
    s_nop 0
    v_mfma_f32_32x32x16_bf16 v[96:111], v[140:143], v[76:79], v[96:111]
    s_setprio 0
    s_nop 15
    v_min_f32 v12, v90, v106
    s_mov_b32 s40, 0x21800000
    v_cmp_nle_f32 vcc, s40, v12
    s_nop 4
    s_cbranch_vccz L_at_fin
    v_and_b32 v6, 31, v1
    v_lshlrev_b32 v6, 2, v6
    v_mov_b32 v64, 0xff800000
    v_mov_b32 v72, 0xff800000
    v_mov_b32 v117, 0
    s_mov_b32 s42, 0
L_fb1:
    buffer_load_dwordx4 v[112:115], v5, s[28:31], s42 offen sc1
    buffer_load_dword v116, v6, s[28:31], s42 offen offset:1024 sc1
    s_waitcnt vmcnt(0)
    v_mfma_f32_32x32x16_bf16 v[32:47], v[112:115], v[16:19], 0
    v_mfma_f32_32x32x16_bf16 v[32:47], v[116:119], v[20:23], v[32:47]
    v_mfma_f32_32x32x16_bf16 v[48:63], v[112:115], v[24:27], 0
    v_mfma_f32_32x32x16_bf16 v[48:63], v[116:119], v[28:31], v[48:63]
    s_nop 9
    v_max3_f32 v64, v64, v32, v33
    v_max3_f32 v64, v64, v34, v35
    v_max3_f32 v64, v64, v36, v37
    v_max3_f32 v64, v64, v38, v39
    v_max3_f32 v64, v64, v40, v41
    v_max3_f32 v64, v64, v42, v43
    v_max3_f32 v64, v64, v44, v45
    v_max3_f32 v64, v64, v46, v47
    v_max3_f32 v72, v72, v48, v49
    v_max3_f32 v72, v72, v50, v51
    v_max3_f32 v72, v72, v52, v53
    v_max3_f32 v72, v72, v54, v55
    v_max3_f32 v72, v72, v56, v57
    v_max3_f32 v72, v72, v58, v59
    v_max3_f32 v72, v72, v60, v61
    v_max3_f32 v72, v72, v62, v63
    s_add_u32 s42, s42, 3072
    s_cmp_lt_u32 s42, 196608
    s_cbranch_scc1 L_fb1
    v_cmp_gt_u32 vcc, 32, v1
    s_mov_b32 s54, 0xffff0000
    v_mov_b32 v65, v64
    s_nop 1
    v_permlane32_swap_b32 v64, v65
    v_max_f32 v64, v64, v65
    v_sub_f32 v64, 0, v64
    v_and_b32 v65, s54, v64
    v_sub_f32 v64, v64, v65
    v_and_b32 v66, s54, v64
    v_sub_f32 v64, v64, v66
    v_lshrrev_b32 v65, 16, v65
    v_or_b32 v65, v65, v66
    v_lshrrev_b32 v64, 16, v64
    v_cndmask_b32 v21, 0, v65, vcc
    v_cndmask_b32 v22, 0, v64, vcc
    v_mov_b32 v80, 0
    v_mov_b32 v81, 0
    v_mov_b32 v82, 0
    v_mov_b32 v83, 0
    v_mov_b32 v84, 0
    v_mov_b32 v85, 0
    v_mov_b32 v86, 0
    v_mov_b32 v87, 0
    v_mov_b32 v88, 0
    v_mov_b32 v89, 0
    v_mov_b32 v90, 0
    v_mov_b32 v91, 0
    v_mov_b32 v92, 0
    v_mov_b32 v93, 0
    v_mov_b32 v94, 0
    v_mov_b32 v95, 0
    v_mov_b32 v73, v72
    s_nop 1
    v_permlane32_swap_b32 v72, v73
    v_max_f32 v72, v72, v73
    v_sub_f32 v72, 0, v72
    v_and_b32 v73, s54, v72
    v_sub_f32 v72, v72, v73
    v_and_b32 v74, s54, v72
    v_sub_f32 v72, v72, v74
    v_lshrrev_b32 v73, 16, v73
    v_or_b32 v73, v73, v74
    v_lshrrev_b32 v72, 16, v72
    v_cndmask_b32 v29, 0, v73, vcc
    v_cndmask_b32 v30, 0, v72, vcc
    v_mov_b32 v96, 0
    v_mov_b32 v97, 0
    v_mov_b32 v98, 0
    v_mov_b32 v99, 0
    v_mov_b32 v100, 0
    v_mov_b32 v101, 0
    v_mov_b32 v102, 0
    v_mov_b32 v103, 0
    v_mov_b32 v104, 0
    v_mov_b32 v105, 0
    v_mov_b32 v106, 0
    v_mov_b32 v107, 0
    v_mov_b32 v108, 0
    v_mov_b32 v109, 0
    v_mov_b32 v110, 0
    v_mov_b32 v111, 0
    v_mov_b32 v117, 0x3f803f80
    v_mov_b32 v118, 0x3f80
    s_mov_b32 s42, 0
L_fb2:
    buffer_load_dwordx4 v[112:115], v5, s[28:31], s42 offen sc1
    buffer_load_dword v116, v6, s[28:31], s42 offen offset:1024 sc1
    buffer_load_dwordx4 v[128:131], v9, s[28:31], s42 offen offset:1280 sc1
    buffer_load_dwordx4 v[132:135], v9, s[28:31], s42 offen offset:1920 sc1
    s_waitcnt vmcnt(0)
    v_mfma_f32_32x32x16_bf16 v[32:47], v[112:115], v[16:19], 0
    v_mfma_f32_32x32x16_bf16 v[32:47], v[116:119], v[20:23], v[32:47]
    v_mfma_f32_32x32x16_bf16 v[48:63], v[112:115], v[24:27], 0
    v_mfma_f32_32x32x16_bf16 v[48:63], v[116:119], v[28:31], v[48:63]
    s_nop 9
    v_exp_f32 v32, v32
    v_exp_f32 v33, v33
    v_exp_f32 v34, v34
    v_exp_f32 v35, v35
    v_exp_f32 v36, v36
    v_exp_f32 v37, v37
    v_exp_f32 v38, v38
    v_exp_f32 v39, v39
    v_exp_f32 v40, v40
    v_exp_f32 v41, v41
    v_exp_f32 v42, v42
    v_exp_f32 v43, v43
    v_exp_f32 v44, v44
    v_exp_f32 v45, v45
    v_exp_f32 v46, v46
    v_exp_f32 v47, v47
    v_cvt_pk_bf16_f32 v64, v32, v33
    v_cvt_pk_bf16_f32 v65, v34, v35
    v_cvt_pk_bf16_f32 v66, v36, v37
    v_cvt_pk_bf16_f32 v67, v38, v39
    v_cvt_pk_bf16_f32 v68, v40, v41
    v_cvt_pk_bf16_f32 v69, v42, v43
    v_cvt_pk_bf16_f32 v70, v44, v45
    v_cvt_pk_bf16_f32 v71, v46, v47
    v_mfma_f32_32x32x16_bf16 v[80:95], v[128:131], v[64:67], v[80:95]
    s_nop 0
    v_mfma_f32_32x32x16_bf16 v[80:95], v[132:135], v[68:71], v[80:95]
    v_exp_f32 v48, v48
    v_exp_f32 v49, v49
    v_exp_f32 v50, v50
    v_exp_f32 v51, v51
    v_exp_f32 v52, v52
    v_exp_f32 v53, v53
    v_exp_f32 v54, v54
    v_exp_f32 v55, v55
    v_exp_f32 v56, v56
    v_exp_f32 v57, v57
    v_exp_f32 v58, v58
    v_exp_f32 v59, v59
    v_exp_f32 v60, v60
    v_exp_f32 v61, v61
    v_exp_f32 v62, v62
    v_exp_f32 v63, v63
    v_cvt_pk_bf16_f32 v72, v48, v49
    v_cvt_pk_bf16_f32 v73, v50, v51
    v_cvt_pk_bf16_f32 v74, v52, v53
    v_cvt_pk_bf16_f32 v75, v54, v55
    v_cvt_pk_bf16_f32 v76, v56, v57
    v_cvt_pk_bf16_f32 v77, v58, v59
    v_cvt_pk_bf16_f32 v78, v60, v61
    v_cvt_pk_bf16_f32 v79, v62, v63
    v_mfma_f32_32x32x16_bf16 v[96:111], v[128:131], v[72:75], v[96:111]
    s_nop 0
    v_mfma_f32_32x32x16_bf16 v[96:111], v[132:135], v[76:79], v[96:111]
    s_nop 7
    s_add_u32 s42, s42, 3072
    s_cmp_lt_u32 s42, 196608
    s_cbranch_scc1 L_fb2
    s_nop 15
L_at_fin:
    s_mul_i32 s43, s39, 324
    s_lshl_b32 s40, s38, 1
    s_add_u32 s41, s43, s40
    s_add_u32 s41, s41, 288
    s_lshl_b32 s41, s41, 10
    s_lshr_b32 s42, s40, 3
    s_add_u32 s43, s43, s42
    s_add_u32 s43, s43, 320
    s_lshl_b32 s43, s43, 10
    s_and_b32 s42, s38, 1
    s_lshl_b32 s42, s42, 9
    s_add_u32 s43, s43, s42
    s_bfe_u32 s42, s38, 0x10001
    s_lshl_b32 s42, s42, 3
    s_add_u32 s43, s43, s42
    v_rcp_f32 v32, v90
    s_nop 0
    v_mul_f32 v80, v80, v32
    v_mul_f32 v81, v81, v32
    v_mul_f32 v82, v82, v32
    v_mul_f32 v83, v83, v32
    v_mul_f32 v84, v84, v32
    v_mul_f32 v85, v85, v32
    v_mul_f32 v86, v86, v32
    v_mul_f32 v87, v87, v32
    v_mul_f32 v88, v88, v32
    v_mul_f32 v89, v89, v32
    v_cvt_pk_bf16_f32 v36, v80, v81
    v_cvt_pk_bf16_f32 v37, v82, v83
    v_cvt_pk_bf16_f32 v38, v84, v85
    v_cvt_pk_bf16_f32 v39, v86, v87
    v_cvt_pk_bf16_f32 v40, v88, v89
    buffer_store_dwordx4 v[36:39], v5, s[24:27], s41 offen offset:0 sc1
    v_rcp_f32 v48, v106
    s_nop 0
    v_mul_f32 v96, v96, v48
    v_mul_f32 v97, v97, v48
    v_mul_f32 v98, v98, v48
    v_mul_f32 v99, v99, v48
    v_mul_f32 v100, v100, v48
    v_mul_f32 v101, v101, v48
    v_mul_f32 v102, v102, v48
    v_mul_f32 v103, v103, v48
    v_mul_f32 v104, v104, v48
    v_mul_f32 v105, v105, v48
    v_cvt_pk_bf16_f32 v52, v96, v97
    v_cvt_pk_bf16_f32 v53, v98, v99
    v_cvt_pk_bf16_f32 v54, v100, v101
    v_cvt_pk_bf16_f32 v55, v102, v103
    v_cvt_pk_bf16_f32 v56, v104, v105
    buffer_store_dwordx4 v[52:55], v5, s[24:27], s41 offen offset:1024 sc1
    s_mov_b32 exec_hi, 0
    v_mov_b32 v41, v56
    buffer_store_dwordx2 v[40:41], v5, s[24:27], s43 offen sc1
    s_mov_b32 exec_hi, -1
    s_waitcnt vmcnt(0)
    s_mov_b64 exec, 1
    ds_add_u32 v0, v0 offset:4
    s_mov_b64 exec, -1
    s_add_u32 s52, s52, s53
    s_cmp_lg_u32 s36, 0
    s_cbranch_scc1 L_at_nopub
    ds_read_b32 v15, v0 offset:4
    s_waitcnt lgkmcnt(0)
L_cfin:
    v_cmp_gt_u32 vcc, s52, v15
    s_cbranch_vccz L_cfin_ok
    s_add_u32 s3, s3, 1
    s_cmp_ge_u32 s3, 0x400000
    s_cbranch_scc1 L_cfin_ok
    s_sleep 1
    ds_read_b32 v15, v0 offset:4
    s_waitcnt lgkmcnt(0)
    s_branch L_cfin
L_cfin_ok:
    s_lshl_b32 s40, s37, 4
    s_and_b32 s41, s38, 12
    s_add_u32 s40, s40, s41
    s_lshl_b32 s40, s40, 7
    s_and_b32 s41, s38, 3
    s_lshl_b32 s41, s41, 2
    s_add_u32 s40, s40, s41
    s_add_u32 s40, s40, 9437248
    v_mov_b32 v12, s61
    v_mov_b32 v13, s60
    v_cmp_gt_u32 vcc, 4, v1
    s_nop 1
    v_cndmask_b32 v13, v12, v13, vcc
    v_mul_u32_u24 v12, 128, v1
    s_mov_b64 exec, 0xf0
    v_subrev_u32 v12, 496, v12
    s_mov_b64 exec, 0xff
    buffer_store_dword v13, v12, s[12:15], s40 offen sc1
    s_mov_b64 exec, -1
L_at_nopub:
L_end:
    s_endpgm
.section .rodata,"a"
.p2align 6
.amdhsa_kernel parallel_sum__grouped_kv_mqa__glu_gated_reglu__prompt_kernel
  .amdhsa_next_free_vgpr 256
  .amdhsa_next_free_sgpr 102
  .amdhsa_accum_offset 256
  .amdhsa_group_segment_fixed_size 0
  .amdhsa_kernarg_size 96
  .amdhsa_user_sgpr_count 2
  .amdhsa_user_sgpr_kernarg_segment_ptr 1
  .amdhsa_system_sgpr_workgroup_id_x 1
.end_amdhsa_kernel
```
